```python
import torch

def _softmax(x, axis=-1):
    return torch.softmax(x, dim=axis)
def _gelu(x):
    return torch.nn.functional.gelu(x, approximate="tanh")
def _silu(x):
    return torch.nn.functional.silu(x)
def _sigmoid(x):
    return torch.sigmoid(x)
def _layernorm(x, axis=-1, eps=1e-5):
    m = x.mean(dim=axis, keepdim=True)
    v = x.var(dim=axis, keepdim=True, unbiased=False)
    return (x - m) / torch.sqrt(v + eps)
def _scatter_add(tgt, idx, src, axis=0):
    return tgt.clone().index_add_(axis, idx, src)
def _segment_sum(src, seg, n):
    out = torch.zeros((n,) + src.shape[1:], dtype=src.dtype)
    return out.index_add_(0, seg, src)
def _pad(x, pw):
    flat = tuple(v for pair in reversed(pw) for v in pair)
    return torch.nn.functional.pad(x, flat)

kernel_name = 'parallel_sum__sliding_local_dilated__dense_activation_squared_relu__prompt'

def setup_inputs():

    _w = (lambda a: (lambda t: t.to(torch.bfloat16) if t.is_floating_point() else t)(torch.as_tensor(a)))
    def _A_setup():
        B, S, D = 1, 2048, 576
        return {
            "x": _w((lambda *s: torch.randn(*s, dtype=torch.bfloat16) * 0.05)(B, S, D)),
            "wqkv": _w((lambda *s: torch.randn(*s, dtype=torch.bfloat16) * 0.1)(D, 3 * D)),
            "wo": _w((lambda *s: torch.randn(*s, dtype=torch.bfloat16) * 0.05)(D, D)),
        }
    _A_in = _A_setup()

    def _B_setup():
        B, S, D, F = 1, 2048, 576, 4608
        return {
            "x": _w((lambda *s: torch.randn(*s, dtype=torch.bfloat16) * 0.05)(B, S, D)),
            "w1": _w((lambda *s: torch.randn(*s, dtype=torch.bfloat16) * 0.05)(D, F)),
            "b1": _w((lambda *s: torch.randn(*s, dtype=torch.bfloat16) * 0.2)(F)),
            "w2": _w((lambda *s: torch.randn(*s, dtype=torch.bfloat16) * 0.05)(F, D)),
            "b2": _w((lambda *s: torch.randn(*s, dtype=torch.bfloat16) * 1.6)(D)),
        }
    _B_in = _B_setup()

    return {
        "A_x": _A_in["x"],
        "A_wqkv": _A_in["wqkv"],
        "A_wo": _A_in["wo"],
        "B_x": _B_in["x"],
        "B_w1": _B_in["w1"],
        "B_b1": _B_in["b1"],
        "B_w2": _B_in["w2"],
        "B_b2": _B_in["b2"],
    }

def reference(A_x, A_wqkv, A_wo, B_x, B_w1, B_b1, B_w2, B_b2):
    def _A_ref(x, wqkv, wo):
        B, S, D = x.shape
        H = 32; Dh = D // H
        W, dil = 8, 2
        qkv = (lambda x, *d: x.permute(*d))((x @ wqkv).reshape(B, S, 3, H, Dh), 2, 0, 3, 1, 4)
        q, k, v = qkv[0], qkv[1], qkv[2]
        scale = Dh ** -0.5
        pos = torch.arange(S)
        off = torch.arange(W) * dil
        idx = pos[:, None] - off[None, :]
        mask = idx >= 0
        idx_c = torch.where(mask, idx, 0).reshape(-1)
        kg = k[:, :, idx_c, :].reshape(B, H, S, W, Dh)
        vg = v[:, :, idx_c, :].reshape(B, H, S, W, Dh)
        logits = torch.einsum("bhsd,bhswd->bhsw", q, kg) * scale
        logits = torch.where(mask[None, None, :, :], logits, -1e9)
        attn = _softmax(logits, axis=-1)
        o = torch.einsum("bhsw,bhswd->bhsd", attn, vg)
        return (lambda x, *d: x.permute(*d))(o, 0, 2, 1, 3).reshape(B, S, D) @ wo

    def _B_ref(x, w1, b1, w2, b2):
        h = torch.einsum("bsd,df->bsf", x, w1) + b1
        zero = torch.zeros_like(h)
        r = torch.where(h > zero, h, zero)
        h = r * r
        out = torch.einsum("bsf,fd->bsd", h, w2) + b2
        return out

    x = A_x
    xn = _layernorm(x, axis=-1)
    return x + _A_ref(xn, A_wqkv, A_wo) + _B_ref(xn, B_w1, B_b1, B_w2, B_b2)
```

```asm
; @launch grid=(256,1,1) block=(768,1,1) lds=163840
.amdgcn_target "amdgcn-amd-amdhsa--gfx950"
.text
.globl parallel_sum__sliding_local_dilated__dense_activation_squared_relu__prompt_kernel
.p2align 8
.type parallel_sum__sliding_local_dilated__dense_activation_squared_relu__prompt_kernel,@function
parallel_sum__sliding_local_dilated__dense_activation_squared_relu__prompt_kernel:
    s_cmp_ge_u32 s2, 256
    s_cbranch_scc1 L_exit
    s_load_dwordx4 s[56:59], s[0:1], 0
    s_load_dwordx4 s[64:67], s[0:1], 32
    s_load_dwordx2 s[60:61], s[0:1], 16
    s_load_dwordx8 s[68:75], s[0:1], 48
    s_load_dwordx2 s[76:77], s[0:1], 80
    s_memrealtime s[78:79]
    v_lshrrev_b32 v2, 6, v0
    v_and_b32 v3, 63, v0
    v_readfirstlane_b32 s31, v2
    v_lshlrev_b32 v1, 4, v3
    s_and_b32 s29, s2, 3
    s_bfe_u32 s30, s2, 0x20003
    s_lshr_b32 s36, s2, 6
    s_bfe_u32 s34, s2, 0x10002
    s_bfe_u32 s35, s2, 0x10005
    s_lshl_b32 s28, s36, 2
    s_lshl_b32 s34, s34, 1
    s_add_u32 s28, s28, s34
    s_add_u32 s28, s28, s35
    s_lshl_b32 s36, s36, 1
    s_add_u32 s53, s36, s35
    s_and_b32 s32, s31, 3
    s_lshr_b32 s33, s31, 2
    s_mov_b32 s50, 0x07060302
    s_mov_b32 s52, 0xffff0000
    s_mul_i32 s48, s29, 3
    s_add_u32 s48, s48, s30
    s_add_u32 s34, s29, 12
    s_cmp_eq_u32 s30, 3
    s_cselect_b32 s48, s34, s48
    s_cbranch_scc1 L_roleA
    s_cmp_ge_u32 s31, 8
    s_cbranch_scc1 L_helperF
L_cpf0F:
    s_getpc_b64 s[94:95]
    s_bfe_u32 s54, s2, 0x30005
    s_lshl_b32 s54, s54, 13
    v_lshrrev_b32 v2, 3, v0
    v_lshlrev_b32 v2, 7, v2
    v_add_u32 v2, s54, v2
    v_min_u32 v2, CODE_LAST, v2
    global_load_dword v16, v2, s[94:95]
    s_waitcnt lgkmcnt(0)
    s_mov_b32 s16, s76
    s_mov_b32 s17, s77
    s_mov_b32 s18, 35946496
    s_mov_b32 s19, 0x20000
    s_or_b32 s51, s78, 1
    s_setprio 2
    v_bfe_u32 v4, v1, 4, 5
    v_lshrrev_b32 v5, 9, v1
    v_bfe_u32 v6, v1, 5, 3
    v_xor_b32 v5, v5, v6
    s_lshl_b32 s34, s32, 12
    s_add_u32 s34, s34, 122880
    v_lshlrev_b32 v4, 7, v4
    v_add_u32 v4, s34, v4
    v_xor_b32 v6, 0, v5
    v_lshl_add_u32 v8, v6, 4, v4
    v_xor_b32 v6, 2, v5
    v_lshl_add_u32 v9, v6, 4, v4
    v_xor_b32 v6, 4, v5
    v_lshl_add_u32 v10, v6, 4, v4
    v_xor_b32 v6, 6, v5
    v_lshl_add_u32 v11, v6, 4, v4
    v_lshrrev_b32 v4, 9, v1
    v_bfe_u32 v5, v1, 6, 2
    v_lshl_add_u32 v4, v4, 2, v5
    v_mul_u32_u24 v4, 384, v4
    v_bfe_u32 v6, v1, 8, 1
    v_lshl_add_u32 v4, v6, 5, v4
    v_bfe_u32 v6, v1, 4, 2
    v_lshl_add_u32 v4, v6, 3, v4
    v_bfe_u32 v5, v1, 7, 1
    v_lshlrev_b32 v5, 6, v5
    s_mul_i32 s34, s33, 12288
    v_add3_u32 v2, v4, v5, s34
    v_sub_u32 v4, v4, v5
    v_add_u32 v3, s34, v4
    s_lshl_b32 s34, s31, 11
    s_add_u32 s34, s34, 122880
    v_add_u32 v12, s34, v1
    s_xor_b32 s34, s31, 4
    s_lshl_b32 s34, s34, 11
    s_add_u32 s34, s34, 122880
    v_add_u32 v13, s34, v1
    v_add_u32 v14, -98304, v12
    v_add_u32 v15, -98304, v13
    s_mov_b32 s98, s30
    s_add_u32 s96, s30, 1
    s_cmp_eq_u32 s96, 3
    s_cselect_b32 s96, 0, s96
    s_add_u32 s97, s96, 1
    s_cmp_eq_u32 s97, 3
    s_cselect_b32 s97, 0, s97
    s_mul_i32 s34, s28, 36
    s_add_u32 s34, s34, s48
    s_lshl_b32 s34, s34, 2
    s_add_u32 s34, s34, s32
    s_mul_i32 s34, s34, 6
    s_add_u32 s34, s34, s33
    s_lshl_b32 s34, s34, 11
    s_mul_i32 s56, s96, 589824
    s_add_u32 s56, s56, s34
    s_mul_i32 s57, s97, 589824
    s_add_u32 s57, s57, s34
    s_mul_i32 s58, s98, 589824
    s_add_u32 s58, s58, s34
    s_waitcnt vmcnt(0)
    s_barrier
    ds_read_b128 v[136:139], v8 offset:0
    ds_read_b128 v[140:143], v9 offset:0
    ds_read_b64_tr_b16 v[16:17], v2 offset:0
    ds_read_b64_tr_b16 v[18:19], v2 offset:3072
    ds_read_b64_tr_b16 v[20:21], v3 offset:64
    ds_read_b64_tr_b16 v[22:23], v3 offset:3136
    ds_read_b64_tr_b16 v[24:25], v2 offset:128
    ds_read_b64_tr_b16 v[26:27], v2 offset:3200
    ds_read_b64_tr_b16 v[28:29], v3 offset:192
    ds_read_b64_tr_b16 v[30:31], v3 offset:3264
    ds_read_b64_tr_b16 v[32:33], v2 offset:256
    ds_read_b64_tr_b16 v[34:35], v2 offset:3328
    ds_read_b64_tr_b16 v[36:37], v3 offset:320
    ds_read_b64_tr_b16 v[38:39], v3 offset:3392
    s_waitcnt lgkmcnt(13)
    s_waitcnt lgkmcnt(10)
    v_mfma_f32_32x32x16_bf16 v[40:55], v[16:19], v[136:139], 0
    ds_read_b64_tr_b16 v[16:17], v2 offset:6144
    ds_read_b64_tr_b16 v[18:19], v2 offset:9216
    s_waitcnt lgkmcnt(10)
    v_mfma_f32_32x32x16_bf16 v[56:71], v[20:23], v[136:139], 0
    ds_read_b64_tr_b16 v[20:21], v3 offset:6208
    ds_read_b64_tr_b16 v[22:23], v3 offset:9280
    s_waitcnt lgkmcnt(10)
    v_mfma_f32_32x32x16_bf16 v[72:87], v[24:27], v[136:139], 0
    ds_read_b64_tr_b16 v[24:25], v2 offset:6272
    ds_read_b64_tr_b16 v[26:27], v2 offset:9344
    s_waitcnt lgkmcnt(10)
    v_mfma_f32_32x32x16_bf16 v[88:103], v[28:31], v[136:139], 0
    ds_read_b64_tr_b16 v[28:29], v3 offset:6336
    ds_read_b64_tr_b16 v[30:31], v3 offset:9408
    s_waitcnt lgkmcnt(10)
    v_mfma_f32_32x32x16_bf16 v[104:119], v[32:35], v[136:139], 0
    ds_read_b64_tr_b16 v[32:33], v2 offset:6400
    ds_read_b64_tr_b16 v[34:35], v2 offset:9472
    s_waitcnt lgkmcnt(10)
    v_mfma_f32_32x32x16_bf16 v[120:135], v[36:39], v[136:139], 0
    ds_read_b64_tr_b16 v[36:37], v3 offset:6464
    ds_read_b64_tr_b16 v[38:39], v3 offset:9536
    s_waitcnt lgkmcnt(10)
    v_mfma_f32_32x32x16_bf16 v[40:55], v[16:19], v[140:143], v[40:55]
    s_barrier
    ds_read_b128 v[136:139], v10 offset:0
    ds_read_b64_tr_b16 v[16:17], v2 offset:24576
    ds_read_b64_tr_b16 v[18:19], v2 offset:27648
    s_waitcnt lgkmcnt(11)
    v_mfma_f32_32x32x16_bf16 v[56:71], v[20:23], v[140:143], v[56:71]
    ds_read_b64_tr_b16 v[20:21], v3 offset:24640
    ds_read_b64_tr_b16 v[22:23], v3 offset:27712
    s_waitcnt lgkmcnt(11)
    v_mfma_f32_32x32x16_bf16 v[72:87], v[24:27], v[140:143], v[72:87]
    ds_read_b64_tr_b16 v[24:25], v2 offset:24704
    ds_read_b64_tr_b16 v[26:27], v2 offset:27776
    s_waitcnt lgkmcnt(11)
    v_mfma_f32_32x32x16_bf16 v[88:103], v[28:31], v[140:143], v[88:103]
    ds_read_b64_tr_b16 v[28:29], v3 offset:24768
    ds_read_b64_tr_b16 v[30:31], v3 offset:27840
    s_waitcnt lgkmcnt(11)
    v_mfma_f32_32x32x16_bf16 v[104:119], v[32:35], v[140:143], v[104:119]
    ds_read_b64_tr_b16 v[32:33], v2 offset:24832
    ds_read_b64_tr_b16 v[34:35], v2 offset:27904
    s_waitcnt lgkmcnt(11)
    v_mfma_f32_32x32x16_bf16 v[120:135], v[36:39], v[140:143], v[120:135]
    ds_read_b64_tr_b16 v[36:37], v3 offset:24896
    ds_read_b64_tr_b16 v[38:39], v3 offset:27968
    ds_read_b128 v[140:143], v11 offset:0
    s_waitcnt lgkmcnt(13)
    s_waitcnt lgkmcnt(11)
    v_mfma_f32_32x32x16_bf16 v[40:55], v[16:19], v[136:139], v[40:55]
    ds_read_b64_tr_b16 v[16:17], v2 offset:30720
    ds_read_b64_tr_b16 v[18:19], v2 offset:33792
    s_waitcnt lgkmcnt(11)
    v_mfma_f32_32x32x16_bf16 v[56:71], v[20:23], v[136:139], v[56:71]
    ds_read_b64_tr_b16 v[20:21], v3 offset:30784
    ds_read_b64_tr_b16 v[22:23], v3 offset:33856
    s_waitcnt lgkmcnt(11)
    v_mfma_f32_32x32x16_bf16 v[72:87], v[24:27], v[136:139], v[72:87]
    ds_read_b64_tr_b16 v[24:25], v2 offset:30848
    ds_read_b64_tr_b16 v[26:27], v2 offset:33920
    s_waitcnt lgkmcnt(11)
    v_mfma_f32_32x32x16_bf16 v[88:103], v[28:31], v[136:139], v[88:103]
    ds_read_b64_tr_b16 v[28:29], v3 offset:30912
    ds_read_b64_tr_b16 v[30:31], v3 offset:33984
    s_waitcnt lgkmcnt(11)
    v_mfma_f32_32x32x16_bf16 v[104:119], v[32:35], v[136:139], v[104:119]
    ds_read_b64_tr_b16 v[32:33], v2 offset:30976
    ds_read_b64_tr_b16 v[34:35], v2 offset:34048
    s_waitcnt lgkmcnt(11)
    v_mfma_f32_32x32x16_bf16 v[120:135], v[36:39], v[136:139], v[120:135]
    ds_read_b64_tr_b16 v[36:37], v3 offset:31040
    ds_read_b64_tr_b16 v[38:39], v3 offset:34112
    s_waitcnt lgkmcnt(12)
    s_waitcnt lgkmcnt(10)
    v_mfma_f32_32x32x16_bf16 v[40:55], v[16:19], v[140:143], v[40:55]
    s_barrier
    ds_read_b128 v[136:139], v8 offset:16384
    ds_read_b64_tr_b16 v[16:17], v2 offset:49152
    ds_read_b64_tr_b16 v[18:19], v2 offset:52224
    s_waitcnt lgkmcnt(11)
    v_mfma_f32_32x32x16_bf16 v[56:71], v[20:23], v[140:143], v[56:71]
    ds_read_b64_tr_b16 v[20:21], v3 offset:49216
    ds_read_b64_tr_b16 v[22:23], v3 offset:52288
    s_waitcnt lgkmcnt(11)
    v_mfma_f32_32x32x16_bf16 v[72:87], v[24:27], v[140:143], v[72:87]
    ds_read_b64_tr_b16 v[24:25], v2 offset:49280
    ds_read_b64_tr_b16 v[26:27], v2 offset:52352
    s_waitcnt lgkmcnt(11)
    v_mfma_f32_32x32x16_bf16 v[88:103], v[28:31], v[140:143], v[88:103]
    ds_read_b64_tr_b16 v[28:29], v3 offset:49344
    ds_read_b64_tr_b16 v[30:31], v3 offset:52416
    s_waitcnt lgkmcnt(11)
    v_mfma_f32_32x32x16_bf16 v[104:119], v[32:35], v[140:143], v[104:119]
    ds_read_b64_tr_b16 v[32:33], v2 offset:49408
    ds_read_b64_tr_b16 v[34:35], v2 offset:52480
    s_waitcnt lgkmcnt(11)
    v_mfma_f32_32x32x16_bf16 v[120:135], v[36:39], v[140:143], v[120:135]
    ds_read_b64_tr_b16 v[36:37], v3 offset:49472
    ds_read_b64_tr_b16 v[38:39], v3 offset:52544
    ds_read_b128 v[140:143], v9 offset:16384
    s_waitcnt lgkmcnt(13)
    s_waitcnt lgkmcnt(11)
    v_mfma_f32_32x32x16_bf16 v[40:55], v[16:19], v[136:139], v[40:55]
    ds_read_b64_tr_b16 v[16:17], v2 offset:55296
    ds_read_b64_tr_b16 v[18:19], v2 offset:58368
    s_waitcnt lgkmcnt(11)
    v_mfma_f32_32x32x16_bf16 v[56:71], v[20:23], v[136:139], v[56:71]
    ds_read_b64_tr_b16 v[20:21], v3 offset:55360
    ds_read_b64_tr_b16 v[22:23], v3 offset:58432
    s_waitcnt lgkmcnt(11)
    v_mfma_f32_32x32x16_bf16 v[72:87], v[24:27], v[136:139], v[72:87]
    ds_read_b64_tr_b16 v[24:25], v2 offset:55424
    ds_read_b64_tr_b16 v[26:27], v2 offset:58496
    s_waitcnt lgkmcnt(11)
    v_mfma_f32_32x32x16_bf16 v[88:103], v[28:31], v[136:139], v[88:103]
    ds_read_b64_tr_b16 v[28:29], v3 offset:55488
    ds_read_b64_tr_b16 v[30:31], v3 offset:58560
    s_waitcnt lgkmcnt(11)
    v_mfma_f32_32x32x16_bf16 v[104:119], v[32:35], v[136:139], v[104:119]
    ds_read_b64_tr_b16 v[32:33], v2 offset:55552
    ds_read_b64_tr_b16 v[34:35], v2 offset:58624
    s_waitcnt lgkmcnt(11)
    v_mfma_f32_32x32x16_bf16 v[120:135], v[36:39], v[136:139], v[120:135]
    ds_read_b64_tr_b16 v[36:37], v3 offset:55616
    ds_read_b64_tr_b16 v[38:39], v3 offset:58688
    s_waitcnt lgkmcnt(12)
    s_waitcnt lgkmcnt(10)
    v_mfma_f32_32x32x16_bf16 v[40:55], v[16:19], v[140:143], v[40:55]
    s_barrier
    v_add_u32 v2, 73728, v2
    v_add_u32 v3, 73728, v3
    ds_read_b128 v[136:139], v10 offset:16384
    ds_read_b64_tr_b16 v[16:17], v2 offset:0
    ds_read_b64_tr_b16 v[18:19], v2 offset:3072
    s_waitcnt lgkmcnt(11)
    v_mfma_f32_32x32x16_bf16 v[56:71], v[20:23], v[140:143], v[56:71]
    ds_read_b64_tr_b16 v[20:21], v3 offset:64
    ds_read_b64_tr_b16 v[22:23], v3 offset:3136
    s_waitcnt lgkmcnt(11)
    v_mfma_f32_32x32x16_bf16 v[72:87], v[24:27], v[140:143], v[72:87]
    ds_read_b64_tr_b16 v[24:25], v2 offset:128
    ds_read_b64_tr_b16 v[26:27], v2 offset:3200
    s_waitcnt lgkmcnt(11)
    v_mfma_f32_32x32x16_bf16 v[88:103], v[28:31], v[140:143], v[88:103]
    ds_read_b64_tr_b16 v[28:29], v3 offset:192
    ds_read_b64_tr_b16 v[30:31], v3 offset:3264
    s_waitcnt lgkmcnt(11)
    v_mfma_f32_32x32x16_bf16 v[104:119], v[32:35], v[140:143], v[104:119]
    ds_read_b64_tr_b16 v[32:33], v2 offset:256
    ds_read_b64_tr_b16 v[34:35], v2 offset:3328
    s_waitcnt lgkmcnt(11)
    v_mfma_f32_32x32x16_bf16 v[120:135], v[36:39], v[140:143], v[120:135]
    ds_read_b64_tr_b16 v[36:37], v3 offset:320
    ds_read_b64_tr_b16 v[38:39], v3 offset:3392
    ds_read_b128 v[140:143], v11 offset:16384
    s_waitcnt lgkmcnt(13)
    s_waitcnt lgkmcnt(11)
    v_mfma_f32_32x32x16_bf16 v[40:55], v[16:19], v[136:139], v[40:55]
    ds_read_b64_tr_b16 v[16:17], v2 offset:6144
    ds_read_b64_tr_b16 v[18:19], v2 offset:9216
    s_waitcnt lgkmcnt(11)
    v_mfma_f32_32x32x16_bf16 v[56:71], v[20:23], v[136:139], v[56:71]
    ds_read_b64_tr_b16 v[20:21], v3 offset:6208
    ds_read_b64_tr_b16 v[22:23], v3 offset:9280
    s_waitcnt lgkmcnt(11)
    v_mfma_f32_32x32x16_bf16 v[72:87], v[24:27], v[136:139], v[72:87]
    ds_read_b64_tr_b16 v[24:25], v2 offset:6272
    ds_read_b64_tr_b16 v[26:27], v2 offset:9344
    s_waitcnt lgkmcnt(11)
    v_mfma_f32_32x32x16_bf16 v[88:103], v[28:31], v[136:139], v[88:103]
    ds_read_b64_tr_b16 v[28:29], v3 offset:6336
    ds_read_b64_tr_b16 v[30:31], v3 offset:9408
    s_waitcnt lgkmcnt(11)
    v_mfma_f32_32x32x16_bf16 v[104:119], v[32:35], v[136:139], v[104:119]
    ds_read_b64_tr_b16 v[32:33], v2 offset:6400
    ds_read_b64_tr_b16 v[34:35], v2 offset:9472
    s_waitcnt lgkmcnt(11)
    v_mfma_f32_32x32x16_bf16 v[120:135], v[36:39], v[136:139], v[120:135]
    ds_read_b64_tr_b16 v[36:37], v3 offset:6464
    ds_read_b64_tr_b16 v[38:39], v3 offset:9536
    s_waitcnt lgkmcnt(12)
    s_waitcnt lgkmcnt(10)
    v_mfma_f32_32x32x16_bf16 v[40:55], v[16:19], v[140:143], v[40:55]
    s_barrier
    ds_read_b128 v[136:139], v8 offset:0
    ds_read_b64_tr_b16 v[16:17], v2 offset:24576
    ds_read_b64_tr_b16 v[18:19], v2 offset:27648
    s_waitcnt lgkmcnt(11)
    v_mfma_f32_32x32x16_bf16 v[56:71], v[20:23], v[140:143], v[56:71]
    ds_read_b64_tr_b16 v[20:21], v3 offset:24640
    ds_read_b64_tr_b16 v[22:23], v3 offset:27712
    s_waitcnt lgkmcnt(11)
    v_mfma_f32_32x32x16_bf16 v[72:87], v[24:27], v[140:143], v[72:87]
    ds_read_b64_tr_b16 v[24:25], v2 offset:24704
    ds_read_b64_tr_b16 v[26:27], v2 offset:27776
    s_waitcnt lgkmcnt(11)
    v_mfma_f32_32x32x16_bf16 v[88:103], v[28:31], v[140:143], v[88:103]
    ds_read_b64_tr_b16 v[28:29], v3 offset:24768
    ds_read_b64_tr_b16 v[30:31], v3 offset:27840
    s_waitcnt lgkmcnt(11)
    v_mfma_f32_32x32x16_bf16 v[104:119], v[32:35], v[140:143], v[104:119]
    ds_read_b64_tr_b16 v[32:33], v2 offset:24832
    ds_read_b64_tr_b16 v[34:35], v2 offset:27904
    s_waitcnt lgkmcnt(11)
    v_mfma_f32_32x32x16_bf16 v[120:135], v[36:39], v[140:143], v[120:135]
    ds_read_b64_tr_b16 v[36:37], v3 offset:24896
    ds_read_b64_tr_b16 v[38:39], v3 offset:27968
    ds_read_b128 v[140:143], v9 offset:0
    s_waitcnt lgkmcnt(13)
    s_waitcnt lgkmcnt(11)
    v_mfma_f32_32x32x16_bf16 v[40:55], v[16:19], v[136:139], v[40:55]
    ds_read_b64_tr_b16 v[16:17], v2 offset:30720
    ds_read_b64_tr_b16 v[18:19], v2 offset:33792
    s_waitcnt lgkmcnt(11)
    v_mfma_f32_32x32x16_bf16 v[56:71], v[20:23], v[136:139], v[56:71]
    ds_read_b64_tr_b16 v[20:21], v3 offset:30784
    ds_read_b64_tr_b16 v[22:23], v3 offset:33856
    s_waitcnt lgkmcnt(11)
    v_mfma_f32_32x32x16_bf16 v[72:87], v[24:27], v[136:139], v[72:87]
    ds_read_b64_tr_b16 v[24:25], v2 offset:30848
    ds_read_b64_tr_b16 v[26:27], v2 offset:33920
    s_waitcnt lgkmcnt(11)
    v_mfma_f32_32x32x16_bf16 v[88:103], v[28:31], v[136:139], v[88:103]
    ds_read_b64_tr_b16 v[28:29], v3 offset:30912
    ds_read_b64_tr_b16 v[30:31], v3 offset:33984
    s_waitcnt lgkmcnt(11)
    v_mfma_f32_32x32x16_bf16 v[104:119], v[32:35], v[136:139], v[104:119]
    ds_read_b64_tr_b16 v[32:33], v2 offset:30976
    ds_read_b64_tr_b16 v[34:35], v2 offset:34048
    s_waitcnt lgkmcnt(11)
    v_mfma_f32_32x32x16_bf16 v[120:135], v[36:39], v[136:139], v[120:135]
    ds_read_b64_tr_b16 v[36:37], v3 offset:31040
    ds_read_b64_tr_b16 v[38:39], v3 offset:34112
    s_waitcnt lgkmcnt(12)
    s_waitcnt lgkmcnt(10)
    v_mfma_f32_32x32x16_bf16 v[40:55], v[16:19], v[140:143], v[40:55]
    s_barrier
    v_add_u32 v2, -73728, v2
    v_add_u32 v3, -73728, v3
    ds_read_b128 v[136:139], v10 offset:0
    ds_read_b64_tr_b16 v[16:17], v2 offset:0
    ds_read_b64_tr_b16 v[18:19], v2 offset:3072
    s_waitcnt lgkmcnt(11)
    v_mfma_f32_32x32x16_bf16 v[56:71], v[20:23], v[140:143], v[56:71]
    ds_read_b64_tr_b16 v[20:21], v3 offset:64
    ds_read_b64_tr_b16 v[22:23], v3 offset:3136
    s_waitcnt lgkmcnt(11)
    v_mfma_f32_32x32x16_bf16 v[72:87], v[24:27], v[140:143], v[72:87]
    ds_read_b64_tr_b16 v[24:25], v2 offset:128
    ds_read_b64_tr_b16 v[26:27], v2 offset:3200
    s_waitcnt lgkmcnt(11)
    v_mfma_f32_32x32x16_bf16 v[88:103], v[28:31], v[140:143], v[88:103]
    ds_read_b64_tr_b16 v[28:29], v3 offset:192
    ds_read_b64_tr_b16 v[30:31], v3 offset:3264
    s_waitcnt lgkmcnt(11)
    v_mfma_f32_32x32x16_bf16 v[104:119], v[32:35], v[140:143], v[104:119]
    ds_read_b64_tr_b16 v[32:33], v2 offset:256
    ds_read_b64_tr_b16 v[34:35], v2 offset:3328
    s_waitcnt lgkmcnt(11)
    v_mfma_f32_32x32x16_bf16 v[120:135], v[36:39], v[140:143], v[120:135]
    ds_read_b64_tr_b16 v[36:37], v3 offset:320
    ds_read_b64_tr_b16 v[38:39], v3 offset:3392
    ds_read_b128 v[140:143], v11 offset:0
    s_waitcnt lgkmcnt(13)
    s_waitcnt lgkmcnt(11)
    v_mfma_f32_32x32x16_bf16 v[40:55], v[16:19], v[136:139], v[40:55]
    ds_read_b64_tr_b16 v[16:17], v2 offset:6144
    ds_read_b64_tr_b16 v[18:19], v2 offset:9216
    s_waitcnt lgkmcnt(11)
    v_mfma_f32_32x32x16_bf16 v[56:71], v[20:23], v[136:139], v[56:71]
    ds_read_b64_tr_b16 v[20:21], v3 offset:6208
    ds_read_b64_tr_b16 v[22:23], v3 offset:9280
    s_waitcnt lgkmcnt(11)
    v_mfma_f32_32x32x16_bf16 v[72:87], v[24:27], v[136:139], v[72:87]
    ds_read_b64_tr_b16 v[24:25], v2 offset:6272
    ds_read_b64_tr_b16 v[26:27], v2 offset:9344
    s_waitcnt lgkmcnt(11)
    v_mfma_f32_32x32x16_bf16 v[88:103], v[28:31], v[136:139], v[88:103]
    ds_read_b64_tr_b16 v[28:29], v3 offset:6336
    ds_read_b64_tr_b16 v[30:31], v3 offset:9408
    s_waitcnt lgkmcnt(11)
    v_mfma_f32_32x32x16_bf16 v[104:119], v[32:35], v[136:139], v[104:119]
    ds_read_b64_tr_b16 v[32:33], v2 offset:6400
    ds_read_b64_tr_b16 v[34:35], v2 offset:9472
    s_waitcnt lgkmcnt(11)
    v_mfma_f32_32x32x16_bf16 v[120:135], v[36:39], v[136:139], v[120:135]
    ds_read_b64_tr_b16 v[36:37], v3 offset:6464
    ds_read_b64_tr_b16 v[38:39], v3 offset:9536
    s_waitcnt lgkmcnt(12)
    s_waitcnt lgkmcnt(10)
    v_mfma_f32_32x32x16_bf16 v[40:55], v[16:19], v[140:143], v[40:55]
    s_barrier
    ds_read_b128 v[136:139], v8 offset:16384
    ds_read_b64_tr_b16 v[16:17], v2 offset:24576
    ds_read_b64_tr_b16 v[18:19], v2 offset:27648
    s_waitcnt lgkmcnt(11)
    v_mfma_f32_32x32x16_bf16 v[56:71], v[20:23], v[140:143], v[56:71]
    ds_read_b64_tr_b16 v[20:21], v3 offset:24640
    ds_read_b64_tr_b16 v[22:23], v3 offset:27712
    s_waitcnt lgkmcnt(11)
    v_mfma_f32_32x32x16_bf16 v[72:87], v[24:27], v[140:143], v[72:87]
    ds_read_b64_tr_b16 v[24:25], v2 offset:24704
    ds_read_b64_tr_b16 v[26:27], v2 offset:27776
    s_waitcnt lgkmcnt(11)
    v_mfma_f32_32x32x16_bf16 v[88:103], v[28:31], v[140:143], v[88:103]
    ds_read_b64_tr_b16 v[28:29], v3 offset:24768
    ds_read_b64_tr_b16 v[30:31], v3 offset:27840
    s_waitcnt lgkmcnt(11)
    v_mfma_f32_32x32x16_bf16 v[104:119], v[32:35], v[140:143], v[104:119]
    ds_read_b64_tr_b16 v[32:33], v2 offset:24832
    ds_read_b64_tr_b16 v[34:35], v2 offset:27904
    s_waitcnt lgkmcnt(11)
    v_mfma_f32_32x32x16_bf16 v[120:135], v[36:39], v[140:143], v[120:135]
    ds_read_b64_tr_b16 v[36:37], v3 offset:24896
    ds_read_b64_tr_b16 v[38:39], v3 offset:27968
    ds_read_b128 v[140:143], v9 offset:16384
    s_waitcnt lgkmcnt(13)
    s_waitcnt lgkmcnt(11)
    v_mfma_f32_32x32x16_bf16 v[40:55], v[16:19], v[136:139], v[40:55]
    ds_read_b64_tr_b16 v[16:17], v2 offset:30720
    ds_read_b64_tr_b16 v[18:19], v2 offset:33792
    s_waitcnt lgkmcnt(11)
    v_mfma_f32_32x32x16_bf16 v[56:71], v[20:23], v[136:139], v[56:71]
    ds_read_b64_tr_b16 v[20:21], v3 offset:30784
    ds_read_b64_tr_b16 v[22:23], v3 offset:33856
    s_waitcnt lgkmcnt(11)
    v_mfma_f32_32x32x16_bf16 v[72:87], v[24:27], v[136:139], v[72:87]
    ds_read_b64_tr_b16 v[24:25], v2 offset:30848
    ds_read_b64_tr_b16 v[26:27], v2 offset:33920
    s_waitcnt lgkmcnt(11)
    v_mfma_f32_32x32x16_bf16 v[88:103], v[28:31], v[136:139], v[88:103]
    ds_read_b64_tr_b16 v[28:29], v3 offset:30912
    ds_read_b64_tr_b16 v[30:31], v3 offset:33984
    s_waitcnt lgkmcnt(11)
    v_mfma_f32_32x32x16_bf16 v[104:119], v[32:35], v[136:139], v[104:119]
    ds_read_b64_tr_b16 v[32:33], v2 offset:30976
    ds_read_b64_tr_b16 v[34:35], v2 offset:34048
    s_waitcnt lgkmcnt(11)
    v_mfma_f32_32x32x16_bf16 v[120:135], v[36:39], v[136:139], v[120:135]
    ds_read_b64_tr_b16 v[36:37], v3 offset:31040
    ds_read_b64_tr_b16 v[38:39], v3 offset:34112
    s_waitcnt lgkmcnt(12)
    s_waitcnt lgkmcnt(10)
    v_mfma_f32_32x32x16_bf16 v[40:55], v[16:19], v[140:143], v[40:55]
    s_barrier
    ds_read_b128 v[136:139], v10 offset:16384
    ds_read_b64_tr_b16 v[16:17], v2 offset:49152
    ds_read_b64_tr_b16 v[18:19], v2 offset:52224
    s_waitcnt lgkmcnt(11)
    v_mfma_f32_32x32x16_bf16 v[56:71], v[20:23], v[140:143], v[56:71]
    ds_read_b64_tr_b16 v[20:21], v3 offset:49216
    ds_read_b64_tr_b16 v[22:23], v3 offset:52288
    s_waitcnt lgkmcnt(11)
    v_mfma_f32_32x32x16_bf16 v[72:87], v[24:27], v[140:143], v[72:87]
    ds_read_b64_tr_b16 v[24:25], v2 offset:49280
    ds_read_b64_tr_b16 v[26:27], v2 offset:52352
    s_waitcnt lgkmcnt(11)
    v_mfma_f32_32x32x16_bf16 v[88:103], v[28:31], v[140:143], v[88:103]
    ds_read_b64_tr_b16 v[28:29], v3 offset:49344
    ds_read_b64_tr_b16 v[30:31], v3 offset:52416
    s_waitcnt lgkmcnt(11)
    v_mfma_f32_32x32x16_bf16 v[104:119], v[32:35], v[140:143], v[104:119]
    ds_read_b64_tr_b16 v[32:33], v2 offset:49408
    ds_read_b64_tr_b16 v[34:35], v2 offset:52480
    s_waitcnt lgkmcnt(11)
    v_mfma_f32_32x32x16_bf16 v[120:135], v[36:39], v[140:143], v[120:135]
    ds_read_b64_tr_b16 v[36:37], v3 offset:49472
    ds_read_b64_tr_b16 v[38:39], v3 offset:52544
    ds_read_b128 v[140:143], v11 offset:16384
    s_waitcnt lgkmcnt(13)
    s_waitcnt lgkmcnt(11)
    v_mfma_f32_32x32x16_bf16 v[40:55], v[16:19], v[136:139], v[40:55]
    ds_read_b64_tr_b16 v[16:17], v2 offset:55296
    ds_read_b64_tr_b16 v[18:19], v2 offset:58368
    s_waitcnt lgkmcnt(11)
    v_mfma_f32_32x32x16_bf16 v[56:71], v[20:23], v[136:139], v[56:71]
    ds_read_b64_tr_b16 v[20:21], v3 offset:55360
    ds_read_b64_tr_b16 v[22:23], v3 offset:58432
    s_waitcnt lgkmcnt(11)
    v_mfma_f32_32x32x16_bf16 v[72:87], v[24:27], v[136:139], v[72:87]
    ds_read_b64_tr_b16 v[24:25], v2 offset:55424
    ds_read_b64_tr_b16 v[26:27], v2 offset:58496
    s_waitcnt lgkmcnt(11)
    v_mfma_f32_32x32x16_bf16 v[88:103], v[28:31], v[136:139], v[88:103]
    ds_read_b64_tr_b16 v[28:29], v3 offset:55488
    ds_read_b64_tr_b16 v[30:31], v3 offset:58560
    s_waitcnt lgkmcnt(11)
    v_mfma_f32_32x32x16_bf16 v[104:119], v[32:35], v[136:139], v[104:119]
    ds_read_b64_tr_b16 v[32:33], v2 offset:55552
    ds_read_b64_tr_b16 v[34:35], v2 offset:58624
    s_waitcnt lgkmcnt(11)
    v_mfma_f32_32x32x16_bf16 v[120:135], v[36:39], v[136:139], v[120:135]
    ds_read_b64_tr_b16 v[36:37], v3 offset:55616
    ds_read_b64_tr_b16 v[38:39], v3 offset:58688
    s_waitcnt lgkmcnt(12)
    s_waitcnt lgkmcnt(10)
    v_mfma_f32_32x32x16_bf16 v[40:55], v[16:19], v[140:143], v[40:55]
    s_barrier
    v_add_u32 v2, 73728, v2
    v_add_u32 v3, 73728, v3
    ds_read_b128 v[136:139], v8 offset:0
    ds_read_b64_tr_b16 v[16:17], v2 offset:0
    ds_read_b64_tr_b16 v[18:19], v2 offset:3072
    s_waitcnt lgkmcnt(11)
    v_mfma_f32_32x32x16_bf16 v[56:71], v[20:23], v[140:143], v[56:71]
    ds_read_b64_tr_b16 v[20:21], v3 offset:64
    ds_read_b64_tr_b16 v[22:23], v3 offset:3136
    s_waitcnt lgkmcnt(11)
    v_mfma_f32_32x32x16_bf16 v[72:87], v[24:27], v[140:143], v[72:87]
    ds_read_b64_tr_b16 v[24:25], v2 offset:128
    ds_read_b64_tr_b16 v[26:27], v2 offset:3200
    s_waitcnt lgkmcnt(11)
    v_mfma_f32_32x32x16_bf16 v[88:103], v[28:31], v[140:143], v[88:103]
    ds_read_b64_tr_b16 v[28:29], v3 offset:192
    ds_read_b64_tr_b16 v[30:31], v3 offset:3264
    s_waitcnt lgkmcnt(11)
    v_mfma_f32_32x32x16_bf16 v[104:119], v[32:35], v[140:143], v[104:119]
    ds_read_b64_tr_b16 v[32:33], v2 offset:256
    ds_read_b64_tr_b16 v[34:35], v2 offset:3328
    s_waitcnt lgkmcnt(11)
    v_mfma_f32_32x32x16_bf16 v[120:135], v[36:39], v[140:143], v[120:135]
    ds_read_b64_tr_b16 v[36:37], v3 offset:320
    ds_read_b64_tr_b16 v[38:39], v3 offset:3392
    ds_read_b128 v[140:143], v9 offset:0
    s_waitcnt lgkmcnt(13)
    s_waitcnt lgkmcnt(11)
    v_mfma_f32_32x32x16_bf16 v[40:55], v[16:19], v[136:139], v[40:55]
    ds_read_b64_tr_b16 v[16:17], v2 offset:6144
    ds_read_b64_tr_b16 v[18:19], v2 offset:9216
    s_waitcnt lgkmcnt(11)
    v_mfma_f32_32x32x16_bf16 v[56:71], v[20:23], v[136:139], v[56:71]
    ds_read_b64_tr_b16 v[20:21], v3 offset:6208
    ds_read_b64_tr_b16 v[22:23], v3 offset:9280
    s_waitcnt lgkmcnt(11)
    v_mfma_f32_32x32x16_bf16 v[72:87], v[24:27], v[136:139], v[72:87]
    ds_read_b64_tr_b16 v[24:25], v2 offset:6272
    ds_read_b64_tr_b16 v[26:27], v2 offset:9344
    s_waitcnt lgkmcnt(11)
    v_mfma_f32_32x32x16_bf16 v[88:103], v[28:31], v[136:139], v[88:103]
    ds_read_b64_tr_b16 v[28:29], v3 offset:6336
    ds_read_b64_tr_b16 v[30:31], v3 offset:9408
    s_waitcnt lgkmcnt(11)
    v_mfma_f32_32x32x16_bf16 v[104:119], v[32:35], v[136:139], v[104:119]
    ds_read_b64_tr_b16 v[32:33], v2 offset:6400
    ds_read_b64_tr_b16 v[34:35], v2 offset:9472
    s_waitcnt lgkmcnt(11)
    v_mfma_f32_32x32x16_bf16 v[120:135], v[36:39], v[136:139], v[120:135]
    ds_read_b64_tr_b16 v[36:37], v3 offset:6464
    ds_read_b64_tr_b16 v[38:39], v3 offset:9536
    s_waitcnt lgkmcnt(12)
    s_waitcnt lgkmcnt(10)
    v_mfma_f32_32x32x16_bf16 v[40:55], v[16:19], v[140:143], v[40:55]
    s_barrier
    ds_read_b128 v[136:139], v10 offset:0
    ds_read_b64_tr_b16 v[16:17], v2 offset:24576
    ds_read_b64_tr_b16 v[18:19], v2 offset:27648
    s_waitcnt lgkmcnt(11)
    v_mfma_f32_32x32x16_bf16 v[56:71], v[20:23], v[140:143], v[56:71]
    ds_read_b64_tr_b16 v[20:21], v3 offset:24640
    ds_read_b64_tr_b16 v[22:23], v3 offset:27712
    s_waitcnt lgkmcnt(11)
    v_mfma_f32_32x32x16_bf16 v[72:87], v[24:27], v[140:143], v[72:87]
    ds_read_b64_tr_b16 v[24:25], v2 offset:24704
    ds_read_b64_tr_b16 v[26:27], v2 offset:27776
    s_waitcnt lgkmcnt(11)
    v_mfma_f32_32x32x16_bf16 v[88:103], v[28:31], v[140:143], v[88:103]
    ds_read_b64_tr_b16 v[28:29], v3 offset:24768
    ds_read_b64_tr_b16 v[30:31], v3 offset:27840
    s_waitcnt lgkmcnt(11)
    v_mfma_f32_32x32x16_bf16 v[104:119], v[32:35], v[140:143], v[104:119]
    ds_read_b64_tr_b16 v[32:33], v2 offset:24832
    ds_read_b64_tr_b16 v[34:35], v2 offset:27904
    s_waitcnt lgkmcnt(11)
    v_mfma_f32_32x32x16_bf16 v[120:135], v[36:39], v[140:143], v[120:135]
    ds_read_b64_tr_b16 v[36:37], v3 offset:24896
    ds_read_b64_tr_b16 v[38:39], v3 offset:27968
    ds_read_b128 v[140:143], v11 offset:0
    s_waitcnt lgkmcnt(13)
    s_waitcnt lgkmcnt(11)
    v_mfma_f32_32x32x16_bf16 v[40:55], v[16:19], v[136:139], v[40:55]
    ds_read_b64_tr_b16 v[16:17], v2 offset:30720
    ds_read_b64_tr_b16 v[18:19], v2 offset:33792
    s_waitcnt lgkmcnt(11)
    v_mfma_f32_32x32x16_bf16 v[56:71], v[20:23], v[136:139], v[56:71]
    ds_read_b64_tr_b16 v[20:21], v3 offset:30784
    ds_read_b64_tr_b16 v[22:23], v3 offset:33856
    s_waitcnt lgkmcnt(11)
    v_mfma_f32_32x32x16_bf16 v[72:87], v[24:27], v[136:139], v[72:87]
    ds_read_b64_tr_b16 v[24:25], v2 offset:30848
    ds_read_b64_tr_b16 v[26:27], v2 offset:33920
    s_waitcnt lgkmcnt(11)
    v_mfma_f32_32x32x16_bf16 v[88:103], v[28:31], v[136:139], v[88:103]
    ds_read_b64_tr_b16 v[28:29], v3 offset:30912
    ds_read_b64_tr_b16 v[30:31], v3 offset:33984
    s_waitcnt lgkmcnt(11)
    v_mfma_f32_32x32x16_bf16 v[104:119], v[32:35], v[136:139], v[104:119]
    ds_read_b64_tr_b16 v[32:33], v2 offset:30976
    ds_read_b64_tr_b16 v[34:35], v2 offset:34048
    s_waitcnt lgkmcnt(11)
    v_mfma_f32_32x32x16_bf16 v[120:135], v[36:39], v[136:139], v[120:135]
    ds_read_b64_tr_b16 v[36:37], v3 offset:31040
    ds_read_b64_tr_b16 v[38:39], v3 offset:34112
    s_waitcnt lgkmcnt(12)
    s_waitcnt lgkmcnt(10)
    v_mfma_f32_32x32x16_bf16 v[40:55], v[16:19], v[140:143], v[40:55]
    s_barrier
    v_add_u32 v2, -73728, v2
    v_add_u32 v3, -73728, v3
    ds_read_b128 v[136:139], v8 offset:16384
    ds_read_b64_tr_b16 v[16:17], v2 offset:0
    ds_read_b64_tr_b16 v[18:19], v2 offset:3072
    s_waitcnt lgkmcnt(11)
    v_mfma_f32_32x32x16_bf16 v[56:71], v[20:23], v[140:143], v[56:71]
    ds_read_b64_tr_b16 v[20:21], v3 offset:64
    ds_read_b64_tr_b16 v[22:23], v3 offset:3136
    s_waitcnt lgkmcnt(11)
    v_mfma_f32_32x32x16_bf16 v[72:87], v[24:27], v[140:143], v[72:87]
    ds_read_b64_tr_b16 v[24:25], v2 offset:128
    ds_read_b64_tr_b16 v[26:27], v2 offset:3200
    s_waitcnt lgkmcnt(11)
    v_mfma_f32_32x32x16_bf16 v[88:103], v[28:31], v[140:143], v[88:103]
    ds_read_b64_tr_b16 v[28:29], v3 offset:192
    ds_read_b64_tr_b16 v[30:31], v3 offset:3264
    s_waitcnt lgkmcnt(11)
    v_mfma_f32_32x32x16_bf16 v[104:119], v[32:35], v[140:143], v[104:119]
    ds_read_b64_tr_b16 v[32:33], v2 offset:256
    ds_read_b64_tr_b16 v[34:35], v2 offset:3328
    s_waitcnt lgkmcnt(11)
    v_mfma_f32_32x32x16_bf16 v[120:135], v[36:39], v[140:143], v[120:135]
    ds_read_b64_tr_b16 v[36:37], v3 offset:320
    ds_read_b64_tr_b16 v[38:39], v3 offset:3392
    ds_read_b128 v[140:143], v9 offset:16384
    s_waitcnt lgkmcnt(13)
    s_waitcnt lgkmcnt(11)
    v_mfma_f32_32x32x16_bf16 v[40:55], v[16:19], v[136:139], v[40:55]
    ds_read_b64_tr_b16 v[16:17], v2 offset:6144
    ds_read_b64_tr_b16 v[18:19], v2 offset:9216
    s_waitcnt lgkmcnt(11)
    v_mfma_f32_32x32x16_bf16 v[56:71], v[20:23], v[136:139], v[56:71]
    ds_read_b64_tr_b16 v[20:21], v3 offset:6208
    ds_read_b64_tr_b16 v[22:23], v3 offset:9280
    s_waitcnt lgkmcnt(11)
    v_mfma_f32_32x32x16_bf16 v[72:87], v[24:27], v[136:139], v[72:87]
    ds_read_b64_tr_b16 v[24:25], v2 offset:6272
    ds_read_b64_tr_b16 v[26:27], v2 offset:9344
    s_waitcnt lgkmcnt(11)
    v_mfma_f32_32x32x16_bf16 v[88:103], v[28:31], v[136:139], v[88:103]
    ds_read_b64_tr_b16 v[28:29], v3 offset:6336
    ds_read_b64_tr_b16 v[30:31], v3 offset:9408
    s_waitcnt lgkmcnt(11)
    v_mfma_f32_32x32x16_bf16 v[104:119], v[32:35], v[136:139], v[104:119]
    ds_read_b64_tr_b16 v[32:33], v2 offset:6400
    ds_read_b64_tr_b16 v[34:35], v2 offset:9472
    s_waitcnt lgkmcnt(11)
    v_mfma_f32_32x32x16_bf16 v[120:135], v[36:39], v[136:139], v[120:135]
    ds_read_b64_tr_b16 v[36:37], v3 offset:6464
    ds_read_b64_tr_b16 v[38:39], v3 offset:9536
    s_waitcnt lgkmcnt(12)
    s_waitcnt lgkmcnt(10)
    v_mfma_f32_32x32x16_bf16 v[40:55], v[16:19], v[140:143], v[40:55]
    s_barrier
    ds_read_b128 v[136:139], v10 offset:16384
    ds_read_b64_tr_b16 v[16:17], v2 offset:24576
    ds_read_b64_tr_b16 v[18:19], v2 offset:27648
    s_waitcnt lgkmcnt(11)
    v_mfma_f32_32x32x16_bf16 v[56:71], v[20:23], v[140:143], v[56:71]
    ds_read_b64_tr_b16 v[20:21], v3 offset:24640
    ds_read_b64_tr_b16 v[22:23], v3 offset:27712
    s_waitcnt lgkmcnt(11)
    v_mfma_f32_32x32x16_bf16 v[72:87], v[24:27], v[140:143], v[72:87]
    ds_read_b64_tr_b16 v[24:25], v2 offset:24704
    ds_read_b64_tr_b16 v[26:27], v2 offset:27776
    s_waitcnt lgkmcnt(11)
    v_mfma_f32_32x32x16_bf16 v[88:103], v[28:31], v[140:143], v[88:103]
    ds_read_b64_tr_b16 v[28:29], v3 offset:24768
    ds_read_b64_tr_b16 v[30:31], v3 offset:27840
    s_waitcnt lgkmcnt(11)
    v_mfma_f32_32x32x16_bf16 v[104:119], v[32:35], v[140:143], v[104:119]
    ds_read_b64_tr_b16 v[32:33], v2 offset:24832
    ds_read_b64_tr_b16 v[34:35], v2 offset:27904
    s_waitcnt lgkmcnt(11)
    v_mfma_f32_32x32x16_bf16 v[120:135], v[36:39], v[140:143], v[120:135]
    ds_read_b64_tr_b16 v[36:37], v3 offset:24896
    ds_read_b64_tr_b16 v[38:39], v3 offset:27968
    ds_read_b128 v[140:143], v11 offset:16384
    s_waitcnt lgkmcnt(13)
    s_waitcnt lgkmcnt(11)
    v_mfma_f32_32x32x16_bf16 v[40:55], v[16:19], v[136:139], v[40:55]
    ds_read_b64_tr_b16 v[16:17], v2 offset:30720
    ds_read_b64_tr_b16 v[18:19], v2 offset:33792
    s_waitcnt lgkmcnt(11)
    v_mfma_f32_32x32x16_bf16 v[56:71], v[20:23], v[136:139], v[56:71]
    ds_read_b64_tr_b16 v[20:21], v3 offset:30784
    ds_read_b64_tr_b16 v[22:23], v3 offset:33856
    s_waitcnt lgkmcnt(11)
    v_mfma_f32_32x32x16_bf16 v[72:87], v[24:27], v[136:139], v[72:87]
    ds_read_b64_tr_b16 v[24:25], v2 offset:30848
    ds_read_b64_tr_b16 v[26:27], v2 offset:33920
    s_waitcnt lgkmcnt(11)
    v_mfma_f32_32x32x16_bf16 v[88:103], v[28:31], v[136:139], v[88:103]
    ds_read_b64_tr_b16 v[28:29], v3 offset:30912
    ds_read_b64_tr_b16 v[30:31], v3 offset:33984
    s_waitcnt lgkmcnt(11)
    v_mfma_f32_32x32x16_bf16 v[104:119], v[32:35], v[136:139], v[104:119]
    ds_read_b64_tr_b16 v[32:33], v2 offset:30976
    ds_read_b64_tr_b16 v[34:35], v2 offset:34048
    s_waitcnt lgkmcnt(11)
    v_mfma_f32_32x32x16_bf16 v[120:135], v[36:39], v[136:139], v[120:135]
    ds_read_b64_tr_b16 v[36:37], v3 offset:31040
    ds_read_b64_tr_b16 v[38:39], v3 offset:34112
    s_waitcnt lgkmcnt(12)
    s_waitcnt lgkmcnt(10)
    v_mfma_f32_32x32x16_bf16 v[40:55], v[16:19], v[140:143], v[40:55]
    s_barrier
    ds_read_b128 v[136:139], v8 offset:0
    ds_read_b64_tr_b16 v[16:17], v2 offset:49152
    ds_read_b64_tr_b16 v[18:19], v2 offset:52224
    s_waitcnt lgkmcnt(11)
    v_mfma_f32_32x32x16_bf16 v[56:71], v[20:23], v[140:143], v[56:71]
    ds_read_b64_tr_b16 v[20:21], v3 offset:49216
    ds_read_b64_tr_b16 v[22:23], v3 offset:52288
    s_waitcnt lgkmcnt(11)
    v_mfma_f32_32x32x16_bf16 v[72:87], v[24:27], v[140:143], v[72:87]
    ds_read_b64_tr_b16 v[24:25], v2 offset:49280
    ds_read_b64_tr_b16 v[26:27], v2 offset:52352
    s_waitcnt lgkmcnt(11)
    v_mfma_f32_32x32x16_bf16 v[88:103], v[28:31], v[140:143], v[88:103]
    ds_read_b64_tr_b16 v[28:29], v3 offset:49344
    ds_read_b64_tr_b16 v[30:31], v3 offset:52416
    s_waitcnt lgkmcnt(11)
    v_mfma_f32_32x32x16_bf16 v[104:119], v[32:35], v[140:143], v[104:119]
    ds_read_b64_tr_b16 v[32:33], v2 offset:49408
    ds_read_b64_tr_b16 v[34:35], v2 offset:52480
    s_waitcnt lgkmcnt(11)
    v_mfma_f32_32x32x16_bf16 v[120:135], v[36:39], v[140:143], v[120:135]
    ds_read_b64_tr_b16 v[36:37], v3 offset:49472
    ds_read_b64_tr_b16 v[38:39], v3 offset:52544
    ds_read_b128 v[140:143], v9 offset:0
    s_waitcnt lgkmcnt(13)
    s_waitcnt lgkmcnt(11)
    v_mfma_f32_32x32x16_bf16 v[40:55], v[16:19], v[136:139], v[40:55]
    ds_read_b64_tr_b16 v[16:17], v2 offset:55296
    ds_read_b64_tr_b16 v[18:19], v2 offset:58368
    s_waitcnt lgkmcnt(11)
    v_mfma_f32_32x32x16_bf16 v[56:71], v[20:23], v[136:139], v[56:71]
    ds_read_b64_tr_b16 v[20:21], v3 offset:55360
    ds_read_b64_tr_b16 v[22:23], v3 offset:58432
    s_waitcnt lgkmcnt(11)
    v_mfma_f32_32x32x16_bf16 v[72:87], v[24:27], v[136:139], v[72:87]
    ds_read_b64_tr_b16 v[24:25], v2 offset:55424
    ds_read_b64_tr_b16 v[26:27], v2 offset:58496
    s_waitcnt lgkmcnt(11)
    v_mfma_f32_32x32x16_bf16 v[88:103], v[28:31], v[136:139], v[88:103]
    ds_read_b64_tr_b16 v[28:29], v3 offset:55488
    ds_read_b64_tr_b16 v[30:31], v3 offset:58560
    s_waitcnt lgkmcnt(11)
    v_mfma_f32_32x32x16_bf16 v[104:119], v[32:35], v[136:139], v[104:119]
    ds_read_b64_tr_b16 v[32:33], v2 offset:55552
    ds_read_b64_tr_b16 v[34:35], v2 offset:58624
    s_waitcnt lgkmcnt(11)
    v_mfma_f32_32x32x16_bf16 v[120:135], v[36:39], v[136:139], v[120:135]
    ds_read_b64_tr_b16 v[36:37], v3 offset:55616
    ds_read_b64_tr_b16 v[38:39], v3 offset:58688
    s_waitcnt lgkmcnt(12)
    s_waitcnt lgkmcnt(10)
    v_mfma_f32_32x32x16_bf16 v[40:55], v[16:19], v[140:143], v[40:55]
    s_barrier
    v_add_u32 v2, 73728, v2
    v_add_u32 v3, 73728, v3
    ds_read_b128 v[136:139], v10 offset:0
    ds_read_b64_tr_b16 v[16:17], v2 offset:0
    ds_read_b64_tr_b16 v[18:19], v2 offset:3072
    s_waitcnt lgkmcnt(11)
    v_mfma_f32_32x32x16_bf16 v[56:71], v[20:23], v[140:143], v[56:71]
    ds_read_b64_tr_b16 v[20:21], v3 offset:64
    ds_read_b64_tr_b16 v[22:23], v3 offset:3136
    s_waitcnt lgkmcnt(11)
    v_mfma_f32_32x32x16_bf16 v[72:87], v[24:27], v[140:143], v[72:87]
    ds_read_b64_tr_b16 v[24:25], v2 offset:128
    ds_read_b64_tr_b16 v[26:27], v2 offset:3200
    s_waitcnt lgkmcnt(11)
    v_mfma_f32_32x32x16_bf16 v[88:103], v[28:31], v[140:143], v[88:103]
    ds_read_b64_tr_b16 v[28:29], v3 offset:192
    ds_read_b64_tr_b16 v[30:31], v3 offset:3264
    s_waitcnt lgkmcnt(11)
    v_mfma_f32_32x32x16_bf16 v[104:119], v[32:35], v[140:143], v[104:119]
    ds_read_b64_tr_b16 v[32:33], v2 offset:256
    ds_read_b64_tr_b16 v[34:35], v2 offset:3328
    s_waitcnt lgkmcnt(11)
    v_mfma_f32_32x32x16_bf16 v[120:135], v[36:39], v[140:143], v[120:135]
    ds_read_b64_tr_b16 v[36:37], v3 offset:320
    ds_read_b64_tr_b16 v[38:39], v3 offset:3392
    ds_read_b128 v[140:143], v11 offset:0
L_tgtF:
    s_waitcnt lgkmcnt(13)
    s_waitcnt lgkmcnt(11)
    v_mfma_f32_32x32x16_bf16 v[40:55], v[16:19], v[136:139], v[40:55]
    ds_read_b64_tr_b16 v[16:17], v2 offset:6144
    ds_read_b64_tr_b16 v[18:19], v2 offset:9216
    s_waitcnt lgkmcnt(11)
    v_mfma_f32_32x32x16_bf16 v[56:71], v[20:23], v[136:139], v[56:71]
    ds_read_b64_tr_b16 v[20:21], v3 offset:6208
    ds_read_b64_tr_b16 v[22:23], v3 offset:9280
    s_waitcnt lgkmcnt(11)
    v_mfma_f32_32x32x16_bf16 v[72:87], v[24:27], v[136:139], v[72:87]
    ds_read_b64_tr_b16 v[24:25], v2 offset:6272
    ds_read_b64_tr_b16 v[26:27], v2 offset:9344
    s_waitcnt lgkmcnt(11)
    v_mfma_f32_32x32x16_bf16 v[88:103], v[28:31], v[136:139], v[88:103]
    ds_read_b64_tr_b16 v[28:29], v3 offset:6336
    ds_read_b64_tr_b16 v[30:31], v3 offset:9408
    s_waitcnt lgkmcnt(11)
    v_mfma_f32_32x32x16_bf16 v[104:119], v[32:35], v[136:139], v[104:119]
    ds_read_b64_tr_b16 v[32:33], v2 offset:6400
    ds_read_b64_tr_b16 v[34:35], v2 offset:9472
    s_waitcnt lgkmcnt(11)
    v_mfma_f32_32x32x16_bf16 v[120:135], v[36:39], v[136:139], v[120:135]
    ds_read_b64_tr_b16 v[36:37], v3 offset:6464
    ds_read_b64_tr_b16 v[38:39], v3 offset:9536
    s_waitcnt lgkmcnt(12)
    s_waitcnt lgkmcnt(10)
    v_mfma_f32_32x32x16_bf16 v[40:55], v[16:19], v[140:143], v[40:55]
    s_barrier
    ds_read_b128 v[136:139], v8 offset:16384
    ds_read_b64_tr_b16 v[16:17], v2 offset:24576
    ds_read_b64_tr_b16 v[18:19], v2 offset:27648
    v_mov_b32 v166, 157440
    ds_read_b32 v167, v166
    v_bfe_u32 v5, v1, 4, 5
    v_lshrrev_b32 v4, 9, v1
    v_mul_u32_u24 v4, 3072, v4
    s_waitcnt lgkmcnt(12)
    v_mfma_f32_32x32x16_bf16 v[56:71], v[20:23], v[140:143], v[56:71]
    ds_read_b64_tr_b16 v[20:21], v3 offset:24640
    ds_read_b64_tr_b16 v[22:23], v3 offset:27712
    v_lshl_add_u32 v4, v5, 2, v4
    s_mul_i32 s34, s33, 768
    s_add_u32 s34, s34, 157696
    v_add_u32 v4, s34, v4
    s_lshl_b32 s34, s32, 8
    s_waitcnt lgkmcnt(12)
    v_mfma_f32_32x32x16_bf16 v[72:87], v[24:27], v[140:143], v[72:87]
    ds_read_b64_tr_b16 v[24:25], v2 offset:24704
    ds_read_b64_tr_b16 v[26:27], v2 offset:27776
    s_add_u32 s34, s34, 155648
    v_lshlrev_b32 v6, 3, v5
    v_add_u32 v6, s34, v6
    ds_read_b64 v[146:147], v6
    v_mov_b32 v165, v4
    s_waitcnt lgkmcnt(13)
    v_mfma_f32_32x32x16_bf16 v[88:103], v[28:31], v[140:143], v[88:103]
    ds_read_b64_tr_b16 v[28:29], v3 offset:24768
    ds_read_b64_tr_b16 v[30:31], v3 offset:27840
    s_mul_i32 s34, s33, 384
    s_add_u32 s34, s34, 156672
    v_lshlrev_b32 v5, 1, v5
    v_add_u32 v164, s34, v5
    s_waitcnt lgkmcnt(2)
    v_mfma_f32_32x32x16_bf16 v[104:119], v[32:35], v[140:143], v[104:119]
    ds_read_b64_tr_b16 v[32:33], v2 offset:24832
    ds_read_b64_tr_b16 v[34:35], v2 offset:27904
    v_rsq_f32 v145, v147
    v_xor_b32 v4, 0x80000000, v146
    v_mul_f32 v5, v147, v145
    v_and_b32 v144, s52, v4
    v_sub_f32 v6, v4, v144
    v_mfma_f32_32x32x16_bf16 v[120:135], v[36:39], v[140:143], v[120:135]
    ds_read_b64_tr_b16 v[36:37], v3 offset:24896
    ds_read_b64_tr_b16 v[38:39], v3 offset:27968
    v_and_b32 v144, s52, v6
    v_sub_f32 v7, v6, v144
    v_perm_b32 v160, v6, v4, s50
    v_perm_b32 v161, v7, v4, s50
    v_and_b32 v144, s52, v5
    ds_read_b128 v[140:143], v9 offset:16384
    v_mfma_f32_32x32x16_bf16 v[40:55], v[16:19], v[136:139], v[40:55]
    ds_read_b64_tr_b16 v[16:17], v2 offset:30720
    ds_read_b64_tr_b16 v[18:19], v2 offset:33792
    v_sub_f32 v4, v5, v144
    v_mov_b32 v162, v160
    v_and_b32 v144, s52, v4
    v_sub_f32 v7, v4, v144
    v_perm_b32 v144, v4, v5, s50
    v_mfma_f32_32x32x16_bf16 v[56:71], v[20:23], v[136:139], v[56:71]
    ds_read_b64_tr_b16 v[20:21], v3 offset:30784
    ds_read_b64_tr_b16 v[22:23], v3 offset:33856
    v_lshrrev_b32 v7, 16, v7
    v_cmp_gt_u32 vcc, 512, v1
    s_nop 1
    v_cndmask_b32 v163, v7, v144, vcc
    v_readfirstlane_b32 s46, v167
    s_lshl_b32 s34, s28, 4
    v_mfma_f32_32x32x16_bf16 v[72:87], v[24:27], v[136:139], v[72:87]
    ds_read_b64_tr_b16 v[24:25], v2 offset:30848
    ds_read_b64_tr_b16 v[26:27], v2 offset:33920
    s_add_u32 s34, s34, s48
    s_lshl_b32 s34, s34, 4
    s_add_u32 s34, s34, s31
    s_lshl_b32 s34, s34, 7
    s_add_u32 s84, s34, 33325056
    s_waitcnt lgkmcnt(11)
    v_mfma_f32_32x32x16_bf16 v[88:103], v[28:31], v[136:139], v[88:103]
    ds_read_b64_tr_b16 v[28:29], v3 offset:30912
    ds_read_b64_tr_b16 v[30:31], v3 offset:33984
    s_not_b32 s47, s46
    s_waitcnt lgkmcnt(11)
    v_mfma_f32_32x32x16_bf16 v[104:119], v[32:35], v[136:139], v[104:119]
    ds_read_b64_tr_b16 v[32:33], v2 offset:30976
    ds_read_b64_tr_b16 v[34:35], v2 offset:34048
    s_waitcnt lgkmcnt(11)
    v_mfma_f32_32x32x16_bf16 v[120:135], v[36:39], v[136:139], v[120:135]
    ds_read_b64_tr_b16 v[36:37], v3 offset:31040
    ds_read_b64_tr_b16 v[38:39], v3 offset:34112
    s_waitcnt lgkmcnt(12)
    s_waitcnt lgkmcnt(10)
    v_mfma_f32_32x32x16_bf16 v[40:55], v[16:19], v[140:143], v[40:55]
    s_barrier
    v_add_u32 v2, -73728, v2
    v_add_u32 v3, -73728, v3
    ds_read_b128 v[136:139], v10 offset:16384
    ds_read_b64_tr_b16 v[16:17], v2 offset:0
    ds_read_b64_tr_b16 v[18:19], v2 offset:3072
    s_waitcnt lgkmcnt(11)
    v_mfma_f32_32x32x16_bf16 v[56:71], v[20:23], v[140:143], v[56:71]
    ds_read_b64_tr_b16 v[20:21], v3 offset:64
    ds_read_b64_tr_b16 v[22:23], v3 offset:3136
    s_waitcnt lgkmcnt(11)
    v_mfma_f32_32x32x16_bf16 v[72:87], v[24:27], v[140:143], v[72:87]
    ds_read_b64_tr_b16 v[24:25], v2 offset:128
    ds_read_b64_tr_b16 v[26:27], v2 offset:3200
    s_waitcnt lgkmcnt(11)
    v_mfma_f32_32x32x16_bf16 v[88:103], v[28:31], v[140:143], v[88:103]
    ds_read_b64_tr_b16 v[28:29], v3 offset:192
    ds_read_b64_tr_b16 v[30:31], v3 offset:3264
    s_waitcnt lgkmcnt(11)
    v_mfma_f32_32x32x16_bf16 v[104:119], v[32:35], v[140:143], v[104:119]
    ds_read_b64_tr_b16 v[32:33], v2 offset:256
    ds_read_b64_tr_b16 v[34:35], v2 offset:3328
    s_waitcnt lgkmcnt(11)
    v_mfma_f32_32x32x16_bf16 v[120:135], v[36:39], v[140:143], v[120:135]
    ds_read_b64_tr_b16 v[36:37], v3 offset:320
    ds_read_b64_tr_b16 v[38:39], v3 offset:3392
    ds_read_b128 v[140:143], v11 offset:16384
    s_waitcnt lgkmcnt(13)
    s_waitcnt lgkmcnt(11)
    v_mfma_f32_32x32x16_bf16 v[40:55], v[16:19], v[136:139], v[40:55]
    ds_read_b64_tr_b16 v[16:17], v2 offset:6144
    ds_read_b64_tr_b16 v[18:19], v2 offset:9216
    s_waitcnt lgkmcnt(11)
    v_mfma_f32_32x32x16_bf16 v[56:71], v[20:23], v[136:139], v[56:71]
    ds_read_b64_tr_b16 v[20:21], v3 offset:6208
    ds_read_b64_tr_b16 v[22:23], v3 offset:9280
    s_waitcnt lgkmcnt(11)
    v_mfma_f32_32x32x16_bf16 v[72:87], v[24:27], v[136:139], v[72:87]
    ds_read_b64_tr_b16 v[24:25], v2 offset:6272
    ds_read_b64_tr_b16 v[26:27], v2 offset:9344
    s_waitcnt lgkmcnt(11)
    v_mfma_f32_32x32x16_bf16 v[88:103], v[28:31], v[136:139], v[88:103]
    ds_read_b64_tr_b16 v[28:29], v3 offset:6336
    ds_read_b64_tr_b16 v[30:31], v3 offset:9408
    s_waitcnt lgkmcnt(11)
    v_mfma_f32_32x32x16_bf16 v[104:119], v[32:35], v[136:139], v[104:119]
    ds_read_b64_tr_b16 v[32:33], v2 offset:6400
    ds_read_b64_tr_b16 v[34:35], v2 offset:9472
    s_waitcnt lgkmcnt(11)
    v_mfma_f32_32x32x16_bf16 v[120:135], v[36:39], v[136:139], v[120:135]
    ds_read_b64_tr_b16 v[36:37], v3 offset:6464
    ds_read_b64_tr_b16 v[38:39], v3 offset:9536
    s_waitcnt lgkmcnt(12)
    s_waitcnt lgkmcnt(10)
    v_mfma_f32_32x32x16_bf16 v[40:55], v[16:19], v[140:143], v[40:55]
    s_barrier
    ds_read_b128 v[136:139], v8 offset:0
    ds_read_b32 v148, v165 offset:0
    ds_read_b32 v149, v165 offset:1536
    ds_read_b32 v150, v165 offset:128
    ds_read_b32 v151, v165 offset:1664
    ds_read_b32 v152, v165 offset:256
    ds_read_b32 v153, v165 offset:1792
    ds_read_b32 v154, v165 offset:384
    ds_read_b32 v155, v165 offset:1920
    ds_read_b32 v156, v165 offset:512
    ds_read_b32 v157, v165 offset:2048
    ds_read_b32 v158, v165 offset:640
    ds_read_b32 v159, v165 offset:2176
    ds_read_b64_tr_b16 v[16:17], v2 offset:24576
    ds_read_b64_tr_b16 v[18:19], v2 offset:27648
    s_waitcnt lgkmcnt(2)
    v_add_f32 v148, v148, v149
    v_add_f32 v150, v150, v151
    v_add_f32 v152, v152, v153
    v_add_f32 v154, v154, v155
    v_mfma_f32_32x32x16_bf16 v[56:71], v[20:23], v[140:143], v[56:71]
    ds_read_b64_tr_b16 v[20:21], v3 offset:24640
    ds_read_b64_tr_b16 v[22:23], v3 offset:27712
    v_add_f32 v156, v156, v157
    v_add_f32 v158, v158, v159
    ds_read_u16 v149, v164 offset:0
    ds_read_u16 v151, v164 offset:64
    ds_read_u16 v153, v164 offset:128
    v_mfma_f32_32x32x16_bf16 v[72:87], v[24:27], v[140:143], v[72:87]
    ds_read_b64_tr_b16 v[24:25], v2 offset:24704
    ds_read_b64_tr_b16 v[26:27], v2 offset:27776
    ds_read_u16 v155, v164 offset:192
    ds_read_u16 v157, v164 offset:256
    ds_read_u16 v159, v164 offset:320
    v_and_b32 v4, s52, v148
    v_sub_f32 v5, v148, v4
    v_mfma_f32_32x32x16_bf16 v[88:103], v[28:31], v[140:143], v[88:103]
    ds_read_b64_tr_b16 v[28:29], v3 offset:24768
    ds_read_b64_tr_b16 v[30:31], v3 offset:27840
    v_and_b32 v4, s52, v5
    v_sub_f32 v6, v5, v4
    v_perm_b32 v164, v148, v148, s50
    v_perm_b32 v165, v148, v5, s50
    v_perm_b32 v166, v5, v6, s50
    v_mfma_f32_32x32x16_bf16 v[104:119], v[32:35], v[140:143], v[104:119]
    ds_read_b64_tr_b16 v[32:33], v2 offset:24832
    ds_read_b64_tr_b16 v[34:35], v2 offset:27904
    s_waitcnt lgkmcnt(4)
    v_lshl_or_b32 v167, v149, 16, v149
    s_nop 1
    v_mfma_f32_32x32x16_bf16 v[40:55], v[164:167], v[160:163], v[40:55]
    v_and_b32 v4, s52, v150
    v_sub_f32 v5, v150, v4
    v_mfma_f32_32x32x16_bf16 v[120:135], v[36:39], v[140:143], v[120:135]
    ds_read_b64_tr_b16 v[36:37], v3 offset:24896
    ds_read_b64_tr_b16 v[38:39], v3 offset:27968
    v_and_b32 v4, s52, v5
    v_sub_f32 v6, v5, v4
    v_perm_b32 v164, v150, v150, s50
    v_perm_b32 v165, v150, v5, s50
    v_perm_b32 v166, v5, v6, s50
    ds_read_b128 v[140:143], v9 offset:0
    v_mfma_f32_32x32x16_bf16 v[40:55], v[16:19], v[136:139], v[40:55]
    ds_read_b64_tr_b16 v[16:17], v2 offset:30720
    ds_read_b64_tr_b16 v[18:19], v2 offset:33792
    v_lshl_or_b32 v167, v151, 16, v151
    s_nop 1
    v_mfma_f32_32x32x16_bf16 v[56:71], v[164:167], v[160:163], v[56:71]
    v_and_b32 v4, s52, v152
    v_sub_f32 v5, v152, v4
    v_and_b32 v4, s52, v5
    v_mfma_f32_32x32x16_bf16 v[56:71], v[20:23], v[136:139], v[56:71]
    ds_read_b64_tr_b16 v[20:21], v3 offset:30784
    ds_read_b64_tr_b16 v[22:23], v3 offset:33856
    v_sub_f32 v6, v5, v4
    v_perm_b32 v164, v152, v152, s50
    v_perm_b32 v165, v152, v5, s50
    v_perm_b32 v166, v5, v6, s50
    v_lshl_or_b32 v167, v153, 16, v153
    v_mfma_f32_32x32x16_bf16 v[72:87], v[24:27], v[136:139], v[72:87]
    ds_read_b64_tr_b16 v[24:25], v2 offset:30848
    ds_read_b64_tr_b16 v[26:27], v2 offset:33920
    v_mfma_f32_32x32x16_bf16 v[72:87], v[164:167], v[160:163], v[72:87]
    v_and_b32 v4, s52, v154
    v_sub_f32 v5, v154, v4
    v_and_b32 v4, s52, v5
    v_sub_f32 v6, v5, v4
    s_waitcnt lgkmcnt(11)
    v_mfma_f32_32x32x16_bf16 v[88:103], v[28:31], v[136:139], v[88:103]
    ds_read_b64_tr_b16 v[28:29], v3 offset:30912
    ds_read_b64_tr_b16 v[30:31], v3 offset:33984
    v_perm_b32 v164, v154, v154, s50
    v_perm_b32 v165, v154, v5, s50
    v_perm_b32 v166, v5, v6, s50
    v_lshl_or_b32 v167, v155, 16, v155
    s_nop 1
    v_mfma_f32_32x32x16_bf16 v[88:103], v[164:167], v[160:163], v[88:103]
    s_waitcnt lgkmcnt(11)
    v_mfma_f32_32x32x16_bf16 v[104:119], v[32:35], v[136:139], v[104:119]
    ds_read_b64_tr_b16 v[32:33], v2 offset:30976
    ds_read_b64_tr_b16 v[34:35], v2 offset:34048
    v_and_b32 v4, s52, v156
    v_sub_f32 v5, v156, v4
    v_and_b32 v4, s52, v5
    v_sub_f32 v6, v5, v4
    v_perm_b32 v164, v156, v156, s50
    s_waitcnt lgkmcnt(11)
    v_mfma_f32_32x32x16_bf16 v[120:135], v[36:39], v[136:139], v[120:135]
    ds_read_b64_tr_b16 v[36:37], v3 offset:31040
    ds_read_b64_tr_b16 v[38:39], v3 offset:34112
    v_perm_b32 v165, v156, v5, s50
    v_perm_b32 v166, v5, v6, s50
    v_lshl_or_b32 v167, v157, 16, v157
    s_nop 1
    v_mfma_f32_32x32x16_bf16 v[104:119], v[164:167], v[160:163], v[104:119]
    v_and_b32 v4, s52, v158
    s_waitcnt lgkmcnt(12)
    s_waitcnt lgkmcnt(10)
    v_mfma_f32_32x32x16_bf16 v[40:55], v[16:19], v[140:143], v[40:55]
    s_barrier
    ds_read_b128 v[136:139], v10 offset:0
    ds_read_b128 v[144:147], v11 offset:0
    ds_read_b64_tr_b16 v[16:17], v2 offset:49152
    ds_read_b64_tr_b16 v[18:19], v2 offset:52224
    v_sub_f32 v5, v158, v4
    v_and_b32 v4, s52, v5
    v_sub_f32 v6, v5, v4
    v_perm_b32 v164, v158, v158, s50
    v_perm_b32 v165, v158, v5, s50
    s_waitcnt lgkmcnt(12)
    v_mfma_f32_32x32x16_bf16 v[56:71], v[20:23], v[140:143], v[56:71]
    ds_read_b64_tr_b16 v[20:21], v2 offset:55296
    ds_read_b64_tr_b16 v[22:23], v2 offset:58368
    v_perm_b32 v166, v5, v6, s50
    v_lshl_or_b32 v167, v159, 16, v159
    s_nop 1
    v_mfma_f32_32x32x16_bf16 v[120:135], v[164:167], v[160:163], v[120:135]
    v_lshrrev_b32 v4, 9, v1
    v_bfe_u32 v5, v1, 6, 2
    s_waitcnt lgkmcnt(12)
    v_mfma_f32_32x32x16_bf16 v[72:87], v[24:27], v[140:143], v[72:87]
    ds_read_b64_tr_b16 v[24:25], v3 offset:49216
    ds_read_b64_tr_b16 v[26:27], v3 offset:52288
    v_lshl_add_u32 v4, v4, 2, v5
    v_mul_u32_u24 v4, 128, v4
    v_bfe_u32 v6, v1, 8, 1
    v_lshl_add_u32 v4, v6, 5, v4
    v_bfe_u32 v6, v1, 4, 2
    s_waitcnt lgkmcnt(12)
    v_mfma_f32_32x32x16_bf16 v[88:103], v[28:31], v[140:143], v[88:103]
    ds_read_b64_tr_b16 v[28:29], v3 offset:55360
    ds_read_b64_tr_b16 v[30:31], v3 offset:58432
    v_lshl_add_u32 v4, v6, 3, v4
    v_bfe_u32 v5, v1, 7, 1
    v_lshlrev_b32 v5, 6, v5
    s_lshl_b32 s34, s33, 6
    v_xor_b32 v5, s34, v5
    s_waitcnt lgkmcnt(12)
    v_mfma_f32_32x32x16_bf16 v[104:119], v[32:35], v[140:143], v[104:119]
    ds_read_b64_tr_b16 v[32:33], v2 offset:49280
    ds_read_b64_tr_b16 v[34:35], v2 offset:52352
    s_mul_i32 s36, s33, 12288
    s_sub_u32 s35, 12288, s36
    v_add3_u32 v8, v4, v5, s36
    v_add3_u32 v9, v4, v5, s35
    s_waitcnt lgkmcnt(12)
    v_mfma_f32_32x32x16_bf16 v[120:135], v[36:39], v[140:143], v[120:135]
    ds_read_b64_tr_b16 v[36:37], v2 offset:55424
    ds_read_b64_tr_b16 v[38:39], v2 offset:58496
    s_waitcnt lgkmcnt(13)
    s_waitcnt lgkmcnt(10)
    v_mfma_f32_32x32x16_bf16 v[40:55], v[16:19], v[136:139], v[40:55]
    ds_read_b64_tr_b16 v[16:17], v3 offset:49344
    ds_read_b64_tr_b16 v[18:19], v3 offset:52416
    s_waitcnt lgkmcnt(10)
    v_mfma_f32_32x32x16_bf16 v[40:55], v[20:23], v[144:147], v[40:55]
    ds_read_b64_tr_b16 v[20:21], v3 offset:55488
    ds_read_b64_tr_b16 v[22:23], v3 offset:58560
    s_waitcnt lgkmcnt(10)
    v_mfma_f32_32x32x16_bf16 v[56:71], v[24:27], v[136:139], v[56:71]
    ds_read_b64_tr_b16 v[24:25], v2 offset:49408
    ds_read_b64_tr_b16 v[26:27], v2 offset:52480
    s_waitcnt lgkmcnt(10)
    v_mfma_f32_32x32x16_bf16 v[56:71], v[28:31], v[144:147], v[56:71]
    ds_read_b64_tr_b16 v[28:29], v2 offset:55552
    ds_read_b64_tr_b16 v[30:31], v2 offset:58624
    s_nop 1
    v_max_f32 v40, 0, v40
    v_max_f32 v41, 0, v41
    v_max_f32 v42, 0, v42
    v_max_f32 v43, 0, v43
    v_mul_f32 v40, v40, v40
    v_mul_f32 v41, v41, v41
    v_mul_f32 v42, v42, v42
    v_mul_f32 v43, v43, v43
    s_waitcnt lgkmcnt(10)
    v_mfma_f32_32x32x16_bf16 v[72:87], v[32:35], v[136:139], v[72:87]
    ds_read_b64_tr_b16 v[32:33], v3 offset:49472
    ds_read_b64_tr_b16 v[34:35], v3 offset:52544
    v_cvt_pk_bf16_f32 v40, v40, v41
    v_cvt_pk_bf16_f32 v41, v42, v43
    v_max_f32 v44, 0, v44
    v_max_f32 v45, 0, v45
    v_max_f32 v46, 0, v46
    v_max_f32 v47, 0, v47
    v_mul_f32 v44, v44, v44
    v_mul_f32 v45, v45, v45
    s_waitcnt lgkmcnt(10)
    v_mfma_f32_32x32x16_bf16 v[72:87], v[36:39], v[144:147], v[72:87]
    ds_read_b64_tr_b16 v[36:37], v3 offset:55616
    ds_read_b64_tr_b16 v[38:39], v3 offset:58688
    v_mul_f32 v46, v46, v46
    v_mul_f32 v47, v47, v47
    v_cvt_pk_bf16_f32 v42, v44, v45
    v_cvt_pk_bf16_f32 v43, v46, v47
    v_max_f32 v48, 0, v48
    v_max_f32 v49, 0, v49
    v_max_f32 v50, 0, v50
    v_max_f32 v51, 0, v51
    s_waitcnt lgkmcnt(10)
    v_mfma_f32_32x32x16_bf16 v[88:103], v[16:19], v[136:139], v[88:103]
    s_barrier
    v_add_u32 v8, 49152, v8
    v_add_u32 v9, 49152, v9
    ds_read_b64_tr_b16 v[16:17], v8 offset:24576
    ds_read_b64_tr_b16 v[18:19], v8 offset:25600
    v_mul_f32 v48, v48, v48
    v_mul_f32 v49, v49, v49
    v_mul_f32 v50, v50, v50
    v_mul_f32 v51, v51, v51
    v_cvt_pk_bf16_f32 v44, v48, v49
    v_cvt_pk_bf16_f32 v45, v50, v51
    v_max_f32 v52, 0, v52
    v_max_f32 v53, 0, v53
    s_waitcnt lgkmcnt(10)
    v_mfma_f32_32x32x16_bf16 v[88:103], v[20:23], v[144:147], v[88:103]
    ds_read_b64_tr_b16 v[20:21], v8 offset:26624
    ds_read_b64_tr_b16 v[22:23], v8 offset:27648
    v_max_f32 v54, 0, v54
    v_max_f32 v55, 0, v55
    v_mul_f32 v52, v52, v52
    v_mul_f32 v53, v53, v53
    v_mul_f32 v54, v54, v54
    v_mul_f32 v55, v55, v55
    v_cvt_pk_bf16_f32 v46, v52, v53
    v_cvt_pk_bf16_f32 v47, v54, v55
    s_waitcnt lgkmcnt(10)
    v_mfma_f32_32x32x16_bf16 v[104:119], v[24:27], v[136:139], v[104:119]
    ds_read_b64_tr_b16 v[24:25], v8 offset:28672
    ds_read_b64_tr_b16 v[26:27], v8 offset:29696
    ds_write_b128 v12, v[40:43] offset:0
    ds_write_b128 v12, v[44:47] offset:1024
    v_max_f32 v56, 0, v56
    v_max_f32 v57, 0, v57
    v_max_f32 v58, 0, v58
    v_max_f32 v59, 0, v59
    v_mul_f32 v56, v56, v56
    v_mul_f32 v57, v57, v57
    s_waitcnt lgkmcnt(12)
    v_mfma_f32_32x32x16_bf16 v[104:119], v[28:31], v[144:147], v[104:119]
    ds_read_b64_tr_b16 v[28:29], v8 offset:30720
    ds_read_b64_tr_b16 v[30:31], v8 offset:31744
    v_mul_f32 v58, v58, v58
    v_mul_f32 v59, v59, v59
    v_cvt_pk_bf16_f32 v56, v56, v57
    v_cvt_pk_bf16_f32 v57, v58, v59
    v_max_f32 v60, 0, v60
    v_max_f32 v61, 0, v61
    v_max_f32 v62, 0, v62
    v_max_f32 v63, 0, v63
    s_waitcnt lgkmcnt(12)
    v_mfma_f32_32x32x16_bf16 v[120:135], v[32:35], v[136:139], v[120:135]
    ds_read_b64_tr_b16 v[32:33], v8 offset:32768
    ds_read_b64_tr_b16 v[34:35], v8 offset:33792
    v_mul_f32 v60, v60, v60
    v_mul_f32 v61, v61, v61
    v_mul_f32 v62, v62, v62
    v_mul_f32 v63, v63, v63
    v_cvt_pk_bf16_f32 v58, v60, v61
    v_cvt_pk_bf16_f32 v59, v62, v63
    v_max_f32 v64, 0, v64
    v_max_f32 v65, 0, v65
    s_waitcnt lgkmcnt(12)
    v_mfma_f32_32x32x16_bf16 v[120:135], v[36:39], v[144:147], v[120:135]
    ds_read_b64_tr_b16 v[36:37], v8 offset:34816
    ds_read_b64_tr_b16 v[38:39], v8 offset:35840
    v_max_f32 v66, 0, v66
    v_max_f32 v67, 0, v67
    v_mul_f32 v64, v64, v64
    v_mul_f32 v65, v65, v65
    v_mul_f32 v66, v66, v66
    v_mul_f32 v67, v67, v67
    v_cvt_pk_bf16_f32 v60, v64, v65
    v_cvt_pk_bf16_f32 v61, v66, v67
    s_waitcnt lgkmcnt(12)
    v_mfma_f32_32x32x16_bf16 v[136:151], v[16:19], v[40:43], 0
    ds_read_b64_tr_b16 v[16:17], v9 offset:24576
    ds_read_b64_tr_b16 v[18:19], v9 offset:25600
    v_max_f32 v68, 0, v68
    v_max_f32 v69, 0, v69
    v_max_f32 v70, 0, v70
    v_max_f32 v71, 0, v71
    v_mul_f32 v68, v68, v68
    v_mul_f32 v69, v69, v69
    v_mul_f32 v70, v70, v70
    v_mul_f32 v71, v71, v71
    s_waitcnt lgkmcnt(12)
    v_mfma_f32_32x32x16_bf16 v[136:151], v[20:23], v[44:47], v[136:151]
    ds_read_b64_tr_b16 v[20:21], v9 offset:26624
    ds_read_b64_tr_b16 v[22:23], v9 offset:27648
    v_cvt_pk_bf16_f32 v62, v68, v69
    v_cvt_pk_bf16_f32 v63, v70, v71
    ds_write_b128 v12, v[56:59] offset:16384
    ds_write_b128 v12, v[60:63] offset:17408
    v_max_f32 v72, 0, v72
    v_max_f32 v73, 0, v73
    v_max_f32 v74, 0, v74
    v_max_f32 v75, 0, v75
    s_waitcnt lgkmcnt(14)
    v_mfma_f32_32x32x16_bf16 v[136:151], v[24:27], v[56:59], v[136:151]
    ds_read_b64_tr_b16 v[24:25], v9 offset:28672
    ds_read_b64_tr_b16 v[26:27], v9 offset:29696
    v_mul_f32 v72, v72, v72
    v_mul_f32 v73, v73, v73
    v_mul_f32 v74, v74, v74
    v_mul_f32 v75, v75, v75
    v_cvt_pk_bf16_f32 v72, v72, v73
    v_cvt_pk_bf16_f32 v73, v74, v75
    v_max_f32 v76, 0, v76
    v_max_f32 v77, 0, v77
    s_waitcnt lgkmcnt(12)
    v_mfma_f32_32x32x16_bf16 v[136:151], v[28:31], v[60:63], v[136:151]
    ds_read_b64_tr_b16 v[28:29], v9 offset:30720
    ds_read_b64_tr_b16 v[30:31], v9 offset:31744
    v_max_f32 v78, 0, v78
    v_max_f32 v79, 0, v79
    v_mul_f32 v76, v76, v76
    v_mul_f32 v77, v77, v77
    v_mul_f32 v78, v78, v78
    v_mul_f32 v79, v79, v79
    v_cvt_pk_bf16_f32 v74, v76, v77
    v_cvt_pk_bf16_f32 v75, v78, v79
    v_max_f32 v80, 0, v80
    v_max_f32 v81, 0, v81
    v_max_f32 v82, 0, v82
    v_max_f32 v83, 0, v83
    v_mul_f32 v80, v80, v80
    v_mul_f32 v81, v81, v81
    v_mul_f32 v82, v82, v82
    v_mul_f32 v83, v83, v83
    v_cvt_pk_bf16_f32 v76, v80, v81
    v_cvt_pk_bf16_f32 v77, v82, v83
    v_max_f32 v84, 0, v84
    v_max_f32 v85, 0, v85
    v_max_f32 v86, 0, v86
    v_max_f32 v87, 0, v87
    v_mul_f32 v84, v84, v84
    v_mul_f32 v85, v85, v85
    v_mul_f32 v86, v86, v86
    v_mul_f32 v87, v87, v87
    v_cvt_pk_bf16_f32 v78, v84, v85
    v_cvt_pk_bf16_f32 v79, v86, v87
    s_waitcnt lgkmcnt(12)
    v_mfma_f32_32x32x16_bf16 v[136:151], v[32:35], v[72:75], v[136:151]
    ds_read_b64_tr_b16 v[32:33], v9 offset:32768
    ds_read_b64_tr_b16 v[34:35], v9 offset:33792
    ds_write_b128 v14, v[72:75] offset:0
    ds_write_b128 v14, v[76:79] offset:1024
    s_waitcnt lgkmcnt(0)
    s_barrier
    ds_read_b128 v[48:51], v13 offset:0
    ds_read_b128 v[52:55], v13 offset:1024
    ds_read_b128 v[64:67], v13 offset:16384
    ds_read_b128 v[68:71], v13 offset:17408
    ds_read_b128 v[80:83], v15 offset:0
    ds_read_b128 v[84:87], v15 offset:1024
    v_mfma_f32_32x32x16_bf16 v[136:151], v[36:39], v[76:79], v[136:151]
    ds_read_b64_tr_b16 v[36:37], v9 offset:34816
    ds_read_b64_tr_b16 v[38:39], v9 offset:35840
    v_max_f32 v88, 0, v88
    v_max_f32 v89, 0, v89
    v_max_f32 v90, 0, v90
    v_max_f32 v91, 0, v91
    v_mul_f32 v88, v88, v88
    v_mul_f32 v89, v89, v89
    v_mul_f32 v90, v90, v90
    s_waitcnt lgkmcnt(2)
    v_mfma_f32_32x32x16_bf16 v[136:151], v[16:19], v[48:51], v[136:151]
    s_barrier
    v_add_u32 v8, 49152, v8
    v_add_u32 v9, 49152, v9
    ds_read_b64_tr_b16 v[16:17], v8 offset:0
    ds_read_b64_tr_b16 v[18:19], v8 offset:1024
    v_mul_f32 v91, v91, v91
    v_cvt_pk_bf16_f32 v88, v88, v89
    v_cvt_pk_bf16_f32 v89, v90, v91
    v_max_f32 v92, 0, v92
    v_max_f32 v93, 0, v93
    v_max_f32 v94, 0, v94
    v_max_f32 v95, 0, v95
    v_mfma_f32_32x32x16_bf16 v[136:151], v[20:23], v[52:55], v[136:151]
    ds_read_b64_tr_b16 v[20:21], v8 offset:2048
    ds_read_b64_tr_b16 v[22:23], v8 offset:3072
    v_mul_f32 v92, v92, v92
    v_mul_f32 v93, v93, v93
    v_mul_f32 v94, v94, v94
    v_mul_f32 v95, v95, v95
    v_cvt_pk_bf16_f32 v90, v92, v93
    v_cvt_pk_bf16_f32 v91, v94, v95
    v_max_f32 v96, 0, v96
    v_mfma_f32_32x32x16_bf16 v[136:151], v[24:27], v[64:67], v[136:151]
    ds_read_b64_tr_b16 v[24:25], v8 offset:4096
    ds_read_b64_tr_b16 v[26:27], v8 offset:5120
    v_max_f32 v97, 0, v97
    v_max_f32 v98, 0, v98
    v_max_f32 v99, 0, v99
    v_mul_f32 v96, v96, v96
    v_mul_f32 v97, v97, v97
    v_mul_f32 v98, v98, v98
    v_mul_f32 v99, v99, v99
    v_mfma_f32_32x32x16_bf16 v[136:151], v[28:31], v[68:71], v[136:151]
    ds_read_b64_tr_b16 v[28:29], v8 offset:6144
    ds_read_b64_tr_b16 v[30:31], v8 offset:7168
    v_cvt_pk_bf16_f32 v92, v96, v97
    v_cvt_pk_bf16_f32 v93, v98, v99
    v_max_f32 v100, 0, v100
    v_max_f32 v101, 0, v101
    v_max_f32 v102, 0, v102
    v_max_f32 v103, 0, v103
    v_mul_f32 v100, v100, v100
    v_mfma_f32_32x32x16_bf16 v[136:151], v[32:35], v[80:83], v[136:151]
    ds_read_b64_tr_b16 v[32:33], v8 offset:8192
    ds_read_b64_tr_b16 v[34:35], v8 offset:9216
    v_mul_f32 v101, v101, v101
    v_mul_f32 v102, v102, v102
    v_mul_f32 v103, v103, v103
    v_cvt_pk_bf16_f32 v94, v100, v101
    v_cvt_pk_bf16_f32 v95, v102, v103
    ds_write_b128 v12, v[88:91] offset:0
    ds_write_b128 v12, v[92:95] offset:1024
    s_waitcnt lgkmcnt(12)
    v_mfma_f32_32x32x16_bf16 v[136:151], v[36:39], v[84:87], v[136:151]
    ds_read_b64_tr_b16 v[36:37], v8 offset:10240
    ds_read_b64_tr_b16 v[38:39], v8 offset:11264
    v_max_f32 v104, 0, v104
    v_max_f32 v105, 0, v105
    v_max_f32 v106, 0, v106
    v_max_f32 v107, 0, v107
    v_mul_f32 v104, v104, v104
    v_mul_f32 v105, v105, v105
    v_mul_f32 v106, v106, v106
    s_waitcnt lgkmcnt(12)
    v_mfma_f32_32x32x16_bf16 v[152:167], v[16:19], v[40:43], 0
    ds_read_b64_tr_b16 v[16:17], v9 offset:0
    ds_read_b64_tr_b16 v[18:19], v9 offset:1024
    v_mul_f32 v107, v107, v107
    v_cvt_pk_bf16_f32 v104, v104, v105
    v_cvt_pk_bf16_f32 v105, v106, v107
    v_max_f32 v108, 0, v108
    v_max_f32 v109, 0, v109
    v_max_f32 v110, 0, v110
    v_max_f32 v111, 0, v111
    s_waitcnt lgkmcnt(12)
    v_mfma_f32_32x32x16_bf16 v[152:167], v[20:23], v[44:47], v[152:167]
    ds_read_b64_tr_b16 v[20:21], v9 offset:2048
    ds_read_b64_tr_b16 v[22:23], v9 offset:3072
    v_mul_f32 v108, v108, v108
    v_mul_f32 v109, v109, v109
    v_mul_f32 v110, v110, v110
    v_mul_f32 v111, v111, v111
    v_cvt_pk_bf16_f32 v106, v108, v109
    v_cvt_pk_bf16_f32 v107, v110, v111
    v_max_f32 v112, 0, v112
    s_waitcnt lgkmcnt(12)
    v_mfma_f32_32x32x16_bf16 v[152:167], v[24:27], v[56:59], v[152:167]
    ds_read_b64_tr_b16 v[24:25], v9 offset:4096
    ds_read_b64_tr_b16 v[26:27], v9 offset:5120
    v_max_f32 v113, 0, v113
    v_max_f32 v114, 0, v114
    v_max_f32 v115, 0, v115
    v_mul_f32 v112, v112, v112
    v_mul_f32 v113, v113, v113
    v_mul_f32 v114, v114, v114
    v_mul_f32 v115, v115, v115
    s_waitcnt lgkmcnt(12)
    v_mfma_f32_32x32x16_bf16 v[152:167], v[28:31], v[60:63], v[152:167]
    ds_read_b64_tr_b16 v[28:29], v9 offset:6144
    ds_read_b64_tr_b16 v[30:31], v9 offset:7168
    v_cvt_pk_bf16_f32 v108, v112, v113
    v_cvt_pk_bf16_f32 v109, v114, v115
    v_max_f32 v116, 0, v116
    v_max_f32 v117, 0, v117
    v_max_f32 v118, 0, v118
    v_max_f32 v119, 0, v119
    v_mul_f32 v116, v116, v116
    s_waitcnt lgkmcnt(12)
    v_mfma_f32_32x32x16_bf16 v[152:167], v[32:35], v[72:75], v[152:167]
    ds_read_b64_tr_b16 v[32:33], v9 offset:8192
    ds_read_b64_tr_b16 v[34:35], v9 offset:9216
    v_mul_f32 v117, v117, v117
    v_mul_f32 v118, v118, v118
    v_mul_f32 v119, v119, v119
    v_cvt_pk_bf16_f32 v110, v116, v117
    v_cvt_pk_bf16_f32 v111, v118, v119
    ds_write_b128 v12, v[104:107] offset:16384
    ds_write_b128 v12, v[108:111] offset:17408
    s_waitcnt lgkmcnt(12)
    v_mfma_f32_32x32x16_bf16 v[152:167], v[36:39], v[76:79], v[152:167]
    ds_read_b64_tr_b16 v[36:37], v9 offset:10240
    ds_read_b64_tr_b16 v[38:39], v9 offset:11264
    v_max_f32 v120, 0, v120
    v_max_f32 v121, 0, v121
    v_max_f32 v122, 0, v122
    v_max_f32 v123, 0, v123
    v_mul_f32 v120, v120, v120
    v_mul_f32 v121, v121, v121
    v_mul_f32 v122, v122, v122
    s_waitcnt lgkmcnt(12)
    v_mfma_f32_32x32x16_bf16 v[152:167], v[16:19], v[48:51], v[152:167]
    s_barrier
    v_add_u32 v8, -98304, v8
    v_add_u32 v9, -98304, v9
    ds_read_b64_tr_b16 v[16:17], v8 offset:0
    ds_read_b64_tr_b16 v[18:19], v8 offset:1024
    v_mul_f32 v123, v123, v123
    v_cvt_pk_bf16_f32 v120, v120, v121
    v_cvt_pk_bf16_f32 v121, v122, v123
    v_max_f32 v124, 0, v124
    v_max_f32 v125, 0, v125
    v_max_f32 v126, 0, v126
    v_max_f32 v127, 0, v127
    s_waitcnt lgkmcnt(12)
    v_mfma_f32_32x32x16_bf16 v[152:167], v[20:23], v[52:55], v[152:167]
    ds_read_b64_tr_b16 v[20:21], v8 offset:2048
    ds_read_b64_tr_b16 v[22:23], v8 offset:3072
    v_mul_f32 v124, v124, v124
    v_mul_f32 v125, v125, v125
    v_mul_f32 v126, v126, v126
    v_mul_f32 v127, v127, v127
    v_cvt_pk_bf16_f32 v122, v124, v125
    v_cvt_pk_bf16_f32 v123, v126, v127
    v_max_f32 v128, 0, v128
    s_waitcnt lgkmcnt(12)
    v_mfma_f32_32x32x16_bf16 v[152:167], v[24:27], v[64:67], v[152:167]
    ds_read_b64_tr_b16 v[24:25], v8 offset:4096
    ds_read_b64_tr_b16 v[26:27], v8 offset:5120
    v_max_f32 v129, 0, v129
    v_max_f32 v130, 0, v130
    v_max_f32 v131, 0, v131
    v_mul_f32 v128, v128, v128
    v_mul_f32 v129, v129, v129
    v_mul_f32 v130, v130, v130
    v_mul_f32 v131, v131, v131
    s_waitcnt lgkmcnt(12)
    v_mfma_f32_32x32x16_bf16 v[152:167], v[28:31], v[68:71], v[152:167]
    ds_read_b64_tr_b16 v[28:29], v8 offset:6144
    ds_read_b64_tr_b16 v[30:31], v8 offset:7168
    v_cvt_pk_bf16_f32 v124, v128, v129
    v_cvt_pk_bf16_f32 v125, v130, v131
    v_max_f32 v132, 0, v132
    v_max_f32 v133, 0, v133
    v_max_f32 v134, 0, v134
    v_max_f32 v135, 0, v135
    v_mul_f32 v132, v132, v132
    s_waitcnt lgkmcnt(12)
    v_mfma_f32_32x32x16_bf16 v[152:167], v[32:35], v[80:83], v[152:167]
    ds_read_b64_tr_b16 v[32:33], v8 offset:8192
    ds_read_b64_tr_b16 v[34:35], v8 offset:9216
    v_mul_f32 v133, v133, v133
    v_mul_f32 v134, v134, v134
    v_mul_f32 v135, v135, v135
    v_cvt_pk_bf16_f32 v126, v132, v133
    v_cvt_pk_bf16_f32 v127, v134, v135
    ds_write_b128 v14, v[120:123] offset:24576
    ds_write_b128 v14, v[124:127] offset:25600
    s_waitcnt lgkmcnt(12)
    v_mfma_f32_32x32x16_bf16 v[152:167], v[36:39], v[84:87], v[152:167]
    ds_read_b64_tr_b16 v[36:37], v8 offset:10240
    ds_read_b64_tr_b16 v[38:39], v8 offset:11264
    s_waitcnt lgkmcnt(2)
    s_barrier
    ds_read_b128 v[96:99], v13 offset:0
    ds_read_b128 v[100:103], v13 offset:1024
    ds_read_b128 v[112:115], v13 offset:16384
    ds_read_b128 v[116:119], v13 offset:17408
    ds_read_b128 v[128:131], v15 offset:24576
    ds_read_b128 v[132:135], v15 offset:25600
    v_mfma_f32_32x32x16_bf16 v[136:151], v[16:19], v[88:91], v[136:151]
    ds_read_b64_tr_b16 v[16:17], v9 offset:0
    ds_read_b64_tr_b16 v[18:19], v9 offset:1024
    v_mfma_f32_32x32x16_bf16 v[136:151], v[20:23], v[92:95], v[136:151]
    ds_read_b64_tr_b16 v[20:21], v9 offset:2048
    ds_read_b64_tr_b16 v[22:23], v9 offset:3072
    v_mfma_f32_32x32x16_bf16 v[136:151], v[24:27], v[104:107], v[136:151]
    ds_read_b64_tr_b16 v[24:25], v9 offset:4096
    ds_read_b64_tr_b16 v[26:27], v9 offset:5120
    v_mfma_f32_32x32x16_bf16 v[136:151], v[28:31], v[108:111], v[136:151]
    ds_read_b64_tr_b16 v[28:29], v9 offset:6144
    ds_read_b64_tr_b16 v[30:31], v9 offset:7168
    v_mfma_f32_32x32x16_bf16 v[136:151], v[32:35], v[120:123], v[136:151]
    ds_read_b64_tr_b16 v[32:33], v9 offset:8192
    ds_read_b64_tr_b16 v[34:35], v9 offset:9216
    s_waitcnt lgkmcnt(15)
    v_mfma_f32_32x32x16_bf16 v[136:151], v[36:39], v[124:127], v[136:151]
    ds_read_b64_tr_b16 v[36:37], v9 offset:10240
    ds_read_b64_tr_b16 v[38:39], v9 offset:11264
    s_waitcnt lgkmcnt(12)
    s_waitcnt lgkmcnt(10)
    v_mfma_f32_32x32x16_bf16 v[136:151], v[16:19], v[96:99], v[136:151]
    s_barrier
    ds_read_b64_tr_b16 v[16:17], v8 offset:24576
    ds_read_b64_tr_b16 v[18:19], v8 offset:25600
    s_waitcnt lgkmcnt(10)
    v_mfma_f32_32x32x16_bf16 v[136:151], v[20:23], v[100:103], v[136:151]
    ds_read_b64_tr_b16 v[20:21], v8 offset:26624
    ds_read_b64_tr_b16 v[22:23], v8 offset:27648
    s_waitcnt lgkmcnt(10)
    v_mfma_f32_32x32x16_bf16 v[136:151], v[24:27], v[112:115], v[136:151]
    ds_read_b64_tr_b16 v[24:25], v8 offset:28672
    ds_read_b64_tr_b16 v[26:27], v8 offset:29696
    s_waitcnt lgkmcnt(10)
    v_mfma_f32_32x32x16_bf16 v[136:151], v[28:31], v[116:119], v[136:151]
    ds_read_b64_tr_b16 v[28:29], v8 offset:30720
    ds_read_b64_tr_b16 v[30:31], v8 offset:31744
    s_waitcnt lgkmcnt(10)
    v_mfma_f32_32x32x16_bf16 v[136:151], v[32:35], v[128:131], v[136:151]
    ds_read_b64_tr_b16 v[32:33], v8 offset:32768
    ds_read_b64_tr_b16 v[34:35], v8 offset:33792
    s_waitcnt lgkmcnt(10)
    v_mfma_f32_32x32x16_bf16 v[136:151], v[36:39], v[132:135], v[136:151]
    ds_read_b64_tr_b16 v[36:37], v8 offset:34816
    ds_read_b64_tr_b16 v[38:39], v8 offset:35840
    s_waitcnt lgkmcnt(10)
    v_mfma_f32_32x32x16_bf16 v[152:167], v[16:19], v[88:91], v[152:167]
    ds_read_b64_tr_b16 v[16:17], v9 offset:24576
    ds_read_b64_tr_b16 v[18:19], v9 offset:25600
    s_waitcnt lgkmcnt(10)
    v_mfma_f32_32x32x16_bf16 v[152:167], v[20:23], v[92:95], v[152:167]
    ds_read_b64_tr_b16 v[20:21], v9 offset:26624
    ds_read_b64_tr_b16 v[22:23], v9 offset:27648
    s_waitcnt lgkmcnt(10)
    v_mfma_f32_32x32x16_bf16 v[152:167], v[24:27], v[104:107], v[152:167]
    ds_read_b64_tr_b16 v[24:25], v9 offset:28672
    ds_read_b64_tr_b16 v[26:27], v9 offset:29696
    s_add_u32 s37, s56, 0
    v_cvt_pk_bf16_f32 v136, v136, v137
    v_cvt_pk_bf16_f32 v137, v138, v139
    v_cvt_pk_bf16_f32 v138, v140, v141
    v_cvt_pk_bf16_f32 v139, v142, v143
    s_waitcnt lgkmcnt(10)
    v_mfma_f32_32x32x16_bf16 v[152:167], v[28:31], v[108:111], v[152:167]
    ds_read_b64_tr_b16 v[28:29], v9 offset:30720
    ds_read_b64_tr_b16 v[30:31], v9 offset:31744
    buffer_store_dwordx4 v[136:139], v1, s[16:19], s37 offen offset:0 sc1
    v_cvt_pk_bf16_f32 v140, v144, v145
    v_cvt_pk_bf16_f32 v141, v146, v147
    v_cvt_pk_bf16_f32 v142, v148, v149
    v_cvt_pk_bf16_f32 v143, v150, v151
    s_waitcnt lgkmcnt(10)
    v_mfma_f32_32x32x16_bf16 v[152:167], v[32:35], v[120:123], v[152:167]
    ds_read_b64_tr_b16 v[32:33], v9 offset:32768
    ds_read_b64_tr_b16 v[34:35], v9 offset:33792
    buffer_store_dwordx4 v[140:143], v1, s[16:19], s37 offen offset:1024 sc1
    s_waitcnt lgkmcnt(10)
    v_mfma_f32_32x32x16_bf16 v[152:167], v[36:39], v[124:127], v[152:167]
    ds_read_b64_tr_b16 v[36:37], v9 offset:34816
    ds_read_b64_tr_b16 v[38:39], v9 offset:35840
    s_waitcnt lgkmcnt(10)
    v_mfma_f32_32x32x16_bf16 v[152:167], v[16:19], v[96:99], v[152:167]
    s_barrier
    v_add_u32 v8, 49152, v8
    v_add_u32 v9, 49152, v9
    ds_read_b64_tr_b16 v[16:17], v8 offset:0
    ds_read_b64_tr_b16 v[18:19], v8 offset:1024
    s_waitcnt lgkmcnt(10)
    v_mfma_f32_32x32x16_bf16 v[152:167], v[20:23], v[100:103], v[152:167]
    ds_read_b64_tr_b16 v[20:21], v8 offset:2048
    ds_read_b64_tr_b16 v[22:23], v8 offset:3072
    s_waitcnt lgkmcnt(10)
    v_mfma_f32_32x32x16_bf16 v[152:167], v[24:27], v[112:115], v[152:167]
    ds_read_b64_tr_b16 v[24:25], v8 offset:4096
    ds_read_b64_tr_b16 v[26:27], v8 offset:5120
    s_waitcnt lgkmcnt(10)
    v_mfma_f32_32x32x16_bf16 v[152:167], v[28:31], v[116:119], v[152:167]
    ds_read_b64_tr_b16 v[28:29], v8 offset:6144
    ds_read_b64_tr_b16 v[30:31], v8 offset:7168
    s_waitcnt lgkmcnt(10)
    v_mfma_f32_32x32x16_bf16 v[152:167], v[32:35], v[128:131], v[152:167]
    ds_read_b64_tr_b16 v[32:33], v8 offset:8192
    ds_read_b64_tr_b16 v[34:35], v8 offset:9216
    s_waitcnt lgkmcnt(10)
    v_mfma_f32_32x32x16_bf16 v[152:167], v[36:39], v[132:135], v[152:167]
    ds_read_b64_tr_b16 v[36:37], v8 offset:10240
    ds_read_b64_tr_b16 v[38:39], v8 offset:11264
    s_waitcnt lgkmcnt(10)
    v_mfma_f32_32x32x16_bf16 v[136:151], v[16:19], v[40:43], 0
    ds_read_b64_tr_b16 v[16:17], v9 offset:0
    ds_read_b64_tr_b16 v[18:19], v9 offset:1024
    s_waitcnt lgkmcnt(10)
    v_mfma_f32_32x32x16_bf16 v[136:151], v[20:23], v[44:47], v[136:151]
    ds_read_b64_tr_b16 v[20:21], v9 offset:2048
    ds_read_b64_tr_b16 v[22:23], v9 offset:3072
    s_waitcnt lgkmcnt(10)
    v_mfma_f32_32x32x16_bf16 v[136:151], v[24:27], v[56:59], v[136:151]
    ds_read_b64_tr_b16 v[24:25], v9 offset:4096
    ds_read_b64_tr_b16 v[26:27], v9 offset:5120
    s_add_u32 s37, s56, 4096
    v_cvt_pk_bf16_f32 v152, v152, v153
    v_cvt_pk_bf16_f32 v153, v154, v155
    v_cvt_pk_bf16_f32 v154, v156, v157
    v_cvt_pk_bf16_f32 v155, v158, v159
    s_waitcnt lgkmcnt(10)
    v_mfma_f32_32x32x16_bf16 v[136:151], v[28:31], v[60:63], v[136:151]
    ds_read_b64_tr_b16 v[28:29], v9 offset:6144
    ds_read_b64_tr_b16 v[30:31], v9 offset:7168
    buffer_store_dwordx4 v[152:155], v1, s[16:19], s37 offen offset:0 sc1
    v_cvt_pk_bf16_f32 v156, v160, v161
    v_cvt_pk_bf16_f32 v157, v162, v163
    v_cvt_pk_bf16_f32 v158, v164, v165
    v_cvt_pk_bf16_f32 v159, v166, v167
    s_lshl_b32 s34, s32, 10
    s_add_u32 s34, s34, 122880
    v_add_u32 v3, s34, v1
    s_waitcnt lgkmcnt(10)
    v_mfma_f32_32x32x16_bf16 v[136:151], v[32:35], v[72:75], v[136:151]
    ds_read_b64_tr_b16 v[32:33], v9 offset:8192
    ds_read_b64_tr_b16 v[34:35], v9 offset:9216
    buffer_store_dwordx4 v[156:159], v1, s[16:19], s37 offen offset:1024 sc1
    s_waitcnt lgkmcnt(10)
    v_mfma_f32_32x32x16_bf16 v[136:151], v[36:39], v[76:79], v[136:151]
    ds_read_b64_tr_b16 v[36:37], v9 offset:10240
    ds_read_b64_tr_b16 v[38:39], v9 offset:11264
    s_waitcnt lgkmcnt(10)
    v_mfma_f32_32x32x16_bf16 v[136:151], v[16:19], v[48:51], v[136:151]
    s_barrier
    ds_read_b64_tr_b16 v[16:17], v8 offset:24576
    ds_read_b64_tr_b16 v[18:19], v8 offset:25600
    s_waitcnt lgkmcnt(10)
    v_mfma_f32_32x32x16_bf16 v[136:151], v[20:23], v[52:55], v[136:151]
    ds_read_b64_tr_b16 v[20:21], v8 offset:26624
    ds_read_b64_tr_b16 v[22:23], v8 offset:27648
    s_waitcnt lgkmcnt(10)
    v_mfma_f32_32x32x16_bf16 v[136:151], v[24:27], v[64:67], v[136:151]
    ds_read_b64_tr_b16 v[24:25], v8 offset:28672
    ds_read_b64_tr_b16 v[26:27], v8 offset:29696
    s_waitcnt lgkmcnt(10)
    v_mfma_f32_32x32x16_bf16 v[136:151], v[28:31], v[68:71], v[136:151]
    ds_read_b64_tr_b16 v[28:29], v8 offset:30720
    ds_read_b64_tr_b16 v[30:31], v8 offset:31744
    s_waitcnt lgkmcnt(10)
    v_mfma_f32_32x32x16_bf16 v[136:151], v[32:35], v[80:83], v[136:151]
    ds_read_b64_tr_b16 v[32:33], v8 offset:32768
    ds_read_b64_tr_b16 v[34:35], v8 offset:33792
    s_waitcnt lgkmcnt(10)
    v_mfma_f32_32x32x16_bf16 v[136:151], v[36:39], v[84:87], v[136:151]
    ds_read_b64_tr_b16 v[36:37], v8 offset:34816
    ds_read_b64_tr_b16 v[38:39], v8 offset:35840
    s_waitcnt lgkmcnt(10)
    v_mfma_f32_32x32x16_bf16 v[136:151], v[16:19], v[88:91], v[136:151]
    ds_read_b64_tr_b16 v[16:17], v9 offset:24576
    ds_read_b64_tr_b16 v[18:19], v9 offset:25600
    s_waitcnt lgkmcnt(10)
    v_mfma_f32_32x32x16_bf16 v[136:151], v[20:23], v[92:95], v[136:151]
    ds_read_b64_tr_b16 v[20:21], v9 offset:26624
    ds_read_b64_tr_b16 v[22:23], v9 offset:27648
    s_waitcnt lgkmcnt(10)
    v_mfma_f32_32x32x16_bf16 v[136:151], v[24:27], v[104:107], v[136:151]
    ds_read_b64_tr_b16 v[24:25], v9 offset:28672
    ds_read_b64_tr_b16 v[26:27], v9 offset:29696
    s_waitcnt lgkmcnt(10)
    v_mfma_f32_32x32x16_bf16 v[136:151], v[28:31], v[108:111], v[136:151]
    ds_read_b64_tr_b16 v[28:29], v9 offset:30720
    ds_read_b64_tr_b16 v[30:31], v9 offset:31744
    s_waitcnt lgkmcnt(10)
    v_mfma_f32_32x32x16_bf16 v[136:151], v[32:35], v[120:123], v[136:151]
    ds_read_b64_tr_b16 v[32:33], v9 offset:32768
    ds_read_b64_tr_b16 v[34:35], v9 offset:33792
    s_waitcnt lgkmcnt(10)
    v_mfma_f32_32x32x16_bf16 v[136:151], v[36:39], v[124:127], v[136:151]
    ds_read_b64_tr_b16 v[36:37], v9 offset:34816
    ds_read_b64_tr_b16 v[38:39], v9 offset:35840
    s_waitcnt lgkmcnt(10)
    v_mfma_f32_32x32x16_bf16 v[136:151], v[16:19], v[96:99], v[136:151]
    s_barrier
    v_add_u32 v8, 49152, v8
    v_add_u32 v9, 49152, v9
    ds_read_b64_tr_b16 v[16:17], v8 offset:0
    ds_read_b64_tr_b16 v[18:19], v8 offset:1024
    s_waitcnt lgkmcnt(10)
    v_mfma_f32_32x32x16_bf16 v[136:151], v[20:23], v[100:103], v[136:151]
    ds_read_b64_tr_b16 v[20:21], v8 offset:2048
    ds_read_b64_tr_b16 v[22:23], v8 offset:3072
    s_waitcnt lgkmcnt(10)
    v_mfma_f32_32x32x16_bf16 v[136:151], v[24:27], v[112:115], v[136:151]
    ds_read_b64_tr_b16 v[24:25], v8 offset:4096
    ds_read_b64_tr_b16 v[26:27], v8 offset:5120
    s_waitcnt lgkmcnt(10)
    v_mfma_f32_32x32x16_bf16 v[136:151], v[28:31], v[116:119], v[136:151]
    ds_read_b64_tr_b16 v[28:29], v8 offset:6144
    ds_read_b64_tr_b16 v[30:31], v8 offset:7168
    s_waitcnt lgkmcnt(10)
    v_mfma_f32_32x32x16_bf16 v[136:151], v[32:35], v[128:131], v[136:151]
    ds_read_b64_tr_b16 v[32:33], v8 offset:8192
    ds_read_b64_tr_b16 v[34:35], v8 offset:9216
    s_waitcnt lgkmcnt(10)
    v_mfma_f32_32x32x16_bf16 v[136:151], v[36:39], v[132:135], v[136:151]
    ds_read_b64_tr_b16 v[36:37], v8 offset:10240
    ds_read_b64_tr_b16 v[38:39], v8 offset:11264
    s_waitcnt lgkmcnt(10)
    v_mfma_f32_32x32x16_bf16 v[152:167], v[16:19], v[40:43], 0
    ds_read_b64_tr_b16 v[16:17], v9 offset:0
    ds_read_b64_tr_b16 v[18:19], v9 offset:1024
    s_waitcnt lgkmcnt(10)
    v_mfma_f32_32x32x16_bf16 v[152:167], v[20:23], v[44:47], v[152:167]
    ds_read_b64_tr_b16 v[20:21], v9 offset:2048
    ds_read_b64_tr_b16 v[22:23], v9 offset:3072
    s_waitcnt lgkmcnt(10)
    v_mfma_f32_32x32x16_bf16 v[152:167], v[24:27], v[56:59], v[152:167]
    ds_read_b64_tr_b16 v[24:25], v9 offset:4096
    ds_read_b64_tr_b16 v[26:27], v9 offset:5120
    s_add_u32 s37, s56, 8192
    v_cvt_pk_bf16_f32 v136, v136, v137
    v_cvt_pk_bf16_f32 v137, v138, v139
    v_cvt_pk_bf16_f32 v138, v140, v141
    v_cvt_pk_bf16_f32 v139, v142, v143
    s_waitcnt lgkmcnt(10)
    v_mfma_f32_32x32x16_bf16 v[152:167], v[28:31], v[60:63], v[152:167]
    ds_read_b64_tr_b16 v[28:29], v9 offset:6144
    ds_read_b64_tr_b16 v[30:31], v9 offset:7168
    buffer_store_dwordx4 v[136:139], v1, s[16:19], s37 offen offset:0 sc1
    v_cvt_pk_bf16_f32 v140, v144, v145
    v_cvt_pk_bf16_f32 v141, v146, v147
    v_cvt_pk_bf16_f32 v142, v148, v149
    v_cvt_pk_bf16_f32 v143, v150, v151
    s_waitcnt lgkmcnt(10)
    v_mfma_f32_32x32x16_bf16 v[152:167], v[32:35], v[72:75], v[152:167]
    ds_read_b64_tr_b16 v[32:33], v9 offset:8192
    ds_read_b64_tr_b16 v[34:35], v9 offset:9216
    buffer_store_dwordx4 v[140:143], v1, s[16:19], s37 offen offset:1024 sc1
    s_waitcnt lgkmcnt(10)
    v_mfma_f32_32x32x16_bf16 v[152:167], v[36:39], v[76:79], v[152:167]
    ds_read_b64_tr_b16 v[36:37], v9 offset:10240
    ds_read_b64_tr_b16 v[38:39], v9 offset:11264
    s_waitcnt lgkmcnt(10)
    v_mfma_f32_32x32x16_bf16 v[152:167], v[16:19], v[48:51], v[152:167]
    s_barrier
    v_add_u32 v8, -98304, v8
    v_add_u32 v9, -98304, v9
    ds_read_b64_tr_b16 v[16:17], v8 offset:0
    ds_read_b64_tr_b16 v[18:19], v8 offset:1024
    s_waitcnt lgkmcnt(10)
    v_mfma_f32_32x32x16_bf16 v[152:167], v[20:23], v[52:55], v[152:167]
    ds_read_b64_tr_b16 v[20:21], v8 offset:2048
    ds_read_b64_tr_b16 v[22:23], v8 offset:3072
    s_waitcnt lgkmcnt(10)
    v_mfma_f32_32x32x16_bf16 v[152:167], v[24:27], v[64:67], v[152:167]
    ds_read_b64_tr_b16 v[24:25], v8 offset:4096
    ds_read_b64_tr_b16 v[26:27], v8 offset:5120
    s_waitcnt lgkmcnt(10)
    v_mfma_f32_32x32x16_bf16 v[152:167], v[28:31], v[68:71], v[152:167]
    ds_read_b64_tr_b16 v[28:29], v8 offset:6144
    ds_read_b64_tr_b16 v[30:31], v8 offset:7168
    s_waitcnt lgkmcnt(10)
    v_mfma_f32_32x32x16_bf16 v[152:167], v[32:35], v[80:83], v[152:167]
    ds_read_b64_tr_b16 v[32:33], v8 offset:8192
    ds_read_b64_tr_b16 v[34:35], v8 offset:9216
    s_waitcnt lgkmcnt(10)
    v_mfma_f32_32x32x16_bf16 v[152:167], v[36:39], v[84:87], v[152:167]
    ds_read_b64_tr_b16 v[36:37], v8 offset:10240
    ds_read_b64_tr_b16 v[38:39], v8 offset:11264
    s_waitcnt lgkmcnt(10)
    v_mfma_f32_32x32x16_bf16 v[152:167], v[16:19], v[88:91], v[152:167]
    ds_read_b64_tr_b16 v[16:17], v9 offset:0
    ds_read_b64_tr_b16 v[18:19], v9 offset:1024
    s_waitcnt lgkmcnt(10)
    v_mfma_f32_32x32x16_bf16 v[152:167], v[20:23], v[92:95], v[152:167]
    ds_read_b64_tr_b16 v[20:21], v9 offset:2048
    ds_read_b64_tr_b16 v[22:23], v9 offset:3072
    s_waitcnt lgkmcnt(10)
    v_mfma_f32_32x32x16_bf16 v[152:167], v[24:27], v[104:107], v[152:167]
    ds_read_b64_tr_b16 v[24:25], v9 offset:4096
    ds_read_b64_tr_b16 v[26:27], v9 offset:5120
    s_waitcnt lgkmcnt(10)
    v_mfma_f32_32x32x16_bf16 v[152:167], v[28:31], v[108:111], v[152:167]
    ds_read_b64_tr_b16 v[28:29], v9 offset:6144
    ds_read_b64_tr_b16 v[30:31], v9 offset:7168
    s_waitcnt lgkmcnt(10)
    v_mfma_f32_32x32x16_bf16 v[152:167], v[32:35], v[120:123], v[152:167]
    ds_read_b64_tr_b16 v[32:33], v9 offset:8192
    ds_read_b64_tr_b16 v[34:35], v9 offset:9216
    s_waitcnt lgkmcnt(10)
    v_mfma_f32_32x32x16_bf16 v[152:167], v[36:39], v[124:127], v[152:167]
    ds_read_b64_tr_b16 v[36:37], v9 offset:10240
    ds_read_b64_tr_b16 v[38:39], v9 offset:11264
    s_waitcnt lgkmcnt(10)
    v_mfma_f32_32x32x16_bf16 v[152:167], v[16:19], v[96:99], v[152:167]
    s_barrier
    ds_read_b64_tr_b16 v[16:17], v8 offset:24576
    ds_read_b64_tr_b16 v[18:19], v8 offset:25600
    s_waitcnt lgkmcnt(10)
    v_mfma_f32_32x32x16_bf16 v[152:167], v[20:23], v[100:103], v[152:167]
    ds_read_b64_tr_b16 v[20:21], v8 offset:26624
    ds_read_b64_tr_b16 v[22:23], v8 offset:27648
    s_waitcnt lgkmcnt(10)
    v_mfma_f32_32x32x16_bf16 v[152:167], v[24:27], v[112:115], v[152:167]
    ds_read_b64_tr_b16 v[24:25], v8 offset:28672
    ds_read_b64_tr_b16 v[26:27], v8 offset:29696
    s_waitcnt lgkmcnt(10)
    v_mfma_f32_32x32x16_bf16 v[152:167], v[28:31], v[116:119], v[152:167]
    ds_read_b64_tr_b16 v[28:29], v8 offset:30720
    ds_read_b64_tr_b16 v[30:31], v8 offset:31744
    s_waitcnt lgkmcnt(10)
    v_mfma_f32_32x32x16_bf16 v[152:167], v[32:35], v[128:131], v[152:167]
    ds_read_b64_tr_b16 v[32:33], v8 offset:32768
    ds_read_b64_tr_b16 v[34:35], v8 offset:33792
    s_waitcnt lgkmcnt(10)
    v_mfma_f32_32x32x16_bf16 v[152:167], v[36:39], v[132:135], v[152:167]
    ds_read_b64_tr_b16 v[36:37], v8 offset:34816
    ds_read_b64_tr_b16 v[38:39], v8 offset:35840
    s_waitcnt lgkmcnt(10)
    v_mfma_f32_32x32x16_bf16 v[136:151], v[16:19], v[40:43], 0
    ds_read_b64_tr_b16 v[16:17], v9 offset:24576
    ds_read_b64_tr_b16 v[18:19], v9 offset:25600
    s_waitcnt lgkmcnt(10)
    v_mfma_f32_32x32x16_bf16 v[136:151], v[20:23], v[44:47], v[136:151]
    ds_read_b64_tr_b16 v[20:21], v9 offset:26624
    ds_read_b64_tr_b16 v[22:23], v9 offset:27648
    s_waitcnt lgkmcnt(10)
    v_mfma_f32_32x32x16_bf16 v[136:151], v[24:27], v[56:59], v[136:151]
    ds_read_b64_tr_b16 v[24:25], v9 offset:28672
    ds_read_b64_tr_b16 v[26:27], v9 offset:29696
    s_add_u32 s37, s57, 0
    v_cvt_pk_bf16_f32 v152, v152, v153
    v_cvt_pk_bf16_f32 v153, v154, v155
    v_cvt_pk_bf16_f32 v154, v156, v157
    v_cvt_pk_bf16_f32 v155, v158, v159
    s_waitcnt lgkmcnt(10)
    v_mfma_f32_32x32x16_bf16 v[136:151], v[28:31], v[60:63], v[136:151]
    ds_read_b64_tr_b16 v[28:29], v9 offset:30720
    ds_read_b64_tr_b16 v[30:31], v9 offset:31744
    buffer_store_dwordx4 v[152:155], v1, s[16:19], s37 offen offset:0 sc1
    v_cvt_pk_bf16_f32 v156, v160, v161
    v_cvt_pk_bf16_f32 v157, v162, v163
    v_cvt_pk_bf16_f32 v158, v164, v165
    v_cvt_pk_bf16_f32 v159, v166, v167
    s_waitcnt lgkmcnt(10)
    v_mfma_f32_32x32x16_bf16 v[136:151], v[32:35], v[72:75], v[136:151]
    ds_read_b64_tr_b16 v[32:33], v9 offset:32768
    ds_read_b64_tr_b16 v[34:35], v9 offset:33792
    buffer_store_dwordx4 v[156:159], v1, s[16:19], s37 offen offset:1024 sc1
    s_waitcnt lgkmcnt(10)
    v_mfma_f32_32x32x16_bf16 v[136:151], v[36:39], v[76:79], v[136:151]
    ds_read_b64_tr_b16 v[36:37], v9 offset:34816
    ds_read_b64_tr_b16 v[38:39], v9 offset:35840
    s_waitcnt lgkmcnt(10)
    v_mfma_f32_32x32x16_bf16 v[136:151], v[16:19], v[48:51], v[136:151]
    s_waitcnt vmcnt(2)
    s_barrier
    v_add_u32 v8, 49152, v8
    v_add_u32 v9, 49152, v9
    ds_read_b64_tr_b16 v[16:17], v8 offset:0
    ds_read_b64_tr_b16 v[18:19], v8 offset:1024
    s_waitcnt lgkmcnt(10)
    v_mfma_f32_32x32x16_bf16 v[136:151], v[20:23], v[52:55], v[136:151]
    ds_read_b64_tr_b16 v[20:21], v8 offset:2048
    ds_read_b64_tr_b16 v[22:23], v8 offset:3072
    s_waitcnt lgkmcnt(10)
    v_mfma_f32_32x32x16_bf16 v[136:151], v[24:27], v[64:67], v[136:151]
    ds_read_b64_tr_b16 v[24:25], v8 offset:4096
    ds_read_b64_tr_b16 v[26:27], v8 offset:5120
    s_waitcnt lgkmcnt(10)
    v_mfma_f32_32x32x16_bf16 v[136:151], v[28:31], v[68:71], v[136:151]
    ds_read_b64_tr_b16 v[28:29], v8 offset:6144
    ds_read_b64_tr_b16 v[30:31], v8 offset:7168
    s_waitcnt lgkmcnt(10)
    v_mfma_f32_32x32x16_bf16 v[136:151], v[32:35], v[80:83], v[136:151]
    ds_read_b64_tr_b16 v[32:33], v8 offset:8192
    ds_read_b64_tr_b16 v[34:35], v8 offset:9216
    s_waitcnt lgkmcnt(10)
    v_mfma_f32_32x32x16_bf16 v[136:151], v[36:39], v[84:87], v[136:151]
    ds_read_b64_tr_b16 v[36:37], v8 offset:10240
    ds_read_b64_tr_b16 v[38:39], v8 offset:11264
    s_waitcnt lgkmcnt(10)
    v_mfma_f32_32x32x16_bf16 v[136:151], v[16:19], v[88:91], v[136:151]
    ds_read_b64_tr_b16 v[16:17], v9 offset:0
    ds_read_b64_tr_b16 v[18:19], v9 offset:1024
    s_waitcnt lgkmcnt(10)
    v_mfma_f32_32x32x16_bf16 v[136:151], v[20:23], v[92:95], v[136:151]
    ds_read_b64_tr_b16 v[20:21], v9 offset:2048
    ds_read_b64_tr_b16 v[22:23], v9 offset:3072
    s_waitcnt lgkmcnt(10)
    v_mfma_f32_32x32x16_bf16 v[136:151], v[24:27], v[104:107], v[136:151]
    ds_read_b64_tr_b16 v[24:25], v9 offset:4096
    ds_read_b64_tr_b16 v[26:27], v9 offset:5120
    s_waitcnt lgkmcnt(10)
    v_mfma_f32_32x32x16_bf16 v[136:151], v[28:31], v[108:111], v[136:151]
    ds_read_b64_tr_b16 v[28:29], v9 offset:6144
    ds_read_b64_tr_b16 v[30:31], v9 offset:7168
    s_waitcnt lgkmcnt(10)
    v_mfma_f32_32x32x16_bf16 v[136:151], v[32:35], v[120:123], v[136:151]
    ds_read_b64_tr_b16 v[32:33], v9 offset:8192
    ds_read_b64_tr_b16 v[34:35], v9 offset:9216
    s_waitcnt lgkmcnt(10)
    v_mfma_f32_32x32x16_bf16 v[136:151], v[36:39], v[124:127], v[136:151]
    ds_read_b64_tr_b16 v[36:37], v9 offset:10240
    ds_read_b64_tr_b16 v[38:39], v9 offset:11264
    s_waitcnt lgkmcnt(10)
    v_mfma_f32_32x32x16_bf16 v[136:151], v[16:19], v[96:99], v[136:151]
    s_barrier
    ds_read_b64_tr_b16 v[16:17], v8 offset:24576
    ds_read_b64_tr_b16 v[18:19], v8 offset:25600
    s_waitcnt lgkmcnt(10)
    v_mfma_f32_32x32x16_bf16 v[136:151], v[20:23], v[100:103], v[136:151]
    ds_read_b64_tr_b16 v[20:21], v8 offset:26624
    ds_read_b64_tr_b16 v[22:23], v8 offset:27648
    s_waitcnt lgkmcnt(10)
    v_mfma_f32_32x32x16_bf16 v[136:151], v[24:27], v[112:115], v[136:151]
    ds_read_b64_tr_b16 v[24:25], v8 offset:28672
    ds_read_b64_tr_b16 v[26:27], v8 offset:29696
    s_waitcnt lgkmcnt(10)
    v_mfma_f32_32x32x16_bf16 v[136:151], v[28:31], v[116:119], v[136:151]
    ds_read_b64_tr_b16 v[28:29], v8 offset:30720
    ds_read_b64_tr_b16 v[30:31], v8 offset:31744
    s_waitcnt lgkmcnt(10)
    v_mfma_f32_32x32x16_bf16 v[136:151], v[32:35], v[128:131], v[136:151]
    ds_read_b64_tr_b16 v[32:33], v8 offset:32768
    ds_read_b64_tr_b16 v[34:35], v8 offset:33792
    s_waitcnt lgkmcnt(10)
    v_mfma_f32_32x32x16_bf16 v[136:151], v[36:39], v[132:135], v[136:151]
    ds_read_b64_tr_b16 v[36:37], v8 offset:34816
    ds_read_b64_tr_b16 v[38:39], v8 offset:35840
    s_waitcnt lgkmcnt(10)
    v_mfma_f32_32x32x16_bf16 v[152:167], v[16:19], v[40:43], 0
    ds_read_b64_tr_b16 v[16:17], v9 offset:24576
    ds_read_b64_tr_b16 v[18:19], v9 offset:25600
    s_waitcnt lgkmcnt(10)
    v_mfma_f32_32x32x16_bf16 v[152:167], v[20:23], v[44:47], v[152:167]
    ds_read_b64_tr_b16 v[20:21], v9 offset:26624
    ds_read_b64_tr_b16 v[22:23], v9 offset:27648
    s_waitcnt lgkmcnt(10)
    v_mfma_f32_32x32x16_bf16 v[152:167], v[24:27], v[56:59], v[152:167]
    ds_read_b64_tr_b16 v[24:25], v9 offset:28672
    ds_read_b64_tr_b16 v[26:27], v9 offset:29696
    s_add_u32 s37, s57, 4096
    v_cvt_pk_bf16_f32 v136, v136, v137
    v_cvt_pk_bf16_f32 v137, v138, v139
    v_cvt_pk_bf16_f32 v138, v140, v141
    v_cvt_pk_bf16_f32 v139, v142, v143
    s_waitcnt lgkmcnt(10)
    v_mfma_f32_32x32x16_bf16 v[152:167], v[28:31], v[60:63], v[152:167]
    ds_read_b64_tr_b16 v[28:29], v9 offset:30720
    ds_read_b64_tr_b16 v[30:31], v9 offset:31744
    buffer_store_dwordx4 v[136:139], v1, s[16:19], s37 offen offset:0 sc1
    v_cvt_pk_bf16_f32 v140, v144, v145
    v_cvt_pk_bf16_f32 v141, v146, v147
    v_cvt_pk_bf16_f32 v142, v148, v149
    v_cvt_pk_bf16_f32 v143, v150, v151
    s_waitcnt lgkmcnt(10)
    v_mfma_f32_32x32x16_bf16 v[152:167], v[32:35], v[72:75], v[152:167]
    ds_read_b64_tr_b16 v[32:33], v9 offset:32768
    ds_read_b64_tr_b16 v[34:35], v9 offset:33792
    buffer_store_dwordx4 v[140:143], v1, s[16:19], s37 offen offset:1024 sc1
    s_waitcnt lgkmcnt(10)
    v_mfma_f32_32x32x16_bf16 v[152:167], v[36:39], v[76:79], v[152:167]
    ds_read_b64_tr_b16 v[36:37], v9 offset:34816
    ds_read_b64_tr_b16 v[38:39], v9 offset:35840
    s_waitcnt lgkmcnt(10)
    v_mfma_f32_32x32x16_bf16 v[152:167], v[16:19], v[48:51], v[152:167]
    s_barrier
    v_add_u32 v8, 49152, v8
    v_add_u32 v9, 49152, v9
    ds_read_b64_tr_b16 v[16:17], v8 offset:0
    ds_read_b64_tr_b16 v[18:19], v8 offset:1024
    s_waitcnt lgkmcnt(10)
    v_mfma_f32_32x32x16_bf16 v[152:167], v[20:23], v[52:55], v[152:167]
    ds_read_b64_tr_b16 v[20:21], v8 offset:2048
    ds_read_b64_tr_b16 v[22:23], v8 offset:3072
    s_waitcnt lgkmcnt(10)
    v_mfma_f32_32x32x16_bf16 v[152:167], v[24:27], v[64:67], v[152:167]
    ds_read_b64_tr_b16 v[24:25], v8 offset:4096
    ds_read_b64_tr_b16 v[26:27], v8 offset:5120
    s_waitcnt lgkmcnt(10)
    v_mfma_f32_32x32x16_bf16 v[152:167], v[28:31], v[68:71], v[152:167]
    ds_read_b64_tr_b16 v[28:29], v8 offset:6144
    ds_read_b64_tr_b16 v[30:31], v8 offset:7168
    s_waitcnt lgkmcnt(10)
    v_mfma_f32_32x32x16_bf16 v[152:167], v[32:35], v[80:83], v[152:167]
    ds_read_b64_tr_b16 v[32:33], v8 offset:8192
    ds_read_b64_tr_b16 v[34:35], v8 offset:9216
    s_waitcnt lgkmcnt(10)
    v_mfma_f32_32x32x16_bf16 v[152:167], v[36:39], v[84:87], v[152:167]
    ds_read_b64_tr_b16 v[36:37], v8 offset:10240
    ds_read_b64_tr_b16 v[38:39], v8 offset:11264
    s_waitcnt lgkmcnt(10)
    v_mfma_f32_32x32x16_bf16 v[152:167], v[16:19], v[88:91], v[152:167]
    ds_read_b64_tr_b16 v[16:17], v9 offset:0
    ds_read_b64_tr_b16 v[18:19], v9 offset:1024
    s_waitcnt lgkmcnt(10)
    v_mfma_f32_32x32x16_bf16 v[152:167], v[20:23], v[92:95], v[152:167]
    ds_read_b64_tr_b16 v[20:21], v9 offset:2048
    ds_read_b64_tr_b16 v[22:23], v9 offset:3072
    s_waitcnt lgkmcnt(10)
    v_mfma_f32_32x32x16_bf16 v[152:167], v[24:27], v[104:107], v[152:167]
    ds_read_b64_tr_b16 v[24:25], v9 offset:4096
    ds_read_b64_tr_b16 v[26:27], v9 offset:5120
    s_waitcnt lgkmcnt(10)
    v_mfma_f32_32x32x16_bf16 v[152:167], v[28:31], v[108:111], v[152:167]
    ds_read_b64_tr_b16 v[28:29], v9 offset:6144
    ds_read_b64_tr_b16 v[30:31], v9 offset:7168
    s_waitcnt lgkmcnt(10)
    v_mfma_f32_32x32x16_bf16 v[152:167], v[32:35], v[120:123], v[152:167]
    ds_read_b64_tr_b16 v[32:33], v9 offset:8192
    ds_read_b64_tr_b16 v[34:35], v9 offset:9216
    s_waitcnt lgkmcnt(10)
    v_mfma_f32_32x32x16_bf16 v[152:167], v[36:39], v[124:127], v[152:167]
    ds_read_b64_tr_b16 v[36:37], v9 offset:10240
    ds_read_b64_tr_b16 v[38:39], v9 offset:11264
    s_waitcnt lgkmcnt(10)
    v_mfma_f32_32x32x16_bf16 v[152:167], v[16:19], v[96:99], v[152:167]
    s_barrier
    v_add_u32 v8, -98304, v8
    v_add_u32 v9, -98304, v9
    ds_read_b64_tr_b16 v[16:17], v8 offset:0
    ds_read_b64_tr_b16 v[18:19], v8 offset:1024
    s_waitcnt lgkmcnt(10)
    v_mfma_f32_32x32x16_bf16 v[152:167], v[20:23], v[100:103], v[152:167]
    ds_read_b64_tr_b16 v[20:21], v8 offset:2048
    ds_read_b64_tr_b16 v[22:23], v8 offset:3072
    s_waitcnt lgkmcnt(10)
    v_mfma_f32_32x32x16_bf16 v[152:167], v[24:27], v[112:115], v[152:167]
    ds_read_b64_tr_b16 v[24:25], v8 offset:4096
    ds_read_b64_tr_b16 v[26:27], v8 offset:5120
    s_waitcnt lgkmcnt(10)
    v_mfma_f32_32x32x16_bf16 v[152:167], v[28:31], v[116:119], v[152:167]
    ds_read_b64_tr_b16 v[28:29], v8 offset:6144
    ds_read_b64_tr_b16 v[30:31], v8 offset:7168
    s_waitcnt lgkmcnt(10)
    v_mfma_f32_32x32x16_bf16 v[152:167], v[32:35], v[128:131], v[152:167]
    ds_read_b64_tr_b16 v[32:33], v8 offset:8192
    ds_read_b64_tr_b16 v[34:35], v8 offset:9216
    s_waitcnt lgkmcnt(10)
    v_mfma_f32_32x32x16_bf16 v[152:167], v[36:39], v[132:135], v[152:167]
    ds_read_b64_tr_b16 v[36:37], v8 offset:10240
    ds_read_b64_tr_b16 v[38:39], v8 offset:11264
    s_waitcnt lgkmcnt(10)
    v_mfma_f32_32x32x16_bf16 v[136:151], v[16:19], v[40:43], 0
    ds_read_b64_tr_b16 v[16:17], v9 offset:0
    ds_read_b64_tr_b16 v[18:19], v9 offset:1024
    s_waitcnt lgkmcnt(10)
    v_mfma_f32_32x32x16_bf16 v[136:151], v[20:23], v[44:47], v[136:151]
    ds_read_b64_tr_b16 v[20:21], v9 offset:2048
    ds_read_b64_tr_b16 v[22:23], v9 offset:3072
    s_waitcnt lgkmcnt(10)
    v_mfma_f32_32x32x16_bf16 v[136:151], v[24:27], v[56:59], v[136:151]
    ds_read_b64_tr_b16 v[24:25], v9 offset:4096
    ds_read_b64_tr_b16 v[26:27], v9 offset:5120
    s_add_u32 s37, s57, 8192
    v_cvt_pk_bf16_f32 v152, v152, v153
    v_cvt_pk_bf16_f32 v153, v154, v155
    v_cvt_pk_bf16_f32 v154, v156, v157
    v_cvt_pk_bf16_f32 v155, v158, v159
    s_waitcnt lgkmcnt(10)
    v_mfma_f32_32x32x16_bf16 v[136:151], v[28:31], v[60:63], v[136:151]
    ds_read_b64_tr_b16 v[28:29], v9 offset:6144
    ds_read_b64_tr_b16 v[30:31], v9 offset:7168
    buffer_store_dwordx4 v[152:155], v1, s[16:19], s37 offen offset:0 sc1
    v_cvt_pk_bf16_f32 v156, v160, v161
    v_cvt_pk_bf16_f32 v157, v162, v163
    v_cvt_pk_bf16_f32 v158, v164, v165
    v_cvt_pk_bf16_f32 v159, v166, v167
    s_waitcnt lgkmcnt(10)
    v_mfma_f32_32x32x16_bf16 v[136:151], v[32:35], v[72:75], v[136:151]
    ds_read_b64_tr_b16 v[32:33], v9 offset:8192
    ds_read_b64_tr_b16 v[34:35], v9 offset:9216
    buffer_store_dwordx4 v[156:159], v1, s[16:19], s37 offen offset:1024 sc1
    s_waitcnt lgkmcnt(10)
    v_mfma_f32_32x32x16_bf16 v[136:151], v[36:39], v[76:79], v[136:151]
    ds_read_b64_tr_b16 v[36:37], v9 offset:10240
    ds_read_b64_tr_b16 v[38:39], v9 offset:11264
    s_waitcnt lgkmcnt(10)
    v_mfma_f32_32x32x16_bf16 v[136:151], v[16:19], v[48:51], v[136:151]
    s_barrier
    ds_read_b64_tr_b16 v[16:17], v8 offset:24576
    ds_read_b64_tr_b16 v[18:19], v8 offset:25600
    s_waitcnt lgkmcnt(10)
    v_mfma_f32_32x32x16_bf16 v[136:151], v[20:23], v[52:55], v[136:151]
    ds_read_b64_tr_b16 v[20:21], v8 offset:26624
    ds_read_b64_tr_b16 v[22:23], v8 offset:27648
    s_waitcnt lgkmcnt(10)
    v_mfma_f32_32x32x16_bf16 v[136:151], v[24:27], v[64:67], v[136:151]
    ds_read_b64_tr_b16 v[24:25], v8 offset:28672
    ds_read_b64_tr_b16 v[26:27], v8 offset:29696
    s_waitcnt lgkmcnt(10)
    v_mfma_f32_32x32x16_bf16 v[136:151], v[28:31], v[68:71], v[136:151]
    ds_read_b64_tr_b16 v[28:29], v8 offset:30720
    ds_read_b64_tr_b16 v[30:31], v8 offset:31744
    s_waitcnt lgkmcnt(10)
    v_mfma_f32_32x32x16_bf16 v[136:151], v[32:35], v[80:83], v[136:151]
    ds_read_b64_tr_b16 v[32:33], v8 offset:32768
    ds_read_b64_tr_b16 v[34:35], v8 offset:33792
    s_waitcnt lgkmcnt(10)
    v_mfma_f32_32x32x16_bf16 v[136:151], v[36:39], v[84:87], v[136:151]
    ds_read_b64_tr_b16 v[36:37], v8 offset:34816
    ds_read_b64_tr_b16 v[38:39], v8 offset:35840
    s_waitcnt lgkmcnt(10)
    v_mfma_f32_32x32x16_bf16 v[136:151], v[16:19], v[88:91], v[136:151]
    ds_read_b64_tr_b16 v[16:17], v9 offset:24576
    ds_read_b64_tr_b16 v[18:19], v9 offset:25600
    s_waitcnt lgkmcnt(10)
    v_mfma_f32_32x32x16_bf16 v[136:151], v[20:23], v[92:95], v[136:151]
    ds_read_b64_tr_b16 v[20:21], v9 offset:26624
    ds_read_b64_tr_b16 v[22:23], v9 offset:27648
    s_waitcnt lgkmcnt(10)
    v_mfma_f32_32x32x16_bf16 v[136:151], v[24:27], v[104:107], v[136:151]
    ds_read_b64_tr_b16 v[24:25], v9 offset:28672
    ds_read_b64_tr_b16 v[26:27], v9 offset:29696
    s_waitcnt lgkmcnt(10)
    v_mfma_f32_32x32x16_bf16 v[136:151], v[28:31], v[108:111], v[136:151]
    ds_read_b64_tr_b16 v[28:29], v9 offset:30720
    ds_read_b64_tr_b16 v[30:31], v9 offset:31744
    s_waitcnt lgkmcnt(10)
    v_mfma_f32_32x32x16_bf16 v[136:151], v[32:35], v[120:123], v[136:151]
    ds_read_b64_tr_b16 v[32:33], v9 offset:32768
    ds_read_b64_tr_b16 v[34:35], v9 offset:33792
    s_waitcnt lgkmcnt(10)
    v_mfma_f32_32x32x16_bf16 v[136:151], v[36:39], v[124:127], v[136:151]
    ds_read_b64_tr_b16 v[36:37], v9 offset:34816
    ds_read_b64_tr_b16 v[38:39], v9 offset:35840
    s_waitcnt lgkmcnt(10)
    v_mfma_f32_32x32x16_bf16 v[136:151], v[16:19], v[96:99], v[136:151]
    s_barrier
    v_add_u32 v8, 49152, v8
    v_add_u32 v9, 49152, v9
    ds_read_b64_tr_b16 v[16:17], v8 offset:0
    ds_read_b64_tr_b16 v[18:19], v8 offset:1024
    s_waitcnt lgkmcnt(10)
    v_mfma_f32_32x32x16_bf16 v[136:151], v[20:23], v[100:103], v[136:151]
    ds_read_b64_tr_b16 v[20:21], v8 offset:2048
    ds_read_b64_tr_b16 v[22:23], v8 offset:3072
    s_waitcnt lgkmcnt(10)
    v_mfma_f32_32x32x16_bf16 v[136:151], v[24:27], v[112:115], v[136:151]
    ds_read_b64_tr_b16 v[24:25], v8 offset:4096
    ds_read_b64_tr_b16 v[26:27], v8 offset:5120
    s_waitcnt lgkmcnt(10)
    v_mfma_f32_32x32x16_bf16 v[136:151], v[28:31], v[116:119], v[136:151]
    ds_read_b64_tr_b16 v[28:29], v8 offset:6144
    ds_read_b64_tr_b16 v[30:31], v8 offset:7168
    s_waitcnt lgkmcnt(10)
    v_mfma_f32_32x32x16_bf16 v[136:151], v[32:35], v[128:131], v[136:151]
    ds_read_b64_tr_b16 v[32:33], v8 offset:8192
    ds_read_b64_tr_b16 v[34:35], v8 offset:9216
    s_waitcnt lgkmcnt(10)
    v_mfma_f32_32x32x16_bf16 v[136:151], v[36:39], v[132:135], v[136:151]
    ds_read_b64_tr_b16 v[36:37], v8 offset:10240
    ds_read_b64_tr_b16 v[38:39], v8 offset:11264
    s_waitcnt lgkmcnt(10)
    v_mfma_f32_32x32x16_bf16 v[152:167], v[16:19], v[40:43], 0
    ds_read_b64_tr_b16 v[16:17], v9 offset:0
    ds_read_b64_tr_b16 v[18:19], v9 offset:1024
    s_waitcnt lgkmcnt(10)
    v_mfma_f32_32x32x16_bf16 v[152:167], v[20:23], v[44:47], v[152:167]
    ds_read_b64_tr_b16 v[20:21], v9 offset:2048
    ds_read_b64_tr_b16 v[22:23], v9 offset:3072
    s_waitcnt lgkmcnt(10)
    v_mfma_f32_32x32x16_bf16 v[152:167], v[24:27], v[56:59], v[152:167]
    ds_read_b64_tr_b16 v[24:25], v9 offset:4096
    ds_read_b64_tr_b16 v[26:27], v9 offset:5120
    s_waitcnt lgkmcnt(10)
    v_mfma_f32_32x32x16_bf16 v[152:167], v[28:31], v[60:63], v[152:167]
    ds_read_b64_tr_b16 v[28:29], v9 offset:6144
    ds_read_b64_tr_b16 v[30:31], v9 offset:7168
    s_waitcnt lgkmcnt(10)
    v_mfma_f32_32x32x16_bf16 v[152:167], v[32:35], v[72:75], v[152:167]
    ds_read_b64_tr_b16 v[32:33], v9 offset:8192
    ds_read_b64_tr_b16 v[34:35], v9 offset:9216
    s_waitcnt lgkmcnt(10)
    v_mfma_f32_32x32x16_bf16 v[152:167], v[36:39], v[76:79], v[152:167]
    ds_read_b64_tr_b16 v[36:37], v9 offset:10240
    ds_read_b64_tr_b16 v[38:39], v9 offset:11264
    s_waitcnt lgkmcnt(10)
    v_mfma_f32_32x32x16_bf16 v[152:167], v[16:19], v[48:51], v[152:167]
    s_waitcnt vmcnt(0)
    s_barrier
    ds_read_b64_tr_b16 v[16:17], v8 offset:24576
    ds_read_b64_tr_b16 v[18:19], v8 offset:25600
    s_waitcnt lgkmcnt(10)
    v_mfma_f32_32x32x16_bf16 v[152:167], v[20:23], v[52:55], v[152:167]
    ds_read_b64_tr_b16 v[20:21], v8 offset:26624
    ds_read_b64_tr_b16 v[22:23], v8 offset:27648
    s_waitcnt lgkmcnt(10)
    v_mfma_f32_32x32x16_bf16 v[152:167], v[24:27], v[64:67], v[152:167]
    ds_read_b64_tr_b16 v[24:25], v8 offset:28672
    ds_read_b64_tr_b16 v[26:27], v8 offset:29696
    s_waitcnt lgkmcnt(10)
    v_mfma_f32_32x32x16_bf16 v[152:167], v[28:31], v[68:71], v[152:167]
    ds_read_b64_tr_b16 v[28:29], v8 offset:30720
    ds_read_b64_tr_b16 v[30:31], v8 offset:31744
    s_waitcnt lgkmcnt(10)
    v_mfma_f32_32x32x16_bf16 v[152:167], v[32:35], v[80:83], v[152:167]
    ds_read_b64_tr_b16 v[32:33], v8 offset:32768
    ds_read_b64_tr_b16 v[34:35], v8 offset:33792
    s_waitcnt lgkmcnt(10)
    v_mfma_f32_32x32x16_bf16 v[152:167], v[36:39], v[84:87], v[152:167]
    ds_read_b64_tr_b16 v[36:37], v8 offset:34816
    ds_read_b64_tr_b16 v[38:39], v8 offset:35840
    s_waitcnt lgkmcnt(10)
    v_mfma_f32_32x32x16_bf16 v[152:167], v[16:19], v[88:91], v[152:167]
    ds_read_b64_tr_b16 v[16:17], v9 offset:24576
    ds_read_b64_tr_b16 v[18:19], v9 offset:25600
    s_waitcnt lgkmcnt(10)
    v_mfma_f32_32x32x16_bf16 v[152:167], v[20:23], v[92:95], v[152:167]
    ds_read_b64_tr_b16 v[20:21], v9 offset:26624
    ds_read_b64_tr_b16 v[22:23], v9 offset:27648
    s_waitcnt lgkmcnt(10)
    v_mfma_f32_32x32x16_bf16 v[152:167], v[24:27], v[104:107], v[152:167]
    ds_read_b64_tr_b16 v[24:25], v9 offset:28672
    ds_read_b64_tr_b16 v[26:27], v9 offset:29696
    s_waitcnt lgkmcnt(10)
    v_mfma_f32_32x32x16_bf16 v[152:167], v[28:31], v[108:111], v[152:167]
    ds_read_b64_tr_b16 v[28:29], v9 offset:30720
    ds_read_b64_tr_b16 v[30:31], v9 offset:31744
    s_waitcnt lgkmcnt(10)
    v_mfma_f32_32x32x16_bf16 v[152:167], v[32:35], v[120:123], v[152:167]
    ds_read_b64_tr_b16 v[32:33], v9 offset:32768
    ds_read_b64_tr_b16 v[34:35], v9 offset:33792
    s_waitcnt lgkmcnt(10)
    v_mfma_f32_32x32x16_bf16 v[152:167], v[36:39], v[124:127], v[152:167]
    ds_read_b64_tr_b16 v[36:37], v9 offset:34816
    ds_read_b64_tr_b16 v[38:39], v9 offset:35840
    s_waitcnt lgkmcnt(10)
    v_mfma_f32_32x32x16_bf16 v[152:167], v[16:19], v[96:99], v[152:167]
    s_barrier
    v_add_u32 v8, 49152, v8
    v_add_u32 v9, 49152, v9
    v_subrev_u32 v2, s36, v8
    ds_read_b64_tr_b16 v[16:17], v2 offset:0
    ds_read_b64_tr_b16 v[18:19], v2 offset:1024
    s_waitcnt lgkmcnt(10)
    v_mfma_f32_32x32x16_bf16 v[152:167], v[20:23], v[100:103], v[152:167]
    ds_read_b64_tr_b16 v[20:21], v2 offset:2048
    ds_read_b64_tr_b16 v[22:23], v2 offset:3072
    s_waitcnt lgkmcnt(10)
    v_mfma_f32_32x32x16_bf16 v[152:167], v[24:27], v[112:115], v[152:167]
    ds_read_b64_tr_b16 v[24:25], v2 offset:4096
    ds_read_b64_tr_b16 v[26:27], v2 offset:5120
    ds_read_b128 v[4:7], v3 offset:0
    ds_read_b128 v[12:15], v3 offset:4096
    s_waitcnt lgkmcnt(12)
    v_mfma_f32_32x32x16_bf16 v[152:167], v[28:31], v[116:119], v[152:167]
    ds_read_b64_tr_b16 v[28:29], v2 offset:6144
    ds_read_b64_tr_b16 v[30:31], v2 offset:7168
    s_waitcnt lgkmcnt(12)
    v_mfma_f32_32x32x16_bf16 v[152:167], v[32:35], v[128:131], v[152:167]
    ds_read_b64_tr_b16 v[32:33], v2 offset:8192
    ds_read_b64_tr_b16 v[34:35], v2 offset:9216
    s_waitcnt lgkmcnt(12)
    v_mfma_f32_32x32x16_bf16 v[152:167], v[36:39], v[132:135], v[152:167]
    ds_read_b64_tr_b16 v[36:37], v2 offset:10240
    ds_read_b64_tr_b16 v[38:39], v2 offset:11264
    s_waitcnt lgkmcnt(7)
    v_mfma_f32_32x32x16_bf16 v[136:151], v[16:19], v[4:7], v[136:151]
    ds_read_b128 v[4:7], v3 offset:8192
    ds_read_b64_tr_b16 v[16:17], v2 offset:12288
    ds_read_b64_tr_b16 v[18:19], v2 offset:13312
    s_waitcnt lgkmcnt(9)
    v_mfma_f32_32x32x16_bf16 v[136:151], v[20:23], v[12:15], v[136:151]
    ds_read_b128 v[12:15], v3 offset:12288
    ds_read_b64_tr_b16 v[20:21], v2 offset:14336
    ds_read_b64_tr_b16 v[22:23], v2 offset:15360
    s_waitcnt lgkmcnt(5)
    v_mfma_f32_32x32x16_bf16 v[136:151], v[24:27], v[4:7], v[136:151]
    ds_read_b128 v[4:7], v3 offset:16384
    ds_read_b64_tr_b16 v[24:25], v2 offset:16384
    ds_read_b64_tr_b16 v[26:27], v2 offset:17408
    s_waitcnt lgkmcnt(5)
    v_mfma_f32_32x32x16_bf16 v[136:151], v[28:31], v[12:15], v[136:151]
    ds_read_b128 v[12:15], v3 offset:20480
    s_barrier
    v_add_u32 v8, -98304, v8
    v_add_u32 v9, -98304, v9
    v_subrev_u32 v2, s36, v8
    ds_read_b64_tr_b16 v[28:29], v2 offset:0
    ds_read_b64_tr_b16 v[30:31], v2 offset:1024
    s_waitcnt lgkmcnt(5)
    v_mfma_f32_32x32x16_bf16 v[136:151], v[32:35], v[4:7], v[136:151]
    ds_read_b128 v[4:7], v3 offset:24576
    ds_read_b64_tr_b16 v[32:33], v2 offset:2048
    ds_read_b64_tr_b16 v[34:35], v2 offset:3072
    s_waitcnt lgkmcnt(5)
    v_mfma_f32_32x32x16_bf16 v[136:151], v[36:39], v[12:15], v[136:151]
    ds_read_b128 v[12:15], v3 offset:28672
    ds_read_b64_tr_b16 v[36:37], v2 offset:4096
    ds_read_b64_tr_b16 v[38:39], v2 offset:5120
    s_waitcnt lgkmcnt(5)
    v_mfma_f32_32x32x16_bf16 v[136:151], v[16:19], v[4:7], v[136:151]
    ds_read_b128 v[4:7], v3 offset:32768
    ds_read_b64_tr_b16 v[16:17], v2 offset:6144
    ds_read_b64_tr_b16 v[18:19], v2 offset:7168
    s_waitcnt lgkmcnt(5)
    v_mfma_f32_32x32x16_bf16 v[136:151], v[20:23], v[12:15], v[136:151]
    ds_read_b128 v[12:15], v3 offset:4096
    ds_read_b64_tr_b16 v[20:21], v2 offset:8192
    ds_read_b64_tr_b16 v[22:23], v2 offset:9216
    s_waitcnt lgkmcnt(5)
    v_mfma_f32_32x32x16_bf16 v[136:151], v[24:27], v[4:7], v[136:151]
    ds_read_b128 v[4:7], v3 offset:0
    ds_read_b64_tr_b16 v[24:25], v2 offset:10240
    ds_read_b64_tr_b16 v[26:27], v2 offset:11264
    s_waitcnt lgkmcnt(2)
    v_mfma_f32_32x32x16_bf16 v[152:167], v[28:31], v[4:7], v[152:167]
    ds_read_b128 v[4:7], v3 offset:8192
    ds_read_b64_tr_b16 v[28:29], v2 offset:12288
    ds_read_b64_tr_b16 v[30:31], v2 offset:13312
    v_mfma_f32_32x32x16_bf16 v[152:167], v[32:35], v[12:15], v[152:167]
    ds_read_b128 v[12:15], v3 offset:12288
    ds_read_b64_tr_b16 v[32:33], v2 offset:14336
    ds_read_b64_tr_b16 v[34:35], v2 offset:15360
    s_waitcnt lgkmcnt(5)
    v_mfma_f32_32x32x16_bf16 v[152:167], v[36:39], v[4:7], v[152:167]
    ds_read_b128 v[4:7], v3 offset:16384
    ds_read_b64_tr_b16 v[36:37], v2 offset:16384
    ds_read_b64_tr_b16 v[38:39], v2 offset:17408
    s_add_u32 s37, s58, 0
    v_cvt_pk_bf16_f32 v136, v136, v137
    v_cvt_pk_bf16_f32 v137, v138, v139
    v_cvt_pk_bf16_f32 v138, v140, v141
    v_cvt_pk_bf16_f32 v139, v142, v143
    s_waitcnt lgkmcnt(5)
    v_mfma_f32_32x32x16_bf16 v[152:167], v[16:19], v[12:15], v[152:167]
    ds_read_b128 v[12:15], v3 offset:20480
    s_barrier
    ds_read_b64_tr_b16 v[16:17], v8 offset:24576
    ds_read_b64_tr_b16 v[18:19], v8 offset:25600
    buffer_store_dwordx4 v[136:139], v1, s[16:19], s37 offen offset:0 sc1
    v_cvt_pk_bf16_f32 v140, v144, v145
    v_cvt_pk_bf16_f32 v141, v146, v147
    v_cvt_pk_bf16_f32 v142, v148, v149
    v_cvt_pk_bf16_f32 v143, v150, v151
    s_waitcnt lgkmcnt(5)
    v_mfma_f32_32x32x16_bf16 v[152:167], v[20:23], v[4:7], v[152:167]
    ds_read_b128 v[4:7], v3 offset:24576
    ds_read_b64_tr_b16 v[20:21], v8 offset:26624
    ds_read_b64_tr_b16 v[22:23], v8 offset:27648
    buffer_store_dwordx4 v[140:143], v1, s[16:19], s37 offen offset:1024 sc1
    s_waitcnt lgkmcnt(5)
    v_mfma_f32_32x32x16_bf16 v[152:167], v[24:27], v[12:15], v[152:167]
    ds_read_b128 v[12:15], v3 offset:28672
    ds_read_b64_tr_b16 v[24:25], v8 offset:28672
    ds_read_b64_tr_b16 v[26:27], v8 offset:29696
    s_waitcnt lgkmcnt(5)
    v_mfma_f32_32x32x16_bf16 v[152:167], v[28:31], v[4:7], v[152:167]
    ds_read_b128 v[4:7], v3 offset:32768
    ds_read_b64_tr_b16 v[28:29], v8 offset:30720
    ds_read_b64_tr_b16 v[30:31], v8 offset:31744
    s_waitcnt lgkmcnt(5)
    v_mfma_f32_32x32x16_bf16 v[152:167], v[32:35], v[12:15], v[152:167]
    ds_read_b64_tr_b16 v[32:33], v8 offset:32768
    ds_read_b64_tr_b16 v[34:35], v8 offset:33792
    s_waitcnt lgkmcnt(4)
    v_mfma_f32_32x32x16_bf16 v[152:167], v[36:39], v[4:7], v[152:167]
    ds_read_b64_tr_b16 v[36:37], v8 offset:34816
    ds_read_b64_tr_b16 v[38:39], v8 offset:35840
    v_mfma_f32_32x32x16_bf16 v[136:151], v[16:19], v[40:43], 0
    ds_read_b64_tr_b16 v[16:17], v9 offset:24576
    ds_read_b64_tr_b16 v[18:19], v9 offset:25600
    v_mfma_f32_32x32x16_bf16 v[136:151], v[20:23], v[44:47], v[136:151]
    ds_read_b64_tr_b16 v[20:21], v9 offset:26624
    ds_read_b64_tr_b16 v[22:23], v9 offset:27648
    v_mfma_f32_32x32x16_bf16 v[136:151], v[24:27], v[56:59], v[136:151]
    ds_read_b64_tr_b16 v[24:25], v9 offset:28672
    ds_read_b64_tr_b16 v[26:27], v9 offset:29696
    s_add_u32 s37, s58, 4096
    v_cvt_pk_bf16_f32 v152, v152, v153
    v_cvt_pk_bf16_f32 v153, v154, v155
    v_cvt_pk_bf16_f32 v154, v156, v157
    v_cvt_pk_bf16_f32 v155, v158, v159
    s_waitcnt lgkmcnt(10)
    v_mfma_f32_32x32x16_bf16 v[136:151], v[28:31], v[60:63], v[136:151]
    ds_read_b64_tr_b16 v[28:29], v9 offset:30720
    ds_read_b64_tr_b16 v[30:31], v9 offset:31744
    buffer_store_dwordx4 v[152:155], v1, s[16:19], s37 offen offset:0 sc1
    v_cvt_pk_bf16_f32 v156, v160, v161
    v_cvt_pk_bf16_f32 v157, v162, v163
    v_cvt_pk_bf16_f32 v158, v164, v165
    v_cvt_pk_bf16_f32 v159, v166, v167
    s_waitcnt lgkmcnt(10)
    v_mfma_f32_32x32x16_bf16 v[136:151], v[32:35], v[72:75], v[136:151]
    ds_read_b64_tr_b16 v[32:33], v9 offset:32768
    ds_read_b64_tr_b16 v[34:35], v9 offset:33792
    buffer_store_dwordx4 v[156:159], v1, s[16:19], s37 offen offset:1024 sc1
    s_waitcnt lgkmcnt(10)
    v_mfma_f32_32x32x16_bf16 v[136:151], v[36:39], v[76:79], v[136:151]
    ds_read_b64_tr_b16 v[36:37], v9 offset:34816
    ds_read_b64_tr_b16 v[38:39], v9 offset:35840
    s_waitcnt lgkmcnt(10)
    v_mfma_f32_32x32x16_bf16 v[136:151], v[16:19], v[48:51], v[136:151]
    v_add_u32 v8, 49152, v8
    v_add_u32 v9, 49152, v9
    ds_read_b64_tr_b16 v[16:17], v8 offset:0
    ds_read_b64_tr_b16 v[18:19], v8 offset:1024
    s_waitcnt lgkmcnt(10)
    v_mfma_f32_32x32x16_bf16 v[136:151], v[20:23], v[52:55], v[136:151]
    ds_read_b64_tr_b16 v[20:21], v8 offset:2048
    ds_read_b64_tr_b16 v[22:23], v8 offset:3072
    s_waitcnt lgkmcnt(10)
    v_mfma_f32_32x32x16_bf16 v[136:151], v[24:27], v[64:67], v[136:151]
    ds_read_b64_tr_b16 v[24:25], v8 offset:4096
    ds_read_b64_tr_b16 v[26:27], v8 offset:5120
    s_waitcnt lgkmcnt(10)
    v_mfma_f32_32x32x16_bf16 v[136:151], v[28:31], v[68:71], v[136:151]
    ds_read_b64_tr_b16 v[28:29], v8 offset:6144
    ds_read_b64_tr_b16 v[30:31], v8 offset:7168
    s_waitcnt lgkmcnt(10)
    v_mfma_f32_32x32x16_bf16 v[136:151], v[32:35], v[80:83], v[136:151]
    ds_read_b64_tr_b16 v[32:33], v8 offset:8192
    ds_read_b64_tr_b16 v[34:35], v8 offset:9216
    s_waitcnt lgkmcnt(10)
    v_mfma_f32_32x32x16_bf16 v[136:151], v[36:39], v[84:87], v[136:151]
    ds_read_b64_tr_b16 v[36:37], v8 offset:10240
    ds_read_b64_tr_b16 v[38:39], v8 offset:11264
    s_waitcnt lgkmcnt(10)
    v_mfma_f32_32x32x16_bf16 v[136:151], v[16:19], v[88:91], v[136:151]
    ds_read_b64_tr_b16 v[16:17], v9 offset:0
    ds_read_b64_tr_b16 v[18:19], v9 offset:1024
    s_waitcnt lgkmcnt(10)
    v_mfma_f32_32x32x16_bf16 v[136:151], v[20:23], v[92:95], v[136:151]
    ds_read_b64_tr_b16 v[20:21], v9 offset:2048
    ds_read_b64_tr_b16 v[22:23], v9 offset:3072
    s_waitcnt lgkmcnt(10)
    v_mfma_f32_32x32x16_bf16 v[136:151], v[24:27], v[104:107], v[136:151]
    ds_read_b64_tr_b16 v[24:25], v9 offset:4096
    ds_read_b64_tr_b16 v[26:27], v9 offset:5120
    s_waitcnt lgkmcnt(10)
    v_mfma_f32_32x32x16_bf16 v[136:151], v[28:31], v[108:111], v[136:151]
    ds_read_b64_tr_b16 v[28:29], v9 offset:6144
    ds_read_b64_tr_b16 v[30:31], v9 offset:7168
    s_waitcnt lgkmcnt(10)
    v_mfma_f32_32x32x16_bf16 v[136:151], v[32:35], v[120:123], v[136:151]
    ds_read_b64_tr_b16 v[32:33], v9 offset:8192
    ds_read_b64_tr_b16 v[34:35], v9 offset:9216
    s_waitcnt lgkmcnt(10)
    v_mfma_f32_32x32x16_bf16 v[136:151], v[36:39], v[124:127], v[136:151]
    ds_read_b64_tr_b16 v[36:37], v9 offset:10240
    ds_read_b64_tr_b16 v[38:39], v9 offset:11264
    s_waitcnt lgkmcnt(10)
    v_mfma_f32_32x32x16_bf16 v[136:151], v[16:19], v[96:99], v[136:151]
    v_subrev_u32 v2, s36, v8
    ds_read_b64_tr_b16 v[16:17], v2 offset:24576
    ds_read_b64_tr_b16 v[18:19], v2 offset:25600
    s_waitcnt lgkmcnt(10)
    v_mfma_f32_32x32x16_bf16 v[136:151], v[20:23], v[100:103], v[136:151]
    ds_read_b64_tr_b16 v[20:21], v2 offset:26624
    ds_read_b64_tr_b16 v[22:23], v2 offset:27648
    s_waitcnt lgkmcnt(10)
    v_mfma_f32_32x32x16_bf16 v[136:151], v[24:27], v[112:115], v[136:151]
    ds_read_b64_tr_b16 v[24:25], v2 offset:28672
    ds_read_b64_tr_b16 v[26:27], v2 offset:29696
    ds_read_b128 v[4:7], v3 offset:0
    ds_read_b128 v[12:15], v3 offset:4096
    s_waitcnt lgkmcnt(12)
    v_mfma_f32_32x32x16_bf16 v[136:151], v[28:31], v[116:119], v[136:151]
    ds_read_b64_tr_b16 v[28:29], v2 offset:30720
    ds_read_b64_tr_b16 v[30:31], v2 offset:31744
    s_waitcnt lgkmcnt(12)
    v_mfma_f32_32x32x16_bf16 v[136:151], v[32:35], v[128:131], v[136:151]
    ds_read_b64_tr_b16 v[32:33], v2 offset:32768
    ds_read_b64_tr_b16 v[34:35], v2 offset:33792
    s_waitcnt lgkmcnt(12)
    v_mfma_f32_32x32x16_bf16 v[136:151], v[36:39], v[132:135], v[136:151]
    ds_read_b64_tr_b16 v[36:37], v2 offset:34816
    ds_read_b64_tr_b16 v[38:39], v2 offset:35840
    s_waitcnt lgkmcnt(7)
    v_mfma_f32_32x32x16_bf16 v[136:151], v[16:19], v[4:7], v[136:151]
    ds_read_b128 v[4:7], v3 offset:8192
    ds_read_b64_tr_b16 v[16:17], v2 offset:36864
    ds_read_b64_tr_b16 v[18:19], v2 offset:37888
    s_waitcnt lgkmcnt(9)
    v_mfma_f32_32x32x16_bf16 v[136:151], v[20:23], v[12:15], v[136:151]
    ds_read_b128 v[12:15], v3 offset:12288
    ds_read_b64_tr_b16 v[20:21], v2 offset:38912
    ds_read_b64_tr_b16 v[22:23], v2 offset:39936
    s_waitcnt lgkmcnt(5)
    v_mfma_f32_32x32x16_bf16 v[136:151], v[24:27], v[4:7], v[136:151]
    ds_read_b128 v[4:7], v3 offset:16384
    ds_read_b64_tr_b16 v[24:25], v2 offset:40960
    ds_read_b64_tr_b16 v[26:27], v2 offset:41984
    s_waitcnt lgkmcnt(5)
    v_mfma_f32_32x32x16_bf16 v[136:151], v[28:31], v[12:15], v[136:151]
    ds_read_b128 v[12:15], v3 offset:20480
    s_waitcnt lgkmcnt(3)
    v_mfma_f32_32x32x16_bf16 v[136:151], v[32:35], v[4:7], v[136:151]
    ds_read_b128 v[4:7], v3 offset:24576
    s_waitcnt lgkmcnt(1)
    v_mfma_f32_32x32x16_bf16 v[136:151], v[36:39], v[12:15], v[136:151]
    ds_read_b128 v[12:15], v3 offset:28672
    s_waitcnt lgkmcnt(1)
    v_mfma_f32_32x32x16_bf16 v[136:151], v[16:19], v[4:7], v[136:151]
    ds_read_b128 v[4:7], v3 offset:32768
    s_waitcnt lgkmcnt(1)
    v_mfma_f32_32x32x16_bf16 v[136:151], v[20:23], v[12:15], v[136:151]
    s_waitcnt lgkmcnt(0)
    v_mfma_f32_32x32x16_bf16 v[136:151], v[24:27], v[4:7], v[136:151]
    s_add_u32 s37, s58, 8192
    s_nop 10
    v_cvt_pk_bf16_f32 v136, v136, v137
    v_cvt_pk_bf16_f32 v137, v138, v139
    v_cvt_pk_bf16_f32 v138, v140, v141
    v_cvt_pk_bf16_f32 v139, v142, v143
    buffer_store_dwordx4 v[136:139], v1, s[16:19], s37 offen offset:0 sc1
    v_cvt_pk_bf16_f32 v140, v144, v145
    v_cvt_pk_bf16_f32 v141, v146, v147
    v_cvt_pk_bf16_f32 v142, v148, v149
    v_cvt_pk_bf16_f32 v143, v150, v151
    buffer_store_dwordx4 v[140:143], v1, s[16:19], s37 offen offset:1024 sc1
    s_waitcnt vmcnt(2)
    v_mov_b32 v40, s46
    s_add_u32 s54, s47, 1
    v_mov_b32 v41, s54
    s_mov_b64 exec, 1
    buffer_store_dwordx2 v[40:41], v1, s[16:19], s84 offen offset:0 sc1
    s_mov_b64 exec, -1
    s_waitcnt vmcnt(1)
    v_mov_b32 v42, s46
    s_add_u32 s54, s47, 2
    v_mov_b32 v43, s54
    s_mov_b64 exec, 1
    buffer_store_dwordx2 v[42:43], v1, s[16:19], s84 offen offset:0 sc1
    s_mov_b64 exec, -1
    s_endpgm
L_helperF:
    s_lshl_b32 s34, s28, 7
    s_lshl_b32 s35, s32, 4
    s_add_u32 s34, s34, s35
    s_mul_i32 s34, s34, 1152
    v_lshrrev_b32 v4, 3, v3
    v_mul_u32_u24 v4, 1152, v4
    v_add_u32 v4, s34, v4
    v_and_b32 v5, 7, v3
    v_lshrrev_b32 v6, 4, v3
    v_xor_b32 v5, v5, v6
    v_lshl_add_u32 v10, v5, 4, v4
    v_xor_b32 v5, 4, v5
    v_lshl_add_u32 v11, v5, 4, v4
    v_add_u32 v11, 9216, v11
    s_lshl_b32 s41, s32, 11
    s_add_u32 s41, s41, 122880
    s_lshr_b32 s37, s32, 1
    s_lshl_b32 s37, s37, 4
    s_and_b32 s35, s32, 1
    s_lshl_b32 s35, s35, 2
    s_add_u32 s37, s37, s35
    s_mul_i32 s40, s32, 3072
    s_mul_i32 s34, s37, 9216
    s_mul_i32 s55, s48, 768
    s_add_u32 s34, s34, s55
    v_add_u32 v5, 0, v3
    v_mul_u32_u24 v4, 2731, v5
    v_lshrrev_b32 v4, 16, v4
    v_mul_u32_u24 v6, 24, v4
    v_sub_u32 v5, v5, v6
    v_bfe_u32 v6, v4, 1, 1
    v_lshlrev_b32 v6, 2, v6
    v_xor_b32 v5, v5, v6
    v_and_b32 v6, 4, v4
    v_add_u32 v4, v4, v6
    v_mul_u32_u24 v4, 9216, v4
    v_lshl_add_u32 v4, v5, 4, v4
    v_add_u32 v16, s34, v4
    v_add_u32 v5, 64, v3
    v_mul_u32_u24 v4, 2731, v5
    v_lshrrev_b32 v4, 16, v4
    v_mul_u32_u24 v6, 24, v4
    v_sub_u32 v5, v5, v6
    v_bfe_u32 v6, v4, 1, 1
    v_lshlrev_b32 v6, 2, v6
    v_xor_b32 v5, v5, v6
    v_and_b32 v6, 4, v4
    v_add_u32 v4, v4, v6
    v_mul_u32_u24 v4, 9216, v4
    v_lshl_add_u32 v4, v5, 4, v4
    v_add_u32 v17, s34, v4
    v_add_u32 v5, 128, v3
    v_mul_u32_u24 v4, 2731, v5
    v_lshrrev_b32 v4, 16, v4
    v_mul_u32_u24 v6, 24, v4
    v_sub_u32 v5, v5, v6
    v_bfe_u32 v6, v4, 1, 1
    v_lshlrev_b32 v6, 2, v6
    v_xor_b32 v5, v5, v6
    v_and_b32 v6, 4, v4
    v_add_u32 v4, v4, v6
    v_mul_u32_u24 v4, 9216, v4
    v_lshl_add_u32 v4, v5, 4, v4
    v_add_u32 v18, s34, v4
    s_waitcnt lgkmcnt(0)
    s_mov_b32 s4, s56
    s_mov_b32 s5, s57
    s_mov_b32 s6, 2359296
    s_mov_b32 s7, 0x20000
    s_mov_b32 s8, s64
    s_mov_b32 s9, s65
    s_mov_b32 s10, 5308416
    s_mov_b32 s11, 0x20000
    s_add_u32 m0, s41, 0
    s_mov_b32 s38, 0
    buffer_load_dwordx4 v10, s[4:7], s38 offen lds
    s_add_u32 m0, s41, 1024
    s_mov_b32 s38, 0
    buffer_load_dwordx4 v11, s[4:7], s38 offen lds
    s_add_u32 m0, s41, 8192
    s_mov_b32 s38, 73728
    buffer_load_dwordx4 v10, s[4:7], s38 offen lds
    s_add_u32 m0, s41, 9216
    s_mov_b32 s38, 73728
    buffer_load_dwordx4 v11, s[4:7], s38 offen lds
    s_add_u32 m0, s40, 0
    s_mov_b32 s38, 0
    buffer_load_dwordx4 v16, s[8:11], s38 offen lds
    s_add_u32 m0, s40, 1024
    s_mov_b32 s38, 0
    buffer_load_dwordx4 v17, s[8:11], s38 offen lds
    s_add_u32 m0, s40, 2048
    s_mov_b32 s38, 0
    buffer_load_dwordx4 v18, s[8:11], s38 offen lds
    s_add_u32 m0, s40, 12288
    s_mov_b32 s38, 384
    buffer_load_dwordx4 v16, s[8:11], s38 offen lds
    s_add_u32 m0, s40, 13312
    s_mov_b32 s38, 384
    buffer_load_dwordx4 v17, s[8:11], s38 offen lds
    s_add_u32 m0, s40, 14336
    s_mov_b32 s38, 384
    buffer_load_dwordx4 v18, s[8:11], s38 offen lds
    v_mov_b32 v2, 0
    s_mov_b32 s24, s74
    s_mov_b32 s25, s75
    s_mov_b32 s26, 256
    s_mov_b32 s27, 0x20000
    s_mov_b32 s16, s76
    s_mov_b32 s17, s77
    s_mov_b32 s18, 35946496
    s_mov_b32 s19, 0x20000
    s_or_b32 s51, s78, 1
    s_lshl_b32 s34, s2, 2
    s_add_u32 s34, s34, s32
    s_lshl_b32 s34, s34, 12
    v_mov_b32 v4, s51
    s_mov_b64 exec, 1
    buffer_store_dword v4, v2, s[24:27], s34 offen sc1
    s_mov_b64 exec, -1
    s_mov_b32 s12, s68
    s_mov_b32 s13, s69
    s_mov_b32 s14, 5308416
    s_mov_b32 s15, 0x20000
    s_mov_b32 s20, s66
    s_mov_b32 s21, s67
    s_mov_b32 s22, 9216
    s_mov_b32 s23, 0x20000
    s_mov_b32 s80, s72
    s_mov_b32 s81, s73
    s_mov_b32 s82, 2359296
    s_mov_b32 s83, 0x20000
    s_mov_b32 s72, s70
    s_mov_b32 s73, s71
    s_mov_b32 s74, 1152
    s_mov_b32 s75, 0x20000
    s_mov_b32 s68, s60
    s_mov_b32 s69, s61
    s_mov_b32 s70, 663552
    s_mov_b32 s71, 0x20000
    s_mov_b32 m0, 156672
    s_mov_b32 exec_hi, 0xffff
    buffer_load_dwordx4 v1, s[20:23], s55 offen lds
    s_mov_b32 exec_hi, -1
    s_lshl_b32 s34, s28, 2
    s_add_u32 s34, s34, s32
    s_mul_i32 s34, s34, 9216
    s_add_u32 s34, s34, s55
    v_min_u32 v4, 752, v1
    v_add_u32 v14, s34, v4
    s_lshl_b32 s34, s28, 4
    s_add_u32 s34, s34, s48
    s_lshl_b32 s35, s34, 2
    s_add_u32 s35, s35, s32
    s_lshl_b32 s35, s35, 1
    s_mul_i32 s49, s35, 1152
    s_lshl_b32 s35, s35, 4
    s_add_u32 s77, s35, 33292288
    s_lshl_b32 s34, s34, 11
    s_add_u32 s88, s34, 33325056
    s_lshl_b32 s34, s32, 7
    s_add_u32 s84, s88, s34
    v_lshrrev_b32 v4, 5, v3
    v_lshlrev_b32 v108, 4, v4
    v_mul_u32_u24 v4, 1152, v4
    v_and_b32 v5, 31, v3
    v_lshl_add_u32 v100, v5, 4, v4
    v_lshl_add_u32 v101, v5, 2, v4
    s_mul_i32 s34, s32, 1536
    s_add_u32 s34, s34, 157696
    v_lshlrev_b32 v4, 1, v1
    v_add_u32 v102, s34, v4
    v_add_u32 v15, s34, v1
    s_lshl_b32 s34, s32, 10
    v_add_u32 v7, s34, v1
    v_min_u32 v4, 1520, v7
    v_add_u32 v103, 157696, v4
    v_cmp_lt_u32 vcc, 2047, v7
    v_mov_b32 v8, 0x7fffff00
    s_nop 0
    v_cndmask_b32 v104, v7, v8, vcc
    s_lshl_b32 s85, s48, 15
    s_add_u32 s85, s85, 32768000
    s_lshl_b32 s34, s28, 11
    s_add_u32 s76, s85, s34
    s_lshl_b32 s34, s32, 13
    s_add_u32 s85, s85, s34
    s_lshl_b32 s34, s32, 6
    s_add_u32 s34, s34, s48
    s_lshl_b32 s34, s34, 11
    s_add_u32 s86, s34, 33326080
    v_and_b32 v4, 3, v3
    v_bfe_u32 v5, v3, 2, 1
    v_lshlrev_b32 v5, 7, v5
    v_lshl_add_u32 v105, v4, 15, v5
    s_lshl_b32 s34, s28, 2
    s_add_u32 s34, s34, s32
    s_lshl_b32 s34, s34, 9
    s_add_u32 s34, s34, 33292288
    v_and_b32 v4, 0x1f0, v1
    v_add_u32 v106, s34, v4
    v_lshrrev_b32 v4, 1, v4
    s_lshl_b32 s34, s32, 8
    s_add_u32 s34, s34, 155648
    v_add_u32 v107, s34, v4
    v_mov_b32 v99, 0
    s_mov_b32 s98, s30
    s_add_u32 s96, s30, 1
    s_cmp_eq_u32 s96, 3
    s_cselect_b32 s96, 0, s96
    s_add_u32 s97, s96, 1
    s_cmp_eq_u32 s97, 3
    s_cselect_b32 s97, 0, s97
    s_mul_i32 s34, s32, 24
    v_lshrrev_b32 v4, 3, v3
    v_add_u32 v4, s34, v4
    v_mul_u32_u24 v4, 1152, v4
    v_bfe_u32 v5, v3, 4, 1
    v_lshlrev_b32 v5, 2, v5
    v_and_b32 v6, 7, v3
    v_xor_b32 v5, v5, v6
    v_lshl_add_u32 v19, v5, 4, v4
    s_mul_i32 s34, s29, 165888
    s_mul_i32 s35, s30, 384
    s_add_u32 s64, s34, s35
    s_mul_i32 s35, s48, 442368
    s_mul_i32 s59, s96, 384
    s_add_u32 s59, s59, s35
    s_mul_i32 s60, s97, 384
    s_add_u32 s60, s60, s35
    s_mul_i32 s61, s98, 384
    s_add_u32 s61, s61, s35
    s_lshl_b32 s34, s28, 4
    s_lshl_b32 s62, s34, 11
    s_add_u32 s62, s62, 33325056
    s_add_u32 s34, s29, 12
    s_lshl_b32 s34, s34, 11
    s_add_u32 s87, s34, s62
    v_and_b32 v4, 7, v3
    v_lshlrev_b32 v30, 7, v4
    s_lshl_b32 s34, s28, 2
    s_add_u32 s34, s34, s29
    s_mul_i32 s34, s34, 36
    s_add_u32 s34, s34, s32
    s_lshl_b32 s34, s34, 10
    s_add_u32 s43, s34, 30408704
    s_mul_i32 s34, s28, 3
    s_add_u32 s34, s34, s30
    s_mul_i32 s34, s34, 589824
    s_lshl_b32 s35, s32, 10
    s_add_u32 s34, s34, s35
    s_mul_i32 s35, s29, 12288
    s_add_u32 s42, s34, s35
    v_and_b32 v4, 3, v3
    v_mul_u32_u24 v26, 6144, v4
    s_lshl_b32 s34, s28, 2
    s_add_u32 s34, s34, s29
    s_lshl_b32 s34, s34, 5
    v_and_b32 v4, 31, v3
    v_add_u32 v4, s34, v4
    v_lshlrev_b32 v5, 4, v4
    v_add_u32 v27, 33292292, v5
    v_mul_u32_u24 v4, 1152, v4
    s_mul_i32 s34, s30, 384
    s_lshl_b32 s35, s32, 5
    s_add_u32 s34, s34, s35
    v_lshrrev_b32 v5, 5, v3
    v_lshlrev_b32 v5, 4, v5
    v_add_u32 v25, s34, v5
    v_add_u32 v24, v4, v25
    s_lshl_b32 s34, s53, 2
    s_add_u32 s34, s34, s32
    s_mul_i32 s35, s34, 13824
    v_min_u32 v4, 35, v3
    v_mul_u32_u24 v5, 21846, v4
    v_lshrrev_b32 v5, 16, v5
    v_mul_u32_u24 v5, 768, v5
    v_lshl_add_u32 v5, v4, 7, v5
    v_add_u32 v21, s35, v5
    s_mul_i32 s34, s34, 14
    v_min_u32 v4, 13, v3
    v_add_u32 v4, s34, v4
    v_min_u32 v4, 431, v4
    v_mul_u32_u24 v5, 21846, v4
    v_lshrrev_b32 v5, 16, v5
    v_mul_u32_u24 v5, 768, v5
    v_lshl_add_u32 v22, v4, 7, v5
    s_add_u32 m0, s40, 24576
    s_mov_b32 s38, 294912
    buffer_load_dwordx4 v16, s[8:11], s38 offen lds
    s_add_u32 m0, s40, 25600
    s_mov_b32 s38, 294912
    buffer_load_dwordx4 v17, s[8:11], s38 offen lds
    s_add_u32 m0, s40, 26624
    s_mov_b32 s38, 294912
    buffer_load_dwordx4 v18, s[8:11], s38 offen lds
    s_add_u32 m0, s40, 36864
    s_mov_b32 s38, 295296
    buffer_load_dwordx4 v16, s[8:11], s38 offen lds
    s_add_u32 m0, s40, 37888
    s_mov_b32 s38, 295296
    buffer_load_dwordx4 v17, s[8:11], s38 offen lds
    s_add_u32 m0, s40, 38912
    s_mov_b32 s38, 295296
    buffer_load_dwordx4 v18, s[8:11], s38 offen lds
    s_add_u32 m0, s41, 16384
    s_mov_b32 s38, 128
    buffer_load_dwordx4 v10, s[4:7], s38 offen lds
    s_add_u32 m0, s41, 17408
    s_mov_b32 s38, 128
    buffer_load_dwordx4 v11, s[4:7], s38 offen lds
    s_add_u32 m0, s41, 24576
    s_mov_b32 s38, 73856
    buffer_load_dwordx4 v10, s[4:7], s38 offen lds
    s_add_u32 m0, s41, 25600
    s_mov_b32 s38, 73856
    buffer_load_dwordx4 v11, s[4:7], s38 offen lds
    s_waitcnt vmcnt(12)
    s_barrier
    s_add_u32 m0, s40, 49152
    s_mov_b32 s38, 589824
    buffer_load_dwordx4 v16, s[8:11], s38 offen lds
    s_add_u32 m0, s40, 50176
    s_mov_b32 s38, 589824
    buffer_load_dwordx4 v17, s[8:11], s38 offen lds
    s_add_u32 m0, s40, 51200
    s_mov_b32 s38, 589824
    buffer_load_dwordx4 v18, s[8:11], s38 offen lds
    s_add_u32 m0, s40, 61440
    s_mov_b32 s38, 590208
    buffer_load_dwordx4 v16, s[8:11], s38 offen lds
    s_add_u32 m0, s40, 62464
    s_mov_b32 s38, 590208
    buffer_load_dwordx4 v17, s[8:11], s38 offen lds
    s_add_u32 m0, s40, 63488
    s_mov_b32 s38, 590208
    buffer_load_dwordx4 v18, s[8:11], s38 offen lds
    s_add_u32 m0, s40, 73728
    s_mov_b32 s38, 884736
    buffer_load_dwordx4 v16, s[8:11], s38 offen lds
    s_add_u32 m0, s40, 74752
    s_mov_b32 s38, 884736
    buffer_load_dwordx4 v17, s[8:11], s38 offen lds
    s_add_u32 m0, s40, 75776
    s_mov_b32 s38, 884736
    buffer_load_dwordx4 v18, s[8:11], s38 offen lds
    s_add_u32 m0, s40, 86016
    s_mov_b32 s38, 885120
    buffer_load_dwordx4 v16, s[8:11], s38 offen lds
    s_add_u32 m0, s40, 87040
    s_mov_b32 s38, 885120
    buffer_load_dwordx4 v17, s[8:11], s38 offen lds
    s_add_u32 m0, s40, 88064
    s_mov_b32 s38, 885120
    buffer_load_dwordx4 v18, s[8:11], s38 offen lds
    buffer_load_dwordx4 v[84:87], v100, s[4:7], s49 offen
    buffer_load_dwordx4 v[88:91], v100, s[4:7], s49 offen offset:512
    buffer_load_dword v92, v101, s[4:7], s49 offen offset:1024
    s_mov_b32 s54, 589824
    buffer_load_dwordx4 v[40:43], v14, s[8:11], s54 offen
    s_mov_b32 s54, 1179648
    buffer_load_dwordx4 v[44:47], v14, s[8:11], s54 offen
    s_mov_b32 s54, 1769472
    buffer_load_dwordx4 v[48:51], v14, s[8:11], s54 offen
    s_waitcnt vmcnt(22)
    s_barrier
    s_add_u32 m0, s40, 98304
    s_mov_b32 s38, 1179648
    buffer_load_dwordx4 v16, s[8:11], s38 offen lds
    s_add_u32 m0, s40, 99328
    s_mov_b32 s38, 1179648
    buffer_load_dwordx4 v17, s[8:11], s38 offen lds
    s_add_u32 m0, s40, 100352
    s_mov_b32 s38, 1179648
    buffer_load_dwordx4 v18, s[8:11], s38 offen lds
    s_add_u32 m0, s40, 110592
    s_mov_b32 s38, 1180032
    buffer_load_dwordx4 v16, s[8:11], s38 offen lds
    s_add_u32 m0, s40, 111616
    s_mov_b32 s38, 1180032
    buffer_load_dwordx4 v17, s[8:11], s38 offen lds
    s_add_u32 m0, s40, 112640
    s_mov_b32 s38, 1180032
    buffer_load_dwordx4 v18, s[8:11], s38 offen lds
    s_waitcnt vmcnt(18)
    s_barrier
    s_add_u32 m0, s41, 0
    s_mov_b32 s38, 256
    buffer_load_dwordx4 v10, s[4:7], s38 offen lds
    s_add_u32 m0, s41, 1024
    s_mov_b32 s38, 256
    buffer_load_dwordx4 v11, s[4:7], s38 offen lds
    s_add_u32 m0, s41, 8192
    s_mov_b32 s38, 73984
    buffer_load_dwordx4 v10, s[4:7], s38 offen lds
    s_add_u32 m0, s41, 9216
    s_mov_b32 s38, 73984
    buffer_load_dwordx4 v11, s[4:7], s38 offen lds
    s_add_u32 m0, s40, 0
    s_mov_b32 s38, 1474560
    buffer_load_dwordx4 v16, s[8:11], s38 offen lds
    s_add_u32 m0, s40, 1024
    s_mov_b32 s38, 1474560
    buffer_load_dwordx4 v17, s[8:11], s38 offen lds
    s_add_u32 m0, s40, 2048
    s_mov_b32 s38, 1474560
    buffer_load_dwordx4 v18, s[8:11], s38 offen lds
    s_add_u32 m0, s40, 12288
    s_mov_b32 s38, 1474944
    buffer_load_dwordx4 v16, s[8:11], s38 offen lds
    s_add_u32 m0, s40, 13312
    s_mov_b32 s38, 1474944
    buffer_load_dwordx4 v17, s[8:11], s38 offen lds
    s_add_u32 m0, s40, 14336
    s_mov_b32 s38, 1474944
    buffer_load_dwordx4 v18, s[8:11], s38 offen lds
    s_mov_b32 s54, 2359296
    buffer_load_dwordx4 v[52:55], v14, s[8:11], s54 offen
    s_mov_b32 s54, 2949120
    buffer_load_dwordx4 v[56:59], v14, s[8:11], s54 offen
    s_mov_b32 s54, 3538944
    buffer_load_dwordx4 v[60:63], v14, s[8:11], s54 offen
    s_mov_b32 s54, 4128768
    buffer_load_dwordx4 v[64:67], v14, s[8:11], s54 offen
    s_mov_b32 s54, 4718592
    buffer_load_dwordx4 v[68:71], v14, s[8:11], s54 offen
    s_mov_b32 s54, 0
    buffer_load_dwordx4 v[72:75], v14, s[8:11], s54 offen
    buffer_load_dword v98, v2, s[24:27], 0 offen sc1
    s_waitcnt vmcnt(29)
    s_barrier
    s_add_u32 m0, s40, 24576
    s_mov_b32 s38, 1769472
    buffer_load_dwordx4 v16, s[8:11], s38 offen lds
    s_add_u32 m0, s40, 25600
    s_mov_b32 s38, 1769472
    buffer_load_dwordx4 v17, s[8:11], s38 offen lds
    s_add_u32 m0, s40, 26624
    s_mov_b32 s38, 1769472
    buffer_load_dwordx4 v18, s[8:11], s38 offen lds
    s_add_u32 m0, s40, 36864
    s_mov_b32 s38, 1769856
    buffer_load_dwordx4 v16, s[8:11], s38 offen lds
    s_add_u32 m0, s40, 37888
    s_mov_b32 s38, 1769856
    buffer_load_dwordx4 v17, s[8:11], s38 offen lds
    s_add_u32 m0, s40, 38912
    s_mov_b32 s38, 1769856
    buffer_load_dwordx4 v18, s[8:11], s38 offen lds
    s_waitcnt vmcnt(32)
    v_lshlrev_b32 v4, 16, v84
    v_and_b32 v5, s52, v84
    v_add_f32 v96, v4, v5
    v_mul_f32 v97, v4, v4
    v_fmac_f32 v97, v5, v5
    v_lshlrev_b32 v4, 16, v85
    v_and_b32 v5, s52, v85
    v_add_f32 v96, v96, v4
    v_fmac_f32 v97, v4, v4
    v_add_f32 v96, v96, v5
    v_fmac_f32 v97, v5, v5
    v_lshlrev_b32 v4, 16, v86
    v_and_b32 v5, s52, v86
    v_add_f32 v96, v96, v4
    v_fmac_f32 v97, v4, v4
    v_add_f32 v96, v96, v5
    v_fmac_f32 v97, v5, v5
    v_lshlrev_b32 v4, 16, v87
    v_and_b32 v5, s52, v87
    v_add_f32 v96, v96, v4
    v_fmac_f32 v97, v4, v4
    v_add_f32 v96, v96, v5
    v_fmac_f32 v97, v5, v5
    v_lshlrev_b32 v4, 16, v88
    v_and_b32 v5, s52, v88
    v_add_f32 v96, v96, v4
    v_fmac_f32 v97, v4, v4
    v_add_f32 v96, v96, v5
    v_fmac_f32 v97, v5, v5
    v_lshlrev_b32 v4, 16, v89
    v_and_b32 v5, s52, v89
    v_add_f32 v96, v96, v4
    v_fmac_f32 v97, v4, v4
    v_add_f32 v96, v96, v5
    v_fmac_f32 v97, v5, v5
    v_lshlrev_b32 v4, 16, v90
    v_and_b32 v5, s52, v90
    v_add_f32 v96, v96, v4
    v_fmac_f32 v97, v4, v4
    v_add_f32 v96, v96, v5
    v_fmac_f32 v97, v5, v5
    v_lshlrev_b32 v4, 16, v91
    v_and_b32 v5, s52, v91
    v_add_f32 v96, v96, v4
    v_fmac_f32 v97, v4, v4
    v_add_f32 v96, v96, v5
    v_fmac_f32 v97, v5, v5
    v_lshlrev_b32 v4, 16, v92
    v_and_b32 v5, s52, v92
    v_add_f32 v96, v96, v4
    v_fmac_f32 v97, v4, v4
    v_add_f32 v96, v96, v5
    v_fmac_f32 v97, v5, v5
    s_nop 0
    v_add_f32_dpp v96, v96, v96 quad_perm:[1,0,3,2] row_mask:0xf bank_mask:0xf
    v_add_f32_dpp v97, v97, v97 quad_perm:[1,0,3,2] row_mask:0xf bank_mask:0xf
    s_nop 0
    v_add_f32_dpp v96, v96, v96 quad_perm:[2,3,0,1] row_mask:0xf bank_mask:0xf
    v_add_f32_dpp v97, v97, v97 quad_perm:[2,3,0,1] row_mask:0xf bank_mask:0xf
    s_nop 0
    v_add_f32_dpp v96, v96, v96 row_half_mirror row_mask:0xf bank_mask:0xf
    v_add_f32_dpp v97, v97, v97 row_half_mirror row_mask:0xf bank_mask:0xf
    s_nop 0
    v_add_f32_dpp v96, v96, v96 row_mirror row_mask:0xf bank_mask:0xf
    v_add_f32_dpp v97, v97, v97 row_mirror row_mask:0xf bank_mask:0xf
    v_mov_b32 v6, v96
    v_mov_b32 v7, v97
    s_nop 0
    v_permlane16_swap_b32 v96, v6
    v_permlane16_swap_b32 v97, v7
    v_add_f32 v96, v96, v6
    v_add_f32 v97, v97, v7
    v_mul_f32 v96, 0x3ae38e39, v96
    v_mul_f32 v97, 0x3ae38e39, v97
    v_fma_f32 v97, -v96, v96, v97
    v_max_f32 v97, 0, v97
    v_add_f32 v97, 0x3727c5ac, v97
    s_waitcnt vmcnt(19)
    s_barrier
    s_add_u32 m0, s41, 16384
    s_mov_b32 s38, 384
    buffer_load_dwordx4 v10, s[4:7], s38 offen lds
    s_add_u32 m0, s41, 17408
    s_mov_b32 s38, 384
    buffer_load_dwordx4 v11, s[4:7], s38 offen lds
    s_add_u32 m0, s41, 24576
    s_mov_b32 s38, 74112
    buffer_load_dwordx4 v10, s[4:7], s38 offen lds
    s_add_u32 m0, s41, 25600
    s_mov_b32 s38, 74112
    buffer_load_dwordx4 v11, s[4:7], s38 offen lds
    s_add_u32 m0, s40, 49152
    s_mov_b32 s38, 2064384
    buffer_load_dwordx4 v16, s[8:11], s38 offen lds
    s_add_u32 m0, s40, 50176
    s_mov_b32 s38, 2064384
    buffer_load_dwordx4 v17, s[8:11], s38 offen lds
    s_add_u32 m0, s40, 51200
    s_mov_b32 s38, 2064384
    buffer_load_dwordx4 v18, s[8:11], s38 offen lds
    s_add_u32 m0, s40, 61440
    s_mov_b32 s38, 2064768
    buffer_load_dwordx4 v16, s[8:11], s38 offen lds
    s_add_u32 m0, s40, 62464
    s_mov_b32 s38, 2064768
    buffer_load_dwordx4 v17, s[8:11], s38 offen lds
    s_add_u32 m0, s40, 63488
    s_mov_b32 s38, 2064768
    buffer_load_dwordx4 v18, s[8:11], s38 offen lds
    s_waitcnt vmcnt(16)
    s_mov_b32 s55, 0
L_nl2:
    v_readfirstlane_b32 s46, v98
    s_add_u32 s55, s55, 1
    s_cmp_lg_u32 s46, 0
    s_cbranch_scc1 L_nw2
    s_cmp_ge_u32 s55, 1048576
    s_cbranch_scc1 L_nw2
    buffer_load_dword v98, v2, s[24:27], 0 offen sc1
    s_waitcnt vmcnt(0)
    s_branch L_nl2
L_nw2:
    s_not_b32 s47, s46
    s_mov_b32 exec_lo, 1
    s_mov_b32 exec_hi, 1
    buffer_store_dwordx4 v[96:99], v108, s[16:19], s77 offen sc1
    s_mov_b64 exec, -1
    v_lshlrev_b32 v76, 16, v40
    v_and_b32 v77, s52, v40
    v_lshlrev_b32 v78, 16, v41
    v_and_b32 v79, s52, v41
    v_lshlrev_b32 v80, 16, v42
    v_and_b32 v81, s52, v42
    v_lshlrev_b32 v82, 16, v43
    v_and_b32 v83, s52, v43
    v_lshlrev_b32 v4, 16, v44
    v_and_b32 v5, s52, v44
    v_add_f32 v76, v76, v4
    v_add_f32 v77, v77, v5
    v_lshlrev_b32 v6, 16, v45
    v_and_b32 v7, s52, v45
    v_add_f32 v78, v78, v6
    v_add_f32 v79, v79, v7
    v_lshlrev_b32 v4, 16, v46
    v_and_b32 v5, s52, v46
    v_add_f32 v80, v80, v4
    v_add_f32 v81, v81, v5
    v_lshlrev_b32 v6, 16, v47
    v_and_b32 v7, s52, v47
    v_add_f32 v82, v82, v6
    v_add_f32 v83, v83, v7
    v_lshlrev_b32 v4, 16, v48
    v_and_b32 v5, s52, v48
    v_add_f32 v76, v76, v4
    v_add_f32 v77, v77, v5
    v_lshlrev_b32 v6, 16, v49
    v_and_b32 v7, s52, v49
    v_add_f32 v78, v78, v6
    v_add_f32 v79, v79, v7
    v_lshlrev_b32 v4, 16, v50
    v_and_b32 v5, s52, v50
    v_add_f32 v80, v80, v4
    v_add_f32 v81, v81, v5
    v_lshlrev_b32 v6, 16, v51
    v_and_b32 v7, s52, v51
    v_add_f32 v82, v82, v6
    v_add_f32 v83, v83, v7
    s_barrier
    s_add_u32 m0, s40, 73728
    s_mov_b32 s38, 2359296
    buffer_load_dwordx4 v16, s[8:11], s38 offen lds
    s_add_u32 m0, s40, 74752
    s_mov_b32 s38, 2359296
    buffer_load_dwordx4 v17, s[8:11], s38 offen lds
    s_add_u32 m0, s40, 75776
    s_mov_b32 s38, 2359296
    buffer_load_dwordx4 v18, s[8:11], s38 offen lds
    s_add_u32 m0, s40, 86016
    s_mov_b32 s38, 2359680
    buffer_load_dwordx4 v16, s[8:11], s38 offen lds
    s_add_u32 m0, s40, 87040
    s_mov_b32 s38, 2359680
    buffer_load_dwordx4 v17, s[8:11], s38 offen lds
    s_add_u32 m0, s40, 88064
    s_mov_b32 s38, 2359680
    buffer_load_dwordx4 v18, s[8:11], s38 offen lds
    v_lshlrev_b32 v4, 16, v52
    v_and_b32 v5, s52, v52
    v_add_f32 v76, v76, v4
    v_add_f32 v77, v77, v5
    v_lshlrev_b32 v6, 16, v53
    v_and_b32 v7, s52, v53
    v_add_f32 v78, v78, v6
    v_add_f32 v79, v79, v7
    v_lshlrev_b32 v4, 16, v54
    v_and_b32 v5, s52, v54
    v_add_f32 v80, v80, v4
    v_add_f32 v81, v81, v5
    v_lshlrev_b32 v6, 16, v55
    v_and_b32 v7, s52, v55
    v_add_f32 v82, v82, v6
    v_add_f32 v83, v83, v7
    v_lshlrev_b32 v4, 16, v56
    v_and_b32 v5, s52, v56
    v_add_f32 v76, v76, v4
    v_add_f32 v77, v77, v5
    v_lshlrev_b32 v6, 16, v57
    v_and_b32 v7, s52, v57
    v_add_f32 v78, v78, v6
    v_add_f32 v79, v79, v7
    v_lshlrev_b32 v4, 16, v58
    v_and_b32 v5, s52, v58
    v_add_f32 v80, v80, v4
    v_add_f32 v81, v81, v5
    v_lshlrev_b32 v6, 16, v59
    v_and_b32 v7, s52, v59
    v_add_f32 v82, v82, v6
    v_add_f32 v83, v83, v7
    v_lshlrev_b32 v4, 16, v60
    v_and_b32 v5, s52, v60
    v_add_f32 v76, v76, v4
    v_add_f32 v77, v77, v5
    v_lshlrev_b32 v6, 16, v61
    v_and_b32 v7, s52, v61
    v_add_f32 v78, v78, v6
    v_add_f32 v79, v79, v7
    v_lshlrev_b32 v4, 16, v62
    v_and_b32 v5, s52, v62
    v_add_f32 v80, v80, v4
    v_add_f32 v81, v81, v5
    v_lshlrev_b32 v6, 16, v63
    v_and_b32 v7, s52, v63
    v_add_f32 v82, v82, v6
    v_add_f32 v83, v83, v7
    v_lshlrev_b32 v4, 16, v64
    v_and_b32 v5, s52, v64
    v_add_f32 v76, v76, v4
    v_add_f32 v77, v77, v5
    v_lshlrev_b32 v6, 16, v65
    v_and_b32 v7, s52, v65
    v_add_f32 v78, v78, v6
    v_add_f32 v79, v79, v7
    v_lshlrev_b32 v4, 16, v66
    v_and_b32 v5, s52, v66
    v_add_f32 v80, v80, v4
    v_add_f32 v81, v81, v5
    v_lshlrev_b32 v6, 16, v67
    v_and_b32 v7, s52, v67
    v_add_f32 v82, v82, v6
    v_add_f32 v83, v83, v7
    s_waitcnt vmcnt(13)
    s_barrier
    s_add_u32 m0, s41, 0
    s_mov_b32 s38, 512
    buffer_load_dwordx4 v10, s[4:7], s38 offen lds
    s_add_u32 m0, s41, 1024
    s_mov_b32 s38, 512
    buffer_load_dwordx4 v11, s[4:7], s38 offen lds
    s_add_u32 m0, s41, 8192
    s_mov_b32 s38, 74240
    buffer_load_dwordx4 v10, s[4:7], s38 offen lds
    s_add_u32 m0, s41, 9216
    s_mov_b32 s38, 74240
    buffer_load_dwordx4 v11, s[4:7], s38 offen lds
    s_add_u32 m0, s40, 98304
    s_mov_b32 s38, 2654208
    buffer_load_dwordx4 v16, s[8:11], s38 offen lds
    s_add_u32 m0, s40, 99328
    s_mov_b32 s38, 2654208
    buffer_load_dwordx4 v17, s[8:11], s38 offen lds
    s_add_u32 m0, s40, 100352
    s_mov_b32 s38, 2654208
    buffer_load_dwordx4 v18, s[8:11], s38 offen lds
    s_add_u32 m0, s40, 110592
    s_mov_b32 s38, 2654592
    buffer_load_dwordx4 v16, s[8:11], s38 offen lds
    s_add_u32 m0, s40, 111616
    s_mov_b32 s38, 2654592
    buffer_load_dwordx4 v17, s[8:11], s38 offen lds
    s_add_u32 m0, s40, 112640
    s_mov_b32 s38, 2654592
    buffer_load_dwordx4 v18, s[8:11], s38 offen lds
    v_lshlrev_b32 v4, 16, v68
    v_and_b32 v5, s52, v68
    v_add_f32 v76, v76, v4
    v_add_f32 v77, v77, v5
    v_lshlrev_b32 v6, 16, v69
    v_and_b32 v7, s52, v69
    v_add_f32 v78, v78, v6
    v_add_f32 v79, v79, v7
    v_lshlrev_b32 v4, 16, v70
    v_and_b32 v5, s52, v70
    v_add_f32 v80, v80, v4
    v_add_f32 v81, v81, v5
    v_lshlrev_b32 v6, 16, v71
    v_and_b32 v7, s52, v71
    v_add_f32 v82, v82, v6
    v_add_f32 v83, v83, v7
    v_lshlrev_b32 v4, 16, v72
    v_and_b32 v5, s52, v72
    v_add_f32 v76, v76, v4
    v_add_f32 v77, v77, v5
    v_lshlrev_b32 v6, 16, v73
    v_and_b32 v7, s52, v73
    v_add_f32 v78, v78, v6
    v_add_f32 v79, v79, v7
    v_lshlrev_b32 v4, 16, v74
    v_and_b32 v5, s52, v74
    v_add_f32 v80, v80, v4
    v_add_f32 v81, v81, v5
    v_lshlrev_b32 v6, 16, v75
    v_and_b32 v7, s52, v75
    v_add_f32 v82, v82, v6
    v_add_f32 v83, v83, v7
    s_mov_b32 exec_hi, 0xffff
    ds_write_b128 v102, v[76:79]
    ds_write_b128 v102, v[80:83] offset:16
    s_mov_b32 exec_hi, -1
    buffer_load_dword v23, v21, s[12:15], s59 offen
    s_waitcnt vmcnt(18) lgkmcnt(0)
    s_barrier
    ds_read_b128 v[40:43], v103 offset:0
    ds_read_b128 v[44:47], v103 offset:1536
    ds_read_b128 v[48:51], v103 offset:3072
    ds_read_b128 v[52:55], v103 offset:4608
    s_add_u32 m0, s40, 0
    s_mov_b32 s38, 2949120
    buffer_load_dwordx4 v16, s[8:11], s38 offen lds
    s_add_u32 m0, s40, 1024
    s_mov_b32 s38, 2949120
    buffer_load_dwordx4 v17, s[8:11], s38 offen lds
    s_add_u32 m0, s40, 2048
    s_mov_b32 s38, 2949120
    buffer_load_dwordx4 v18, s[8:11], s38 offen lds
    s_add_u32 m0, s40, 12288
    s_mov_b32 s38, 2949504
    buffer_load_dwordx4 v16, s[8:11], s38 offen lds
    s_add_u32 m0, s40, 13312
    s_mov_b32 s38, 2949504
    buffer_load_dwordx4 v17, s[8:11], s38 offen lds
    s_add_u32 m0, s40, 14336
    s_mov_b32 s38, 2949504
    buffer_load_dwordx4 v18, s[8:11], s38 offen lds
    s_waitcnt lgkmcnt(0)
    v_add_f32 v40, v40, v44
    v_add_f32 v48, v48, v52
    v_add_f32 v41, v41, v45
    v_add_f32 v49, v49, v53
    v_add_f32 v42, v42, v46
    v_add_f32 v50, v50, v54
    v_add_f32 v43, v43, v47
    v_add_f32 v51, v51, v55
    v_add_f32 v40, v40, v48
    v_add_f32 v41, v41, v49
    v_add_f32 v42, v42, v50
    v_add_f32 v43, v43, v51
    buffer_store_dwordx4 v[40:43], v104, s[16:19], s76 offen sc1
    v_mov_b32 v164, 157440
    v_mov_b32 v165, s46
    ds_write_b32 v164, v165
    s_waitcnt vmcnt(14) lgkmcnt(0)
    s_barrier
    s_add_u32 m0, s41, 16384
    s_mov_b32 s38, 640
    buffer_load_dwordx4 v10, s[4:7], s38 offen lds
    s_add_u32 m0, s41, 17408
    s_mov_b32 s38, 640
    buffer_load_dwordx4 v11, s[4:7], s38 offen lds
    s_add_u32 m0, s41, 24576
    s_mov_b32 s38, 74368
    buffer_load_dwordx4 v10, s[4:7], s38 offen lds
    s_add_u32 m0, s41, 25600
    s_mov_b32 s38, 74368
    buffer_load_dwordx4 v11, s[4:7], s38 offen lds
    s_add_u32 m0, s40, 24576
    s_mov_b32 s38, 3244032
    buffer_load_dwordx4 v16, s[8:11], s38 offen lds
    s_add_u32 m0, s40, 25600
    s_mov_b32 s38, 3244032
    buffer_load_dwordx4 v17, s[8:11], s38 offen lds
    s_add_u32 m0, s40, 26624
    s_mov_b32 s38, 3244032
    buffer_load_dwordx4 v18, s[8:11], s38 offen lds
    s_add_u32 m0, s40, 36864
    s_mov_b32 s38, 3244416
    buffer_load_dwordx4 v16, s[8:11], s38 offen lds
    s_add_u32 m0, s40, 37888
    s_mov_b32 s38, 3244416
    buffer_load_dwordx4 v17, s[8:11], s38 offen lds
    s_add_u32 m0, s40, 38912
    s_mov_b32 s38, 3244416
    buffer_load_dwordx4 v18, s[8:11], s38 offen lds
    buffer_load_dword v23, v21, s[12:15], s60 offen
    s_waitcnt vmcnt(19)
    s_barrier
    s_add_u32 m0, s40, 49152
    s_mov_b32 s38, 3538944
    buffer_load_dwordx4 v16, s[8:11], s38 offen lds
    s_add_u32 m0, s40, 50176
    s_mov_b32 s38, 3538944
    buffer_load_dwordx4 v17, s[8:11], s38 offen lds
    s_add_u32 m0, s40, 51200
    s_mov_b32 s38, 3538944
    buffer_load_dwordx4 v18, s[8:11], s38 offen lds
    s_add_u32 m0, s40, 61440
    s_mov_b32 s38, 3539328
    buffer_load_dwordx4 v16, s[8:11], s38 offen lds
    s_add_u32 m0, s40, 62464
    s_mov_b32 s38, 3539328
    buffer_load_dwordx4 v17, s[8:11], s38 offen lds
    s_add_u32 m0, s40, 63488
    s_mov_b32 s38, 3539328
    buffer_load_dwordx4 v18, s[8:11], s38 offen lds
    s_waitcnt vmcnt(17)
    v_mov_b32 v12, s46
    s_add_u32 s54, s47, 1
    v_mov_b32 v13, s54
    s_mov_b64 exec, 1
    buffer_store_dwordx2 v[12:13], v2, s[16:19], s84 offen offset:1024 sc1
    s_mov_b64 exec, -1
    s_waitcnt vmcnt(14)
    s_barrier
    s_add_u32 m0, s41, 0
    s_mov_b32 s38, 768
    buffer_load_dwordx4 v10, s[4:7], s38 offen lds
    s_add_u32 m0, s41, 1024
    s_mov_b32 s38, 768
    buffer_load_dwordx4 v11, s[4:7], s38 offen lds
    s_add_u32 m0, s41, 8192
    s_mov_b32 s38, 74496
    buffer_load_dwordx4 v10, s[4:7], s38 offen lds
    s_add_u32 m0, s41, 9216
    s_mov_b32 s38, 74496
    buffer_load_dwordx4 v11, s[4:7], s38 offen lds
    s_add_u32 m0, s40, 73728
    s_mov_b32 s38, 3833856
    buffer_load_dwordx4 v16, s[8:11], s38 offen lds
    s_add_u32 m0, s40, 74752
    s_mov_b32 s38, 3833856
    buffer_load_dwordx4 v17, s[8:11], s38 offen lds
    s_add_u32 m0, s40, 75776
    s_mov_b32 s38, 3833856
    buffer_load_dwordx4 v18, s[8:11], s38 offen lds
    s_add_u32 m0, s40, 86016
    s_mov_b32 s38, 3834240
    buffer_load_dwordx4 v16, s[8:11], s38 offen lds
    s_add_u32 m0, s40, 87040
    s_mov_b32 s38, 3834240
    buffer_load_dwordx4 v17, s[8:11], s38 offen lds
    s_add_u32 m0, s40, 88064
    s_mov_b32 s38, 3834240
    buffer_load_dwordx4 v18, s[8:11], s38 offen lds
    buffer_load_dword v23, v21, s[12:15], s61 offen
    buffer_load_dword v23, v22, s[68:71], s64 offen
    s_getpc_b64 s[94:95]
L_cpfF:
    s_sub_u32 s94, s94, L_cpfF-L_tgtF
    s_subb_u32 s95, s95, 0
    s_bfe_u32 s54, s2, 0x30005
    s_lshl_b32 s54, s54, 2
    s_add_u32 s54, s54, s32
    s_lshl_b32 s54, s54, 10
    v_and_b32 v14, 7, v3
    v_lshlrev_b32 v14, 7, v14
    v_add_u32 v14, s54, v14
    v_min_u32 v14, CODE_F, v14
    global_load_dword v23, v14, s[94:95]
    s_waitcnt vmcnt(21)
    s_barrier
    s_add_u32 m0, s40, 98304
    s_mov_b32 s38, 4128768
    buffer_load_dwordx4 v16, s[8:11], s38 offen lds
    s_add_u32 m0, s40, 99328
    s_mov_b32 s38, 4128768
    buffer_load_dwordx4 v17, s[8:11], s38 offen lds
    s_add_u32 m0, s40, 100352
    s_mov_b32 s38, 4128768
    buffer_load_dwordx4 v18, s[8:11], s38 offen lds
    s_add_u32 m0, s40, 110592
    s_mov_b32 s38, 4129152
    buffer_load_dwordx4 v16, s[8:11], s38 offen lds
    s_add_u32 m0, s40, 111616
    s_mov_b32 s38, 4129152
    buffer_load_dwordx4 v17, s[8:11], s38 offen lds
    s_add_u32 m0, s40, 112640
    s_mov_b32 s38, 4129152
    buffer_load_dwordx4 v18, s[8:11], s38 offen lds
    buffer_load_dwordx4 v[84:87], v106, s[16:19], 0 offen sc1
    buffer_load_dwordx2 v[12:13], v105, s[16:19], s86 offen offset:0 sc1
    s_waitcnt vmcnt(17)
    s_barrier
    s_add_u32 m0, s41, 16384
    s_mov_b32 s38, 896
    buffer_load_dwordx4 v10, s[4:7], s38 offen lds
    s_add_u32 m0, s41, 17408
    s_mov_b32 s38, 896
    buffer_load_dwordx4 v11, s[4:7], s38 offen lds
    s_add_u32 m0, s41, 24576
    s_mov_b32 s38, 74624
    buffer_load_dwordx4 v10, s[4:7], s38 offen lds
    s_add_u32 m0, s41, 25600
    s_mov_b32 s38, 74624
    buffer_load_dwordx4 v11, s[4:7], s38 offen lds
    s_add_u32 m0, s40, 0
    s_mov_b32 s38, 4423680
    buffer_load_dwordx4 v16, s[8:11], s38 offen lds
    s_add_u32 m0, s40, 1024
    s_mov_b32 s38, 4423680
    buffer_load_dwordx4 v17, s[8:11], s38 offen lds
    s_add_u32 m0, s40, 2048
    s_mov_b32 s38, 4423680
    buffer_load_dwordx4 v18, s[8:11], s38 offen lds
    s_add_u32 m0, s40, 12288
    s_mov_b32 s38, 4424064
    buffer_load_dwordx4 v16, s[8:11], s38 offen lds
    s_add_u32 m0, s40, 13312
    s_mov_b32 s38, 4424064
    buffer_load_dwordx4 v17, s[8:11], s38 offen lds
    s_add_u32 m0, s40, 14336
    s_mov_b32 s38, 4424064
    buffer_load_dwordx4 v18, s[8:11], s38 offen lds
    s_waitcnt vmcnt(21)
    s_barrier
    s_add_u32 m0, s40, 24576
    s_mov_b32 s38, 4718592
    buffer_load_dwordx4 v16, s[8:11], s38 offen lds
    s_add_u32 m0, s40, 25600
    s_mov_b32 s38, 4718592
    buffer_load_dwordx4 v17, s[8:11], s38 offen lds
    s_add_u32 m0, s40, 26624
    s_mov_b32 s38, 4718592
    buffer_load_dwordx4 v18, s[8:11], s38 offen lds
    s_add_u32 m0, s40, 36864
    s_mov_b32 s38, 4718976
    buffer_load_dwordx4 v16, s[8:11], s38 offen lds
    s_add_u32 m0, s40, 37888
    s_mov_b32 s38, 4718976
    buffer_load_dwordx4 v17, s[8:11], s38 offen lds
    s_add_u32 m0, s40, 38912
    s_mov_b32 s38, 4718976
    buffer_load_dwordx4 v18, s[8:11], s38 offen lds
    s_waitcnt vmcnt(16)
    s_mov_b32 s55, 0
    s_add_u32 s54, s47, 1
L_poll3:
    v_xor_b32 v12, s46, v12
    v_subrev_u32 v13, s54, v13
    v_and_b32 v13, -8, v13
    v_or_b32 v12, v12, v13
    v_cmp_ne_u32 vcc, 0, v12
    s_add_u32 s55, s55, 1
    s_nop 0
    s_cmp_eq_u64 vcc, 0
    s_cbranch_scc1 L_pollx3
    s_cmp_ge_u32 s55, 1048576
    s_cbranch_scc1 L_pollx3
    buffer_load_dwordx2 v[12:13], v105, s[16:19], s86 offen offset:0 sc1
    s_waitcnt vmcnt(0)
    s_branch L_poll3
L_pollx3:
    s_add_u32 s54, s85, 0
    buffer_load_dwordx4 v[40:43], v1, s[16:19], s54 offen offset:0 sc1
    buffer_load_dwordx4 v[44:47], v1, s[16:19], s54 offen offset:1024 sc1
    s_add_u32 s54, s85, 2048
    buffer_load_dwordx4 v[48:51], v1, s[16:19], s54 offen offset:0 sc1
    buffer_load_dwordx4 v[52:55], v1, s[16:19], s54 offen offset:1024 sc1
    s_add_u32 s54, s85, 4096
    buffer_load_dwordx4 v[56:59], v1, s[16:19], s54 offen offset:0 sc1
    buffer_load_dwordx4 v[60:63], v1, s[16:19], s54 offen offset:1024 sc1
    s_add_u32 s54, s85, 6144
    buffer_load_dwordx4 v[64:67], v1, s[16:19], s54 offen offset:0 sc1
    buffer_load_dwordx4 v[68:71], v1, s[16:19], s54 offen offset:1024 sc1
    s_mov_b32 s55, 0
L_st4:
    v_cmp_ne_u32 vcc, s46, v86
    s_add_u32 s55, s55, 1
    s_nop 0
    s_cmp_eq_u64 vcc, 0
    s_cbranch_scc1 L_stx4
    s_cmp_ge_u32 s55, 1048576
    s_cbranch_scc1 L_stx4
    buffer_load_dwordx4 v[84:87], v106, s[16:19], 0 offen sc1
    s_waitcnt vmcnt(0)
    s_branch L_st4
L_stx4:
    ds_write_b64 v107, v[84:85]
    s_waitcnt vmcnt(20) lgkmcnt(0)
    s_barrier
    s_add_u32 m0, s41, 0
    s_mov_b32 s38, 1024
    buffer_load_dwordx4 v10, s[4:7], s38 offen lds
    s_add_u32 m0, s41, 1024
    s_mov_b32 s38, 1024
    buffer_load_dwordx4 v11, s[4:7], s38 offen lds
    s_add_u32 m0, s41, 8192
    s_mov_b32 s38, 74752
    buffer_load_dwordx4 v10, s[4:7], s38 offen lds
    s_add_u32 m0, s41, 9216
    s_mov_b32 s38, 74752
    buffer_load_dwordx4 v11, s[4:7], s38 offen lds
    s_add_u32 m0, s40, 49152
    s_mov_b32 s38, 5013504
    buffer_load_dwordx4 v16, s[8:11], s38 offen lds
    s_add_u32 m0, s40, 50176
    s_mov_b32 s38, 5013504
    buffer_load_dwordx4 v17, s[8:11], s38 offen lds
    s_add_u32 m0, s40, 51200
    s_mov_b32 s38, 5013504
    buffer_load_dwordx4 v18, s[8:11], s38 offen lds
    s_add_u32 m0, s40, 61440
    s_mov_b32 s38, 5013888
    buffer_load_dwordx4 v16, s[8:11], s38 offen lds
    s_add_u32 m0, s40, 62464
    s_mov_b32 s38, 5013888
    buffer_load_dwordx4 v17, s[8:11], s38 offen lds
    s_add_u32 m0, s40, 63488
    s_mov_b32 s38, 5013888
    buffer_load_dwordx4 v18, s[8:11], s38 offen lds
    s_waitcnt vmcnt(24)
    s_barrier
    s_waitcnt vmcnt(10)
    v_add_f32 v40, v40, v56
    v_add_f32 v41, v41, v57
    v_add_f32 v42, v42, v58
    v_add_f32 v43, v43, v59
    v_add_f32 v44, v44, v60
    v_add_f32 v45, v45, v61
    v_add_f32 v46, v46, v62
    v_add_f32 v47, v47, v63
    v_add_f32 v48, v48, v64
    v_add_f32 v49, v49, v65
    v_add_f32 v50, v50, v66
    v_add_f32 v51, v51, v67
    v_add_f32 v52, v52, v68
    v_add_f32 v53, v53, v69
    v_add_f32 v54, v54, v70
    v_add_f32 v55, v55, v71
    v_add_f32 v40, v40, v48
    v_add_f32 v41, v41, v49
    v_add_f32 v42, v42, v50
    v_add_f32 v43, v43, v51
    v_add_f32 v44, v44, v52
    v_add_f32 v45, v45, v53
    v_add_f32 v46, v46, v54
    v_add_f32 v47, v47, v55
    ds_write_b128 v15, v[40:43]
    s_mov_b32 exec_lo, 0xffffffff
    s_mov_b32 exec_hi, 0x0
    ds_write_b128 v15, v[44:47] offset:1024
    s_mov_b64 exec, -1
    s_add_u32 m0, s40, 73728
    s_add_u32 s38, s59, 0
    buffer_load_dwordx4 v19, s[12:15], s38 offen lds
    s_add_u32 m0, s40, 74752
    s_add_u32 s38, s59, 9216
    buffer_load_dwordx4 v19, s[12:15], s38 offen lds
    s_add_u32 m0, s40, 75776
    s_add_u32 s38, s59, 18432
    buffer_load_dwordx4 v19, s[12:15], s38 offen lds
    s_add_u32 m0, s40, 86016
    s_add_u32 s38, s59, 221184
    buffer_load_dwordx4 v19, s[12:15], s38 offen lds
    s_add_u32 m0, s40, 87040
    s_add_u32 s38, s59, 230400
    buffer_load_dwordx4 v19, s[12:15], s38 offen lds
    s_add_u32 m0, s40, 88064
    s_add_u32 s38, s59, 239616
    buffer_load_dwordx4 v19, s[12:15], s38 offen lds
    s_waitcnt vmcnt(12) lgkmcnt(0)
    s_barrier
    s_add_u32 m0, s40, 98304
    s_add_u32 s38, s59, 128
    buffer_load_dwordx4 v19, s[12:15], s38 offen lds
    s_add_u32 m0, s40, 99328
    s_add_u32 s38, s59, 9344
    buffer_load_dwordx4 v19, s[12:15], s38 offen lds
    s_add_u32 m0, s40, 100352
    s_add_u32 s38, s59, 18560
    buffer_load_dwordx4 v19, s[12:15], s38 offen lds
    s_add_u32 m0, s40, 110592
    s_add_u32 s38, s59, 221312
    buffer_load_dwordx4 v19, s[12:15], s38 offen lds
    s_add_u32 m0, s40, 111616
    s_add_u32 s38, s59, 230528
    buffer_load_dwordx4 v19, s[12:15], s38 offen lds
    s_add_u32 m0, s40, 112640
    s_add_u32 s38, s59, 239744
    buffer_load_dwordx4 v19, s[12:15], s38 offen lds
    s_waitcnt vmcnt(12)
    s_barrier
    s_add_u32 m0, s40, 0
    s_add_u32 s38, s59, 110592
    buffer_load_dwordx4 v19, s[12:15], s38 offen lds
    s_add_u32 m0, s40, 1024
    s_add_u32 s38, s59, 119808
    buffer_load_dwordx4 v19, s[12:15], s38 offen lds
    s_add_u32 m0, s40, 2048
    s_add_u32 s38, s59, 129024
    buffer_load_dwordx4 v19, s[12:15], s38 offen lds
    s_add_u32 m0, s40, 12288
    s_add_u32 s38, s59, 331776
    buffer_load_dwordx4 v19, s[12:15], s38 offen lds
    s_add_u32 m0, s40, 13312
    s_add_u32 s38, s59, 340992
    buffer_load_dwordx4 v19, s[12:15], s38 offen lds
    s_add_u32 m0, s40, 14336
    s_add_u32 s38, s59, 350208
    buffer_load_dwordx4 v19, s[12:15], s38 offen lds
    s_waitcnt vmcnt(12)
    s_barrier
    s_lshl_b32 s34, s32, 28
    s_add_u32 s88, s88, s34
    s_lshl_b32 s34, s30, 4
    s_add_u32 s34, s34, s29
    s_and_b32 s35, s32, 2
    s_lshl_b32 s35, s35, 1
    s_add_u32 s34, s34, s35
    s_lshl_b32 s34, s34, 7
    s_add_u32 s63, s62, s34
    s_barrier
    s_waitcnt vmcnt(6)
    s_barrier
    s_add_u32 m0, s40, 24576
    s_add_u32 s38, s59, 110720
    buffer_load_dwordx4 v19, s[12:15], s38 offen lds
    s_add_u32 m0, s40, 25600
    s_add_u32 s38, s59, 119936
    buffer_load_dwordx4 v19, s[12:15], s38 offen lds
    s_add_u32 m0, s40, 26624
    s_add_u32 s38, s59, 129152
    buffer_load_dwordx4 v19, s[12:15], s38 offen lds
    s_add_u32 m0, s40, 36864
    s_add_u32 s38, s59, 331904
    buffer_load_dwordx4 v19, s[12:15], s38 offen lds
    s_add_u32 m0, s40, 37888
    s_add_u32 s38, s59, 341120
    buffer_load_dwordx4 v19, s[12:15], s38 offen lds
    s_add_u32 m0, s40, 38912
    s_add_u32 s38, s59, 350336
    buffer_load_dwordx4 v19, s[12:15], s38 offen lds
    s_mul_i32 s44, s97, 49152
    s_add_u32 s44, s44, s42
    s_lshl_b32 s34, s97, 11
    s_add_u32 s76, s62, s34
    s_mul_i32 s45, s96, 49152
    s_add_u32 s45, s45, s42
    s_lshl_b32 s34, s96, 11
    s_add_u32 s77, s62, s34
    s_mul_i32 s36, s98, 49152
    s_add_u32 s36, s36, s42
    s_lshl_b32 s34, s98, 11
    s_add_u32 s65, s62, s34
    s_waitcnt vmcnt(6)
    s_barrier
    s_add_u32 m0, s40, 73728
    s_add_u32 s38, s59, 110848
    buffer_load_dwordx4 v19, s[12:15], s38 offen lds
    s_add_u32 m0, s40, 74752
    s_add_u32 s38, s59, 120064
    buffer_load_dwordx4 v19, s[12:15], s38 offen lds
    s_add_u32 m0, s40, 75776
    s_add_u32 s38, s59, 129280
    buffer_load_dwordx4 v19, s[12:15], s38 offen lds
    s_add_u32 m0, s40, 86016
    s_add_u32 s38, s59, 332032
    buffer_load_dwordx4 v19, s[12:15], s38 offen lds
    s_add_u32 m0, s40, 87040
    s_add_u32 s38, s59, 341248
    buffer_load_dwordx4 v19, s[12:15], s38 offen lds
    s_add_u32 m0, s40, 88064
    s_add_u32 s38, s59, 350464
    buffer_load_dwordx4 v19, s[12:15], s38 offen lds
    s_barrier
    s_waitcnt vmcnt(6)
    s_barrier
    s_add_u32 m0, s40, 49152
    s_add_u32 s38, s59, 256
    buffer_load_dwordx4 v19, s[12:15], s38 offen lds
    s_add_u32 m0, s40, 50176
    s_add_u32 s38, s59, 9472
    buffer_load_dwordx4 v19, s[12:15], s38 offen lds
    s_add_u32 m0, s40, 51200
    s_add_u32 s38, s59, 18688
    buffer_load_dwordx4 v19, s[12:15], s38 offen lds
    s_add_u32 m0, s40, 61440
    s_add_u32 s38, s59, 221440
    buffer_load_dwordx4 v19, s[12:15], s38 offen lds
    s_add_u32 m0, s40, 62464
    s_add_u32 s38, s59, 230656
    buffer_load_dwordx4 v19, s[12:15], s38 offen lds
    s_add_u32 m0, s40, 63488
    s_add_u32 s38, s59, 239872
    buffer_load_dwordx4 v19, s[12:15], s38 offen lds
    s_add_u32 m0, s40, 98304
    s_add_u32 s38, s60, 0
    buffer_load_dwordx4 v19, s[12:15], s38 offen lds
    s_add_u32 m0, s40, 99328
    s_add_u32 s38, s60, 9216
    buffer_load_dwordx4 v19, s[12:15], s38 offen lds
    s_add_u32 m0, s40, 100352
    s_add_u32 s38, s60, 18432
    buffer_load_dwordx4 v19, s[12:15], s38 offen lds
    s_add_u32 m0, s40, 110592
    s_add_u32 s38, s60, 221184
    buffer_load_dwordx4 v19, s[12:15], s38 offen lds
    s_add_u32 m0, s40, 111616
    s_add_u32 s38, s60, 230400
    buffer_load_dwordx4 v19, s[12:15], s38 offen lds
    s_add_u32 m0, s40, 112640
    s_add_u32 s38, s60, 239616
    buffer_load_dwordx4 v19, s[12:15], s38 offen lds
    s_waitcnt vmcnt(6)
    s_barrier
    s_add_u32 m0, s40, 0
    s_add_u32 s38, s60, 110592
    buffer_load_dwordx4 v19, s[12:15], s38 offen lds
    s_add_u32 m0, s40, 1024
    s_add_u32 s38, s60, 119808
    buffer_load_dwordx4 v19, s[12:15], s38 offen lds
    s_add_u32 m0, s40, 2048
    s_add_u32 s38, s60, 129024
    buffer_load_dwordx4 v19, s[12:15], s38 offen lds
    s_add_u32 m0, s40, 12288
    s_add_u32 s38, s60, 331776
    buffer_load_dwordx4 v19, s[12:15], s38 offen lds
    s_add_u32 m0, s40, 13312
    s_add_u32 s38, s60, 340992
    buffer_load_dwordx4 v19, s[12:15], s38 offen lds
    s_add_u32 m0, s40, 14336
    s_add_u32 s38, s60, 350208
    buffer_load_dwordx4 v19, s[12:15], s38 offen lds
    buffer_load_dword v31, v27, s[16:19], 0 offen sc1
    buffer_load_dwordx4 v[140:143], v24, s[4:7], 0 offen offset:0
    buffer_load_dwordx4 v[152:155], v25, s[72:75], 0 offen offset:0
    s_barrier
    s_add_u32 m0, s40, 24576
    s_add_u32 s38, s60, 128
    buffer_load_dwordx4 v19, s[12:15], s38 offen lds
    s_add_u32 m0, s40, 25600
    s_add_u32 s38, s60, 9344
    buffer_load_dwordx4 v19, s[12:15], s38 offen lds
    s_add_u32 m0, s40, 26624
    s_add_u32 s38, s60, 18560
    buffer_load_dwordx4 v19, s[12:15], s38 offen lds
    s_add_u32 m0, s40, 36864
    s_add_u32 s38, s60, 221312
    buffer_load_dwordx4 v19, s[12:15], s38 offen lds
    s_add_u32 m0, s40, 37888
    s_add_u32 s38, s60, 230528
    buffer_load_dwordx4 v19, s[12:15], s38 offen lds
    s_add_u32 m0, s40, 38912
    s_add_u32 s38, s60, 239744
    buffer_load_dwordx4 v19, s[12:15], s38 offen lds
    buffer_load_dwordx4 v[144:147], v24, s[4:7], 0 offen offset:128
    buffer_load_dwordx4 v[156:159], v25, s[72:75], 0 offen offset:128
    s_waitcnt vmcnt(17)
    s_barrier
    s_add_u32 m0, s40, 49152
    s_add_u32 s38, s60, 110720
    buffer_load_dwordx4 v19, s[12:15], s38 offen lds
    s_add_u32 m0, s40, 50176
    s_add_u32 s38, s60, 119936
    buffer_load_dwordx4 v19, s[12:15], s38 offen lds
    s_add_u32 m0, s40, 51200
    s_add_u32 s38, s60, 129152
    buffer_load_dwordx4 v19, s[12:15], s38 offen lds
    s_add_u32 m0, s40, 61440
    s_add_u32 s38, s60, 331904
    buffer_load_dwordx4 v19, s[12:15], s38 offen lds
    s_add_u32 m0, s40, 62464
    s_add_u32 s38, s60, 341120
    buffer_load_dwordx4 v19, s[12:15], s38 offen lds
    s_add_u32 m0, s40, 63488
    s_add_u32 s38, s60, 350336
    buffer_load_dwordx4 v19, s[12:15], s38 offen lds
    buffer_load_dwordx4 v[148:151], v24, s[4:7], 0 offen offset:256
    buffer_load_dwordx4 v[160:163], v25, s[72:75], 0 offen offset:256
    s_waitcnt vmcnt(19)
    s_barrier
    s_add_u32 m0, s40, 73728
    s_add_u32 s38, s60, 256
    buffer_load_dwordx4 v19, s[12:15], s38 offen lds
    s_add_u32 m0, s40, 74752
    s_add_u32 s38, s60, 9472
    buffer_load_dwordx4 v19, s[12:15], s38 offen lds
    s_add_u32 m0, s40, 75776
    s_add_u32 s38, s60, 18688
    buffer_load_dwordx4 v19, s[12:15], s38 offen lds
    s_add_u32 m0, s40, 86016
    s_add_u32 s38, s60, 221440
    buffer_load_dwordx4 v19, s[12:15], s38 offen lds
    s_add_u32 m0, s40, 87040
    s_add_u32 s38, s60, 230656
    buffer_load_dwordx4 v19, s[12:15], s38 offen lds
    s_add_u32 m0, s40, 88064
    s_add_u32 s38, s60, 239872
    buffer_load_dwordx4 v19, s[12:15], s38 offen lds
    s_waitcnt vmcnt(16)
    s_barrier
    s_add_u32 m0, s40, 98304
    s_add_u32 s38, s60, 110848
    buffer_load_dwordx4 v19, s[12:15], s38 offen lds
    s_add_u32 m0, s40, 99328
    s_add_u32 s38, s60, 120064
    buffer_load_dwordx4 v19, s[12:15], s38 offen lds
    s_add_u32 m0, s40, 100352
    s_add_u32 s38, s60, 129280
    buffer_load_dwordx4 v19, s[12:15], s38 offen lds
    s_add_u32 m0, s40, 110592
    s_add_u32 s38, s60, 332032
    buffer_load_dwordx4 v19, s[12:15], s38 offen lds
    s_add_u32 m0, s40, 111616
    s_add_u32 s38, s60, 341248
    buffer_load_dwordx4 v19, s[12:15], s38 offen lds
    s_add_u32 m0, s40, 112640
    s_add_u32 s38, s60, 350464
    buffer_load_dwordx4 v19, s[12:15], s38 offen lds
    s_waitcnt vmcnt(12)
    v_lshlrev_b32 v104, 16, v140
    v_and_b32 v105, s52, v140
    v_lshlrev_b32 v4, 16, v152
    v_and_b32 v5, s52, v152
    v_add_f32 v104, v104, v4
    v_add_f32 v105, v105, v5
    v_lshlrev_b32 v106, 16, v141
    v_and_b32 v107, s52, v141
    v_lshlrev_b32 v4, 16, v153
    v_and_b32 v5, s52, v153
    v_add_f32 v106, v106, v4
    v_add_f32 v107, v107, v5
    v_lshlrev_b32 v108, 16, v142
    v_and_b32 v109, s52, v142
    v_lshlrev_b32 v4, 16, v154
    v_and_b32 v5, s52, v154
    v_add_f32 v108, v108, v4
    v_add_f32 v109, v109, v5
    v_lshlrev_b32 v110, 16, v143
    v_and_b32 v111, s52, v143
    v_lshlrev_b32 v4, 16, v155
    v_and_b32 v5, s52, v155
    v_add_f32 v110, v110, v4
    v_add_f32 v111, v111, v5
    v_mul_f32 v104, v104, v31
    v_mul_f32 v105, v105, v31
    v_mul_f32 v106, v106, v31
    v_mul_f32 v107, v107, v31
    v_mul_f32 v108, v108, v31
    v_mul_f32 v109, v109, v31
    v_mul_f32 v110, v110, v31
    v_mul_f32 v111, v111, v31
    v_permlane32_swap_b32 v104, v108
    v_permlane32_swap_b32 v105, v109
    v_permlane32_swap_b32 v106, v110
    v_permlane32_swap_b32 v107, v111
    s_barrier
    v_mov_b32 v32, s46
    s_add_u32 s54, s47, 3
    v_mov_b32 v33, s54
    s_mov_b64 exec, 1
    buffer_store_dwordx2 v[32:33], v2, s[16:19], s88 offen offset:1536 sc1
    s_mov_b64 exec, -1
    s_add_u32 m0, s40, 0
    s_add_u32 s38, s61, 0
    buffer_load_dwordx4 v19, s[12:15], s38 offen lds
    s_add_u32 m0, s40, 1024
    s_add_u32 s38, s61, 9216
    buffer_load_dwordx4 v19, s[12:15], s38 offen lds
    s_add_u32 m0, s40, 2048
    s_add_u32 s38, s61, 18432
    buffer_load_dwordx4 v19, s[12:15], s38 offen lds
    s_add_u32 m0, s40, 12288
    s_add_u32 s38, s61, 221184
    buffer_load_dwordx4 v19, s[12:15], s38 offen lds
    s_add_u32 m0, s40, 13312
    s_add_u32 s38, s61, 230400
    buffer_load_dwordx4 v19, s[12:15], s38 offen lds
    s_add_u32 m0, s40, 14336
    s_add_u32 s38, s61, 239616
    buffer_load_dwordx4 v19, s[12:15], s38 offen lds
    v_lshlrev_b32 v112, 16, v144
    v_and_b32 v113, s52, v144
    v_lshlrev_b32 v4, 16, v156
    v_and_b32 v5, s52, v156
    v_add_f32 v112, v112, v4
    v_add_f32 v113, v113, v5
    v_lshlrev_b32 v114, 16, v145
    v_and_b32 v115, s52, v145
    v_lshlrev_b32 v4, 16, v157
    v_and_b32 v5, s52, v157
    v_add_f32 v114, v114, v4
    v_add_f32 v115, v115, v5
    v_lshlrev_b32 v116, 16, v146
    v_and_b32 v117, s52, v146
    v_lshlrev_b32 v4, 16, v158
    v_and_b32 v5, s52, v158
    v_add_f32 v116, v116, v4
    v_add_f32 v117, v117, v5
    v_lshlrev_b32 v118, 16, v147
    v_and_b32 v119, s52, v147
    v_lshlrev_b32 v4, 16, v159
    v_and_b32 v5, s52, v159
    v_add_f32 v118, v118, v4
    v_add_f32 v119, v119, v5
    v_mul_f32 v112, v112, v31
    v_mul_f32 v113, v113, v31
    v_mul_f32 v114, v114, v31
    v_mul_f32 v115, v115, v31
    v_mul_f32 v116, v116, v31
    v_mul_f32 v117, v117, v31
    v_mul_f32 v118, v118, v31
    v_mul_f32 v119, v119, v31
    v_permlane32_swap_b32 v112, v116
    v_permlane32_swap_b32 v113, v117
    v_permlane32_swap_b32 v114, v118
    v_permlane32_swap_b32 v115, v119
    s_waitcnt vmcnt(13)
    s_barrier
    s_add_u32 m0, s40, 24576
    s_add_u32 s38, s61, 110592
    buffer_load_dwordx4 v19, s[12:15], s38 offen lds
    s_add_u32 m0, s40, 25600
    s_add_u32 s38, s61, 119808
    buffer_load_dwordx4 v19, s[12:15], s38 offen lds
    s_add_u32 m0, s40, 26624
    s_add_u32 s38, s61, 129024
    buffer_load_dwordx4 v19, s[12:15], s38 offen lds
    s_add_u32 m0, s40, 36864
    s_add_u32 s38, s61, 331776
    buffer_load_dwordx4 v19, s[12:15], s38 offen lds
    s_add_u32 m0, s40, 37888
    s_add_u32 s38, s61, 340992
    buffer_load_dwordx4 v19, s[12:15], s38 offen lds
    s_add_u32 m0, s40, 38912
    s_add_u32 s38, s61, 350208
    buffer_load_dwordx4 v19, s[12:15], s38 offen lds
    v_lshlrev_b32 v120, 16, v148
    v_and_b32 v121, s52, v148
    v_lshlrev_b32 v4, 16, v160
    v_and_b32 v5, s52, v160
    v_add_f32 v120, v120, v4
    v_add_f32 v121, v121, v5
    v_lshlrev_b32 v122, 16, v149
    v_and_b32 v123, s52, v149
    v_lshlrev_b32 v4, 16, v161
    v_and_b32 v5, s52, v161
    v_add_f32 v122, v122, v4
    v_add_f32 v123, v123, v5
    v_lshlrev_b32 v124, 16, v150
    v_and_b32 v125, s52, v150
    v_lshlrev_b32 v4, 16, v162
    v_and_b32 v5, s52, v162
    v_add_f32 v124, v124, v4
    v_add_f32 v125, v125, v5
    v_lshlrev_b32 v126, 16, v151
    v_and_b32 v127, s52, v151
    v_lshlrev_b32 v4, 16, v163
    v_and_b32 v5, s52, v163
    v_add_f32 v126, v126, v4
    v_add_f32 v127, v127, v5
    v_mul_f32 v120, v120, v31
    v_mul_f32 v121, v121, v31
    v_mul_f32 v122, v122, v31
    v_mul_f32 v123, v123, v31
    v_mul_f32 v124, v124, v31
    v_mul_f32 v125, v125, v31
    v_mul_f32 v126, v126, v31
    v_mul_f32 v127, v127, v31
    v_permlane32_swap_b32 v120, v124
    v_permlane32_swap_b32 v121, v125
    v_permlane32_swap_b32 v122, v126
    v_permlane32_swap_b32 v123, v127
    s_waitcnt vmcnt(13)
    s_barrier
    s_add_u32 m0, s40, 49152
    s_add_u32 s38, s61, 128
    buffer_load_dwordx4 v19, s[12:15], s38 offen lds
    s_add_u32 m0, s40, 50176
    s_add_u32 s38, s61, 9344
    buffer_load_dwordx4 v19, s[12:15], s38 offen lds
    s_add_u32 m0, s40, 51200
    s_add_u32 s38, s61, 18560
    buffer_load_dwordx4 v19, s[12:15], s38 offen lds
    s_add_u32 m0, s40, 61440
    s_add_u32 s38, s61, 221312
    buffer_load_dwordx4 v19, s[12:15], s38 offen lds
    s_add_u32 m0, s40, 62464
    s_add_u32 s38, s61, 230528
    buffer_load_dwordx4 v19, s[12:15], s38 offen lds
    s_add_u32 m0, s40, 63488
    s_add_u32 s38, s61, 239744
    buffer_load_dwordx4 v19, s[12:15], s38 offen lds
    v_rcp_f32 v31, v31
    buffer_load_dwordx2 v[12:13], v26, s[16:19], s76 offen offset:1536 sc1
    s_waitcnt vmcnt(13)
    s_barrier
    s_add_u32 m0, s40, 73728
    s_add_u32 s38, s61, 110720
    buffer_load_dwordx4 v19, s[12:15], s38 offen lds
    s_add_u32 m0, s40, 74752
    s_add_u32 s38, s61, 119936
    buffer_load_dwordx4 v19, s[12:15], s38 offen lds
    s_add_u32 m0, s40, 75776
    s_add_u32 s38, s61, 129152
    buffer_load_dwordx4 v19, s[12:15], s38 offen lds
    s_add_u32 m0, s40, 86016
    s_add_u32 s38, s61, 331904
    buffer_load_dwordx4 v19, s[12:15], s38 offen lds
    s_add_u32 m0, s40, 87040
    s_add_u32 s38, s61, 341120
    buffer_load_dwordx4 v19, s[12:15], s38 offen lds
    s_add_u32 m0, s40, 88064
    s_add_u32 s38, s61, 350336
    buffer_load_dwordx4 v19, s[12:15], s38 offen lds
    buffer_load_dwordx2 v[28:29], v30, s[16:19], s87 offen offset:0 sc1
    s_waitcnt vmcnt(14)
    s_barrier
    s_add_u32 m0, s40, 98304
    s_add_u32 s38, s64, 0
    buffer_load_dwordx4 v19, s[68:71], s38 offen lds
    s_add_u32 m0, s40, 99328
    s_add_u32 s38, s64, 9216
    buffer_load_dwordx4 v19, s[68:71], s38 offen lds
    s_add_u32 m0, s40, 100352
    s_add_u32 s38, s64, 18432
    buffer_load_dwordx4 v19, s[68:71], s38 offen lds
    s_add_u32 m0, s40, 110592
    s_add_u32 s38, s64, 110592
    buffer_load_dwordx4 v19, s[68:71], s38 offen lds
    s_add_u32 m0, s40, 111616
    s_add_u32 s38, s64, 119808
    buffer_load_dwordx4 v19, s[68:71], s38 offen lds
    s_add_u32 m0, s40, 112640
    s_add_u32 s38, s64, 129024
    buffer_load_dwordx4 v19, s[68:71], s38 offen lds
    s_waitcnt vmcnt(13)
    s_mov_b32 s55, 0
    s_add_u32 s54, s47, 3
L_poll5:
    v_xor_b32 v12, s46, v12
    v_subrev_u32 v13, s54, v13
    v_and_b32 v13, -8, v13
    v_or_b32 v12, v12, v13
    v_cmp_ne_u32 vcc, 0, v12
    s_add_u32 s55, s55, 1
    s_nop 0
    s_cmp_eq_u64 vcc, 0
    s_cbranch_scc1 L_pollx5
    s_cmp_ge_u32 s55, 1048576
    s_cbranch_scc1 L_pollx5
    buffer_load_dwordx2 v[12:13], v26, s[16:19], s76 offen offset:1536 sc1
    s_waitcnt vmcnt(0)
    s_branch L_poll5
L_pollx5:
    s_add_u32 s54, s44, 0
    buffer_load_dwordx4 v[40:43], v1, s[16:19], s54 offen sc1
    s_add_u32 s54, s44, 147456
    buffer_load_dwordx4 v[44:47], v1, s[16:19], s54 offen sc1
    s_add_u32 s54, s44, 294912
    buffer_load_dwordx4 v[48:51], v1, s[16:19], s54 offen sc1
    s_add_u32 s54, s44, 442368
    buffer_load_dwordx4 v[52:55], v1, s[16:19], s54 offen sc1
    s_barrier
    s_waitcnt vmcnt(10)
    s_mov_b32 s55, 0
    s_add_u32 s54, s47, 1
L_poll6:
    v_xor_b32 v28, s46, v28
    v_subrev_u32 v29, s54, v29
    v_and_b32 v29, -8, v29
    v_or_b32 v28, v28, v29
    v_cmp_ne_u32 vcc, 0, v28
    s_add_u32 s55, s55, 1
    s_nop 0
    s_cmp_eq_u64 vcc, 0
    s_cbranch_scc1 L_pollx6
    s_cmp_ge_u32 s55, 1048576
    s_cbranch_scc1 L_pollx6
    buffer_load_dwordx2 v[28:29], v30, s[16:19], s87 offen offset:0 sc1
    s_waitcnt vmcnt(0)
    s_branch L_poll6
L_pollx6:
    s_lshl_b32 s34, s32, 10
    s_add_u32 m0, s34, 122880
    s_add_u32 s38, s43, 0
    buffer_load_dwordx4 v1, s[16:19], s38 offen sc1 lds
    s_add_u32 m0, s34, 126976
    s_add_u32 s38, s43, 4096
    buffer_load_dwordx4 v1, s[16:19], s38 offen sc1 lds
    s_add_u32 m0, s34, 131072
    s_add_u32 s38, s43, 8192
    buffer_load_dwordx4 v1, s[16:19], s38 offen sc1 lds
    s_add_u32 m0, s34, 135168
    s_add_u32 s38, s43, 12288
    buffer_load_dwordx4 v1, s[16:19], s38 offen sc1 lds
    s_add_u32 m0, s34, 139264
    s_add_u32 s38, s43, 16384
    buffer_load_dwordx4 v1, s[16:19], s38 offen sc1 lds
    s_add_u32 m0, s34, 143360
    s_add_u32 s38, s43, 20480
    buffer_load_dwordx4 v1, s[16:19], s38 offen sc1 lds
    s_add_u32 m0, s34, 147456
    s_add_u32 s38, s43, 24576
    buffer_load_dwordx4 v1, s[16:19], s38 offen sc1 lds
    s_add_u32 m0, s34, 151552
    s_add_u32 s38, s43, 28672
    buffer_load_dwordx4 v1, s[16:19], s38 offen sc1 lds
    s_add_u32 m0, s34, 155648
    s_add_u32 s38, s43, 32768
    buffer_load_dwordx4 v1, s[16:19], s38 offen sc1 lds
    s_add_u32 m0, s40, 0
    s_add_u32 s38, s64, 128
    buffer_load_dwordx4 v19, s[68:71], s38 offen lds
    s_add_u32 m0, s40, 1024
    s_add_u32 s38, s64, 9344
    buffer_load_dwordx4 v19, s[68:71], s38 offen lds
    s_add_u32 m0, s40, 2048
    s_add_u32 s38, s64, 18560
    buffer_load_dwordx4 v19, s[68:71], s38 offen lds
    s_add_u32 m0, s40, 12288
    s_add_u32 s38, s64, 110720
    buffer_load_dwordx4 v19, s[68:71], s38 offen lds
    s_add_u32 m0, s40, 13312
    s_add_u32 s38, s64, 119936
    buffer_load_dwordx4 v19, s[68:71], s38 offen lds
    s_add_u32 m0, s40, 14336
    s_add_u32 s38, s64, 129152
    buffer_load_dwordx4 v19, s[68:71], s38 offen lds
    s_barrier
    v_mov_b32 v32, s46
    s_add_u32 s54, s47, 6
    v_mov_b32 v33, s54
    s_mov_b64 exec, 1
    buffer_store_dwordx2 v[32:33], v2, s[16:19], s88 offen offset:1536 sc1
    s_mov_b64 exec, -1
    s_add_u32 m0, s40, 24576
    s_add_u32 s38, s61, 256
    buffer_load_dwordx4 v19, s[12:15], s38 offen lds
    s_add_u32 m0, s40, 25600
    s_add_u32 s38, s61, 9472
    buffer_load_dwordx4 v19, s[12:15], s38 offen lds
    s_add_u32 m0, s40, 26624
    s_add_u32 s38, s61, 18688
    buffer_load_dwordx4 v19, s[12:15], s38 offen lds
    s_add_u32 m0, s40, 36864
    s_add_u32 s38, s61, 221440
    buffer_load_dwordx4 v19, s[12:15], s38 offen lds
    s_add_u32 m0, s40, 37888
    s_add_u32 s38, s61, 230656
    buffer_load_dwordx4 v19, s[12:15], s38 offen lds
    s_add_u32 m0, s40, 38912
    s_add_u32 s38, s61, 239872
    buffer_load_dwordx4 v19, s[12:15], s38 offen lds
    s_add_u32 s54, s44, 4096
    buffer_load_dwordx4 v[56:59], v1, s[16:19], s54 offen sc1
    s_add_u32 s54, s44, 151552
    buffer_load_dwordx4 v[60:63], v1, s[16:19], s54 offen sc1
    s_add_u32 s54, s44, 299008
    buffer_load_dwordx4 v[64:67], v1, s[16:19], s54 offen sc1
    s_add_u32 s54, s44, 446464
    buffer_load_dwordx4 v[68:71], v1, s[16:19], s54 offen sc1
    s_waitcnt vmcnt(17)
    s_barrier
    s_add_u32 m0, s40, 49152
    s_add_u32 s38, s61, 110848
    buffer_load_dwordx4 v19, s[12:15], s38 offen lds
    s_add_u32 m0, s40, 50176
    s_add_u32 s38, s61, 120064
    buffer_load_dwordx4 v19, s[12:15], s38 offen lds
    s_add_u32 m0, s40, 51200
    s_add_u32 s38, s61, 129280
    buffer_load_dwordx4 v19, s[12:15], s38 offen lds
    s_add_u32 m0, s40, 61440
    s_add_u32 s38, s61, 332032
    buffer_load_dwordx4 v19, s[12:15], s38 offen lds
    s_add_u32 m0, s40, 62464
    s_add_u32 s38, s61, 341248
    buffer_load_dwordx4 v19, s[12:15], s38 offen lds
    s_add_u32 m0, s40, 63488
    s_add_u32 s38, s61, 350464
    buffer_load_dwordx4 v19, s[12:15], s38 offen lds
    s_add_u32 s54, s44, 8192
    buffer_load_dwordx4 v[72:75], v1, s[16:19], s54 offen sc1
    s_add_u32 s54, s44, 155648
    buffer_load_dwordx4 v[76:79], v1, s[16:19], s54 offen sc1
    s_add_u32 s54, s44, 303104
    buffer_load_dwordx4 v[80:83], v1, s[16:19], s54 offen sc1
    s_add_u32 s54, s44, 450560
    buffer_load_dwordx4 v[84:87], v1, s[16:19], s54 offen sc1
    v_lshlrev_b32 v4, 16, v40
    v_and_b32 v5, s52, v40
    v_add_f32 v104, v104, v4
    v_add_f32 v105, v105, v5
    v_lshlrev_b32 v6, 16, v41
    v_and_b32 v7, s52, v41
    v_add_f32 v106, v106, v6
    v_add_f32 v107, v107, v7
    v_lshlrev_b32 v4, 16, v42
    v_and_b32 v5, s52, v42
    v_add_f32 v108, v108, v4
    v_add_f32 v109, v109, v5
    v_lshlrev_b32 v6, 16, v43
    v_and_b32 v7, s52, v43
    v_add_f32 v110, v110, v6
    v_add_f32 v111, v111, v7
    v_lshlrev_b32 v4, 16, v44
    v_and_b32 v5, s52, v44
    v_add_f32 v104, v104, v4
    v_add_f32 v105, v105, v5
    v_lshlrev_b32 v6, 16, v45
    v_and_b32 v7, s52, v45
    v_add_f32 v106, v106, v6
    v_add_f32 v107, v107, v7
    v_lshlrev_b32 v4, 16, v46
    v_and_b32 v5, s52, v46
    v_add_f32 v108, v108, v4
    v_add_f32 v109, v109, v5
    v_lshlrev_b32 v6, 16, v47
    v_and_b32 v7, s52, v47
    v_add_f32 v110, v110, v6
    v_add_f32 v111, v111, v7
    s_waitcnt vmcnt(21)
    s_barrier
    s_add_u32 m0, s40, 73728
    s_add_u32 s38, s64, 256
    buffer_load_dwordx4 v19, s[68:71], s38 offen lds
    s_add_u32 m0, s40, 74752
    s_add_u32 s38, s64, 9472
    buffer_load_dwordx4 v19, s[68:71], s38 offen lds
    s_add_u32 m0, s40, 75776
    s_add_u32 s38, s64, 18688
    buffer_load_dwordx4 v19, s[68:71], s38 offen lds
    s_add_u32 m0, s40, 86016
    s_add_u32 s38, s64, 110848
    buffer_load_dwordx4 v19, s[68:71], s38 offen lds
    s_add_u32 m0, s40, 87040
    s_add_u32 s38, s64, 120064
    buffer_load_dwordx4 v19, s[68:71], s38 offen lds
    s_add_u32 m0, s40, 88064
    s_add_u32 s38, s64, 129280
    buffer_load_dwordx4 v19, s[68:71], s38 offen lds
    buffer_load_dwordx2 v[12:13], v26, s[16:19], s77 offen offset:1536 sc1
    v_lshlrev_b32 v4, 16, v48
    v_and_b32 v5, s52, v48
    v_add_f32 v104, v104, v4
    v_add_f32 v105, v105, v5
    v_lshlrev_b32 v6, 16, v49
    v_and_b32 v7, s52, v49
    v_add_f32 v106, v106, v6
    v_add_f32 v107, v107, v7
    v_lshlrev_b32 v4, 16, v50
    v_and_b32 v5, s52, v50
    v_add_f32 v108, v108, v4
    v_add_f32 v109, v109, v5
    v_lshlrev_b32 v6, 16, v51
    v_and_b32 v7, s52, v51
    v_add_f32 v110, v110, v6
    v_add_f32 v111, v111, v7
    v_lshlrev_b32 v4, 16, v52
    v_and_b32 v5, s52, v52
    v_add_f32 v104, v104, v4
    v_add_f32 v105, v105, v5
    v_lshlrev_b32 v6, 16, v53
    v_and_b32 v7, s52, v53
    v_add_f32 v106, v106, v6
    v_add_f32 v107, v107, v7
    v_lshlrev_b32 v4, 16, v54
    v_and_b32 v5, s52, v54
    v_add_f32 v108, v108, v4
    v_add_f32 v109, v109, v5
    v_lshlrev_b32 v6, 16, v55
    v_and_b32 v7, s52, v55
    v_add_f32 v110, v110, v6
    v_add_f32 v111, v111, v7
    s_waitcnt vmcnt(1)
    s_barrier
    s_waitcnt vmcnt(0)
    s_mov_b32 s55, 0
    s_add_u32 s54, s47, 6
L_poll7:
    v_xor_b32 v12, s46, v12
    v_subrev_u32 v13, s54, v13
    v_and_b32 v13, -8, v13
    v_or_b32 v12, v12, v13
    v_cmp_ne_u32 vcc, 0, v12
    s_add_u32 s55, s55, 1
    s_nop 0
    s_cmp_eq_u64 vcc, 0
    s_cbranch_scc1 L_pollx7
    s_cmp_ge_u32 s55, 1048576
    s_cbranch_scc1 L_pollx7
    buffer_load_dwordx2 v[12:13], v26, s[16:19], s77 offen offset:1536 sc1
    s_waitcnt vmcnt(0)
    s_branch L_poll7
L_pollx7:
    s_add_u32 s54, s45, 0
    buffer_load_dwordx4 v[88:91], v1, s[16:19], s54 offen sc1
    s_add_u32 s54, s45, 147456
    buffer_load_dwordx4 v[92:95], v1, s[16:19], s54 offen sc1
    s_add_u32 s54, s45, 294912
    buffer_load_dwordx4 v[96:99], v1, s[16:19], s54 offen sc1
    s_add_u32 s54, s45, 442368
    buffer_load_dwordx4 v[100:103], v1, s[16:19], s54 offen sc1
    s_add_u32 s54, s45, 4096
    buffer_load_dwordx4 v[128:131], v1, s[16:19], s54 offen sc1
    s_add_u32 s54, s45, 151552
    buffer_load_dwordx4 v[132:135], v1, s[16:19], s54 offen sc1
    s_add_u32 s54, s45, 299008
    buffer_load_dwordx4 v[136:139], v1, s[16:19], s54 offen sc1
    s_add_u32 s54, s45, 446464
    buffer_load_dwordx4 v[140:143], v1, s[16:19], s54 offen sc1
    s_add_u32 s54, s45, 8192
    buffer_load_dwordx4 v[144:147], v1, s[16:19], s54 offen sc1
    s_add_u32 s54, s45, 155648
    buffer_load_dwordx4 v[148:151], v1, s[16:19], s54 offen sc1
    s_add_u32 s54, s45, 303104
    buffer_load_dwordx4 v[152:155], v1, s[16:19], s54 offen sc1
    s_add_u32 s54, s45, 450560
    buffer_load_dwordx4 v[156:159], v1, s[16:19], s54 offen sc1
    v_lshlrev_b32 v4, 16, v56
    v_and_b32 v5, s52, v56
    v_add_f32 v112, v112, v4
    v_add_f32 v113, v113, v5
    v_lshlrev_b32 v6, 16, v57
    v_and_b32 v7, s52, v57
    v_add_f32 v114, v114, v6
    v_add_f32 v115, v115, v7
    v_lshlrev_b32 v4, 16, v58
    v_and_b32 v5, s52, v58
    v_add_f32 v116, v116, v4
    v_add_f32 v117, v117, v5
    v_lshlrev_b32 v6, 16, v59
    v_and_b32 v7, s52, v59
    v_add_f32 v118, v118, v6
    v_add_f32 v119, v119, v7
    v_lshlrev_b32 v4, 16, v60
    v_and_b32 v5, s52, v60
    v_add_f32 v112, v112, v4
    v_add_f32 v113, v113, v5
    v_lshlrev_b32 v6, 16, v61
    v_and_b32 v7, s52, v61
    v_add_f32 v114, v114, v6
    v_add_f32 v115, v115, v7
    v_lshlrev_b32 v4, 16, v62
    v_and_b32 v5, s52, v62
    v_add_f32 v116, v116, v4
    v_add_f32 v117, v117, v5
    v_lshlrev_b32 v6, 16, v63
    v_and_b32 v7, s52, v63
    v_add_f32 v118, v118, v6
    v_add_f32 v119, v119, v7
    v_lshlrev_b32 v4, 16, v64
    v_and_b32 v5, s52, v64
    v_add_f32 v112, v112, v4
    v_add_f32 v113, v113, v5
    v_lshlrev_b32 v6, 16, v65
    v_and_b32 v7, s52, v65
    v_add_f32 v114, v114, v6
    v_add_f32 v115, v115, v7
    v_lshlrev_b32 v4, 16, v66
    v_and_b32 v5, s52, v66
    v_add_f32 v116, v116, v4
    v_add_f32 v117, v117, v5
    v_lshlrev_b32 v6, 16, v67
    v_and_b32 v7, s52, v67
    v_add_f32 v118, v118, v6
    v_add_f32 v119, v119, v7
    v_lshlrev_b32 v4, 16, v68
    v_and_b32 v5, s52, v68
    v_add_f32 v112, v112, v4
    v_add_f32 v113, v113, v5
    v_lshlrev_b32 v6, 16, v69
    v_and_b32 v7, s52, v69
    v_add_f32 v114, v114, v6
    v_add_f32 v115, v115, v7
    v_lshlrev_b32 v4, 16, v70
    v_and_b32 v5, s52, v70
    v_add_f32 v116, v116, v4
    v_add_f32 v117, v117, v5
    v_lshlrev_b32 v6, 16, v71
    v_and_b32 v7, s52, v71
    v_add_f32 v118, v118, v6
    v_add_f32 v119, v119, v7
    v_lshlrev_b32 v4, 16, v72
    v_and_b32 v5, s52, v72
    v_add_f32 v120, v120, v4
    v_add_f32 v121, v121, v5
    v_lshlrev_b32 v6, 16, v73
    v_and_b32 v7, s52, v73
    v_add_f32 v122, v122, v6
    v_add_f32 v123, v123, v7
    v_lshlrev_b32 v4, 16, v74
    v_and_b32 v5, s52, v74
    v_add_f32 v124, v124, v4
    v_add_f32 v125, v125, v5
    v_lshlrev_b32 v6, 16, v75
    v_and_b32 v7, s52, v75
    v_add_f32 v126, v126, v6
    v_add_f32 v127, v127, v7
    v_lshlrev_b32 v4, 16, v76
    v_and_b32 v5, s52, v76
    v_add_f32 v120, v120, v4
    v_add_f32 v121, v121, v5
    v_lshlrev_b32 v6, 16, v77
    v_and_b32 v7, s52, v77
    v_add_f32 v122, v122, v6
    v_add_f32 v123, v123, v7
    v_lshlrev_b32 v4, 16, v78
    v_and_b32 v5, s52, v78
    v_add_f32 v124, v124, v4
    v_add_f32 v125, v125, v5
    v_lshlrev_b32 v6, 16, v79
    v_and_b32 v7, s52, v79
    v_add_f32 v126, v126, v6
    v_add_f32 v127, v127, v7
    v_lshlrev_b32 v4, 16, v80
    v_and_b32 v5, s52, v80
    v_add_f32 v120, v120, v4
    v_add_f32 v121, v121, v5
    v_lshlrev_b32 v6, 16, v81
    v_and_b32 v7, s52, v81
    v_add_f32 v122, v122, v6
    v_add_f32 v123, v123, v7
    v_lshlrev_b32 v4, 16, v82
    v_and_b32 v5, s52, v82
    v_add_f32 v124, v124, v4
    v_add_f32 v125, v125, v5
    v_lshlrev_b32 v6, 16, v83
    v_and_b32 v7, s52, v83
    v_add_f32 v126, v126, v6
    v_add_f32 v127, v127, v7
    v_lshlrev_b32 v4, 16, v84
    v_and_b32 v5, s52, v84
    v_add_f32 v120, v120, v4
    v_add_f32 v121, v121, v5
    v_lshlrev_b32 v6, 16, v85
    v_and_b32 v7, s52, v85
    v_add_f32 v122, v122, v6
    v_add_f32 v123, v123, v7
    v_lshlrev_b32 v4, 16, v86
    v_and_b32 v5, s52, v86
    v_add_f32 v124, v124, v4
    v_add_f32 v125, v125, v5
    v_lshlrev_b32 v6, 16, v87
    v_and_b32 v7, s52, v87
    v_add_f32 v126, v126, v6
    v_add_f32 v127, v127, v7
    s_waitcnt vmcnt(8)
    v_lshlrev_b32 v4, 16, v88
    v_and_b32 v5, s52, v88
    v_add_f32 v104, v104, v4
    v_add_f32 v105, v105, v5
    v_lshlrev_b32 v6, 16, v89
    v_and_b32 v7, s52, v89
    v_add_f32 v106, v106, v6
    v_add_f32 v107, v107, v7
    v_lshlrev_b32 v4, 16, v90
    v_and_b32 v5, s52, v90
    v_add_f32 v108, v108, v4
    v_add_f32 v109, v109, v5
    v_lshlrev_b32 v6, 16, v91
    v_and_b32 v7, s52, v91
    v_add_f32 v110, v110, v6
    v_add_f32 v111, v111, v7
    v_lshlrev_b32 v4, 16, v92
    v_and_b32 v5, s52, v92
    v_add_f32 v104, v104, v4
    v_add_f32 v105, v105, v5
    v_lshlrev_b32 v6, 16, v93
    v_and_b32 v7, s52, v93
    v_add_f32 v106, v106, v6
    v_add_f32 v107, v107, v7
    v_lshlrev_b32 v4, 16, v94
    v_and_b32 v5, s52, v94
    v_add_f32 v108, v108, v4
    v_add_f32 v109, v109, v5
    v_lshlrev_b32 v6, 16, v95
    v_and_b32 v7, s52, v95
    v_add_f32 v110, v110, v6
    v_add_f32 v111, v111, v7
    v_lshlrev_b32 v4, 16, v96
    v_and_b32 v5, s52, v96
    v_add_f32 v104, v104, v4
    v_add_f32 v105, v105, v5
    v_lshlrev_b32 v6, 16, v97
    v_and_b32 v7, s52, v97
    v_add_f32 v106, v106, v6
    v_add_f32 v107, v107, v7
    v_lshlrev_b32 v4, 16, v98
    v_and_b32 v5, s52, v98
    v_add_f32 v108, v108, v4
    v_add_f32 v109, v109, v5
    v_lshlrev_b32 v6, 16, v99
    v_and_b32 v7, s52, v99
    v_add_f32 v110, v110, v6
    v_add_f32 v111, v111, v7
    v_lshlrev_b32 v4, 16, v100
    v_and_b32 v5, s52, v100
    v_add_f32 v104, v104, v4
    v_add_f32 v105, v105, v5
    v_lshlrev_b32 v6, 16, v101
    v_and_b32 v7, s52, v101
    v_add_f32 v106, v106, v6
    v_add_f32 v107, v107, v7
    v_lshlrev_b32 v4, 16, v102
    v_and_b32 v5, s52, v102
    v_add_f32 v108, v108, v4
    v_add_f32 v109, v109, v5
    v_lshlrev_b32 v6, 16, v103
    v_and_b32 v7, s52, v103
    v_add_f32 v110, v110, v6
    v_add_f32 v111, v111, v7
    s_waitcnt vmcnt(4)
    v_lshlrev_b32 v4, 16, v128
    v_and_b32 v5, s52, v128
    v_add_f32 v112, v112, v4
    v_add_f32 v113, v113, v5
    v_lshlrev_b32 v6, 16, v129
    v_and_b32 v7, s52, v129
    v_add_f32 v114, v114, v6
    v_add_f32 v115, v115, v7
    v_lshlrev_b32 v4, 16, v130
    v_and_b32 v5, s52, v130
    v_add_f32 v116, v116, v4
    v_add_f32 v117, v117, v5
    v_lshlrev_b32 v6, 16, v131
    v_and_b32 v7, s52, v131
    v_add_f32 v118, v118, v6
    v_add_f32 v119, v119, v7
    v_lshlrev_b32 v4, 16, v132
    v_and_b32 v5, s52, v132
    v_add_f32 v112, v112, v4
    v_add_f32 v113, v113, v5
    v_lshlrev_b32 v6, 16, v133
    v_and_b32 v7, s52, v133
    v_add_f32 v114, v114, v6
    v_add_f32 v115, v115, v7
    v_lshlrev_b32 v4, 16, v134
    v_and_b32 v5, s52, v134
    v_add_f32 v116, v116, v4
    v_add_f32 v117, v117, v5
    v_lshlrev_b32 v6, 16, v135
    v_and_b32 v7, s52, v135
    v_add_f32 v118, v118, v6
    v_add_f32 v119, v119, v7
    v_lshlrev_b32 v4, 16, v136
    v_and_b32 v5, s52, v136
    v_add_f32 v112, v112, v4
    v_add_f32 v113, v113, v5
    v_lshlrev_b32 v6, 16, v137
    v_and_b32 v7, s52, v137
    v_add_f32 v114, v114, v6
    v_add_f32 v115, v115, v7
    v_lshlrev_b32 v4, 16, v138
    v_and_b32 v5, s52, v138
    v_add_f32 v116, v116, v4
    v_add_f32 v117, v117, v5
    v_lshlrev_b32 v6, 16, v139
    v_and_b32 v7, s52, v139
    v_add_f32 v118, v118, v6
    v_add_f32 v119, v119, v7
    v_lshlrev_b32 v4, 16, v140
    v_and_b32 v5, s52, v140
    v_add_f32 v112, v112, v4
    v_add_f32 v113, v113, v5
    v_lshlrev_b32 v6, 16, v141
    v_and_b32 v7, s52, v141
    v_add_f32 v114, v114, v6
    v_add_f32 v115, v115, v7
    v_lshlrev_b32 v4, 16, v142
    v_and_b32 v5, s52, v142
    v_add_f32 v116, v116, v4
    v_add_f32 v117, v117, v5
    v_lshlrev_b32 v6, 16, v143
    v_and_b32 v7, s52, v143
    v_add_f32 v118, v118, v6
    v_add_f32 v119, v119, v7
    buffer_load_dwordx2 v[12:13], v26, s[16:19], s63 offen offset:0 sc1
    s_waitcnt vmcnt(1)
    v_lshlrev_b32 v4, 16, v144
    v_and_b32 v5, s52, v144
    v_add_f32 v120, v120, v4
    v_add_f32 v121, v121, v5
    v_lshlrev_b32 v6, 16, v145
    v_and_b32 v7, s52, v145
    v_add_f32 v122, v122, v6
    v_add_f32 v123, v123, v7
    v_lshlrev_b32 v4, 16, v146
    v_and_b32 v5, s52, v146
    v_add_f32 v124, v124, v4
    v_add_f32 v125, v125, v5
    v_lshlrev_b32 v6, 16, v147
    v_and_b32 v7, s52, v147
    v_add_f32 v126, v126, v6
    v_add_f32 v127, v127, v7
    v_lshlrev_b32 v4, 16, v148
    v_and_b32 v5, s52, v148
    v_add_f32 v120, v120, v4
    v_add_f32 v121, v121, v5
    v_lshlrev_b32 v6, 16, v149
    v_and_b32 v7, s52, v149
    v_add_f32 v122, v122, v6
    v_add_f32 v123, v123, v7
    v_lshlrev_b32 v4, 16, v150
    v_and_b32 v5, s52, v150
    v_add_f32 v124, v124, v4
    v_add_f32 v125, v125, v5
    v_lshlrev_b32 v6, 16, v151
    v_and_b32 v7, s52, v151
    v_add_f32 v126, v126, v6
    v_add_f32 v127, v127, v7
    v_lshlrev_b32 v4, 16, v152
    v_and_b32 v5, s52, v152
    v_add_f32 v120, v120, v4
    v_add_f32 v121, v121, v5
    v_lshlrev_b32 v6, 16, v153
    v_and_b32 v7, s52, v153
    v_add_f32 v122, v122, v6
    v_add_f32 v123, v123, v7
    v_lshlrev_b32 v4, 16, v154
    v_and_b32 v5, s52, v154
    v_add_f32 v124, v124, v4
    v_add_f32 v125, v125, v5
    v_lshlrev_b32 v6, 16, v155
    v_and_b32 v7, s52, v155
    v_add_f32 v126, v126, v6
    v_add_f32 v127, v127, v7
    v_lshlrev_b32 v4, 16, v156
    v_and_b32 v5, s52, v156
    v_add_f32 v120, v120, v4
    v_add_f32 v121, v121, v5
    v_lshlrev_b32 v6, 16, v157
    v_and_b32 v7, s52, v157
    v_add_f32 v122, v122, v6
    v_add_f32 v123, v123, v7
    v_lshlrev_b32 v4, 16, v158
    v_and_b32 v5, s52, v158
    v_add_f32 v124, v124, v4
    v_add_f32 v125, v125, v5
    v_lshlrev_b32 v6, 16, v159
    v_and_b32 v7, s52, v159
    v_add_f32 v126, v126, v6
    v_add_f32 v127, v127, v7
    s_waitcnt vmcnt(0)
    s_mov_b32 s55, 0
    s_add_u32 s54, s47, 1
L_poll8:
    v_xor_b32 v12, s46, v12
    v_subrev_u32 v13, s54, v13
    v_and_b32 v13, -8, v13
    v_or_b32 v12, v12, v13
    v_cmp_ne_u32 vcc, 0, v12
    s_add_u32 s55, s55, 1
    s_nop 0
    s_cmp_eq_u64 vcc, 0
    s_cbranch_scc1 L_pollx8
    s_cmp_ge_u32 s55, 1048576
    s_cbranch_scc1 L_pollx8
    buffer_load_dwordx2 v[12:13], v26, s[16:19], s63 offen offset:0 sc1
    s_waitcnt vmcnt(0)
    s_branch L_poll8
L_pollx8:
    s_add_u32 s54, s36, 0
    buffer_load_dwordx4 v[40:43], v1, s[16:19], s54 offen sc1
    s_add_u32 s54, s36, 147456
    buffer_load_dwordx4 v[44:47], v1, s[16:19], s54 offen sc1
    s_add_u32 s54, s36, 294912
    buffer_load_dwordx4 v[48:51], v1, s[16:19], s54 offen sc1
    s_add_u32 s54, s36, 442368
    buffer_load_dwordx4 v[52:55], v1, s[16:19], s54 offen sc1
    s_add_u32 s54, s36, 4096
    buffer_load_dwordx4 v[56:59], v1, s[16:19], s54 offen sc1
    s_add_u32 s54, s36, 151552
    buffer_load_dwordx4 v[60:63], v1, s[16:19], s54 offen sc1
    s_add_u32 s54, s36, 299008
    buffer_load_dwordx4 v[64:67], v1, s[16:19], s54 offen sc1
    s_add_u32 s54, s36, 446464
    buffer_load_dwordx4 v[68:71], v1, s[16:19], s54 offen sc1
    buffer_load_dwordx2 v[12:13], v26, s[16:19], s63 offen offset:0 sc1
    s_waitcnt vmcnt(0)
    s_mov_b32 s55, 0
    s_add_u32 s54, s47, 2
L_poll9:
    v_xor_b32 v12, s46, v12
    v_subrev_u32 v13, s54, v13
    v_and_b32 v13, -8, v13
    v_or_b32 v12, v12, v13
    v_cmp_ne_u32 vcc, 0, v12
    s_add_u32 s55, s55, 1
    s_nop 0
    s_cmp_eq_u64 vcc, 0
    s_cbranch_scc1 L_pollx9
    s_cmp_ge_u32 s55, 1048576
    s_cbranch_scc1 L_pollx9
    buffer_load_dwordx2 v[12:13], v26, s[16:19], s63 offen offset:0 sc1
    s_waitcnt vmcnt(0)
    s_branch L_poll9
L_pollx9:
    s_add_u32 s54, s36, 8192
    buffer_load_dwordx4 v[72:75], v1, s[16:19], s54 offen sc1
    s_add_u32 s54, s36, 155648
    buffer_load_dwordx4 v[76:79], v1, s[16:19], s54 offen sc1
    s_add_u32 s54, s36, 303104
    buffer_load_dwordx4 v[80:83], v1, s[16:19], s54 offen sc1
    s_add_u32 s54, s36, 450560
    buffer_load_dwordx4 v[84:87], v1, s[16:19], s54 offen sc1
    v_lshlrev_b32 v4, 16, v40
    v_and_b32 v5, s52, v40
    v_add_f32 v104, v104, v4
    v_add_f32 v105, v105, v5
    v_lshlrev_b32 v6, 16, v41
    v_and_b32 v7, s52, v41
    v_add_f32 v106, v106, v6
    v_add_f32 v107, v107, v7
    v_lshlrev_b32 v4, 16, v42
    v_and_b32 v5, s52, v42
    v_add_f32 v108, v108, v4
    v_add_f32 v109, v109, v5
    v_lshlrev_b32 v6, 16, v43
    v_and_b32 v7, s52, v43
    v_add_f32 v110, v110, v6
    v_add_f32 v111, v111, v7
    v_lshlrev_b32 v4, 16, v44
    v_and_b32 v5, s52, v44
    v_add_f32 v104, v104, v4
    v_add_f32 v105, v105, v5
    v_lshlrev_b32 v6, 16, v45
    v_and_b32 v7, s52, v45
    v_add_f32 v106, v106, v6
    v_add_f32 v107, v107, v7
    v_lshlrev_b32 v4, 16, v46
    v_and_b32 v5, s52, v46
    v_add_f32 v108, v108, v4
    v_add_f32 v109, v109, v5
    v_lshlrev_b32 v6, 16, v47
    v_and_b32 v7, s52, v47
    v_add_f32 v110, v110, v6
    v_add_f32 v111, v111, v7
    v_lshlrev_b32 v4, 16, v48
    v_and_b32 v5, s52, v48
    v_add_f32 v104, v104, v4
    v_add_f32 v105, v105, v5
    v_lshlrev_b32 v6, 16, v49
    v_and_b32 v7, s52, v49
    v_add_f32 v106, v106, v6
    v_add_f32 v107, v107, v7
    v_lshlrev_b32 v4, 16, v50
    v_and_b32 v5, s52, v50
    v_add_f32 v108, v108, v4
    v_add_f32 v109, v109, v5
    v_lshlrev_b32 v6, 16, v51
    v_and_b32 v7, s52, v51
    v_add_f32 v110, v110, v6
    v_add_f32 v111, v111, v7
    v_lshlrev_b32 v4, 16, v52
    v_and_b32 v5, s52, v52
    v_add_f32 v104, v104, v4
    v_add_f32 v105, v105, v5
    v_lshlrev_b32 v6, 16, v53
    v_and_b32 v7, s52, v53
    v_add_f32 v106, v106, v6
    v_add_f32 v107, v107, v7
    v_lshlrev_b32 v4, 16, v54
    v_and_b32 v5, s52, v54
    v_add_f32 v108, v108, v4
    v_add_f32 v109, v109, v5
    v_lshlrev_b32 v6, 16, v55
    v_and_b32 v7, s52, v55
    v_add_f32 v110, v110, v6
    v_add_f32 v111, v111, v7
    v_mul_f32 v104, v104, v31
    v_mul_f32 v105, v105, v31
    v_mul_f32 v106, v106, v31
    v_mul_f32 v107, v107, v31
    v_mul_f32 v108, v108, v31
    v_mul_f32 v109, v109, v31
    v_mul_f32 v110, v110, v31
    v_mul_f32 v111, v111, v31
    v_cvt_pk_bf16_f32 v104, v104, v105
    v_cvt_pk_bf16_f32 v105, v106, v107
    v_cvt_pk_bf16_f32 v106, v108, v109
    v_cvt_pk_bf16_f32 v107, v110, v111
    s_nop 0
    v_permlane32_swap_b32 v104, v106
    v_permlane32_swap_b32 v105, v107
    buffer_store_dwordx4 v[104:107], v24, s[80:83], 0 offen offset:0
    v_lshlrev_b32 v4, 16, v56
    v_and_b32 v5, s52, v56
    v_add_f32 v112, v112, v4
    v_add_f32 v113, v113, v5
    v_lshlrev_b32 v6, 16, v57
    v_and_b32 v7, s52, v57
    v_add_f32 v114, v114, v6
    v_add_f32 v115, v115, v7
    v_lshlrev_b32 v4, 16, v58
    v_and_b32 v5, s52, v58
    v_add_f32 v116, v116, v4
    v_add_f32 v117, v117, v5
    v_lshlrev_b32 v6, 16, v59
    v_and_b32 v7, s52, v59
    v_add_f32 v118, v118, v6
    v_add_f32 v119, v119, v7
    v_lshlrev_b32 v4, 16, v60
    v_and_b32 v5, s52, v60
    v_add_f32 v112, v112, v4
    v_add_f32 v113, v113, v5
    v_lshlrev_b32 v6, 16, v61
    v_and_b32 v7, s52, v61
    v_add_f32 v114, v114, v6
    v_add_f32 v115, v115, v7
    v_lshlrev_b32 v4, 16, v62
    v_and_b32 v5, s52, v62
    v_add_f32 v116, v116, v4
    v_add_f32 v117, v117, v5
    v_lshlrev_b32 v6, 16, v63
    v_and_b32 v7, s52, v63
    v_add_f32 v118, v118, v6
    v_add_f32 v119, v119, v7
    v_lshlrev_b32 v4, 16, v64
    v_and_b32 v5, s52, v64
    v_add_f32 v112, v112, v4
    v_add_f32 v113, v113, v5
    v_lshlrev_b32 v6, 16, v65
    v_and_b32 v7, s52, v65
    v_add_f32 v114, v114, v6
    v_add_f32 v115, v115, v7
    v_lshlrev_b32 v4, 16, v66
    v_and_b32 v5, s52, v66
    v_add_f32 v116, v116, v4
    v_add_f32 v117, v117, v5
    v_lshlrev_b32 v6, 16, v67
    v_and_b32 v7, s52, v67
    v_add_f32 v118, v118, v6
    v_add_f32 v119, v119, v7
    v_lshlrev_b32 v4, 16, v68
    v_and_b32 v5, s52, v68
    v_add_f32 v112, v112, v4
    v_add_f32 v113, v113, v5
    v_lshlrev_b32 v6, 16, v69
    v_and_b32 v7, s52, v69
    v_add_f32 v114, v114, v6
    v_add_f32 v115, v115, v7
    v_lshlrev_b32 v4, 16, v70
    v_and_b32 v5, s52, v70
    v_add_f32 v116, v116, v4
    v_add_f32 v117, v117, v5
    v_lshlrev_b32 v6, 16, v71
    v_and_b32 v7, s52, v71
    v_add_f32 v118, v118, v6
    v_add_f32 v119, v119, v7
    v_mul_f32 v112, v112, v31
    v_mul_f32 v113, v113, v31
    v_mul_f32 v114, v114, v31
    v_mul_f32 v115, v115, v31
    v_mul_f32 v116, v116, v31
    v_mul_f32 v117, v117, v31
    v_mul_f32 v118, v118, v31
    v_mul_f32 v119, v119, v31
    v_cvt_pk_bf16_f32 v112, v112, v113
    v_cvt_pk_bf16_f32 v113, v114, v115
    v_cvt_pk_bf16_f32 v114, v116, v117
    v_cvt_pk_bf16_f32 v115, v118, v119
    s_nop 0
    v_permlane32_swap_b32 v112, v114
    v_permlane32_swap_b32 v113, v115
    buffer_store_dwordx4 v[112:115], v24, s[80:83], 0 offen offset:128
    s_waitcnt vmcnt(2)
    v_lshlrev_b32 v4, 16, v72
    v_and_b32 v5, s52, v72
    v_add_f32 v120, v120, v4
    v_add_f32 v121, v121, v5
    v_lshlrev_b32 v6, 16, v73
    v_and_b32 v7, s52, v73
    v_add_f32 v122, v122, v6
    v_add_f32 v123, v123, v7
    v_lshlrev_b32 v4, 16, v74
    v_and_b32 v5, s52, v74
    v_add_f32 v124, v124, v4
    v_add_f32 v125, v125, v5
    v_lshlrev_b32 v6, 16, v75
    v_and_b32 v7, s52, v75
    v_add_f32 v126, v126, v6
    v_add_f32 v127, v127, v7
    v_lshlrev_b32 v4, 16, v76
    v_and_b32 v5, s52, v76
    v_add_f32 v120, v120, v4
    v_add_f32 v121, v121, v5
    v_lshlrev_b32 v6, 16, v77
    v_and_b32 v7, s52, v77
    v_add_f32 v122, v122, v6
    v_add_f32 v123, v123, v7
    v_lshlrev_b32 v4, 16, v78
    v_and_b32 v5, s52, v78
    v_add_f32 v124, v124, v4
    v_add_f32 v125, v125, v5
    v_lshlrev_b32 v6, 16, v79
    v_and_b32 v7, s52, v79
    v_add_f32 v126, v126, v6
    v_add_f32 v127, v127, v7
    v_lshlrev_b32 v4, 16, v80
    v_and_b32 v5, s52, v80
    v_add_f32 v120, v120, v4
    v_add_f32 v121, v121, v5
    v_lshlrev_b32 v6, 16, v81
    v_and_b32 v7, s52, v81
    v_add_f32 v122, v122, v6
    v_add_f32 v123, v123, v7
    v_lshlrev_b32 v4, 16, v82
    v_and_b32 v5, s52, v82
    v_add_f32 v124, v124, v4
    v_add_f32 v125, v125, v5
    v_lshlrev_b32 v6, 16, v83
    v_and_b32 v7, s52, v83
    v_add_f32 v126, v126, v6
    v_add_f32 v127, v127, v7
    v_lshlrev_b32 v4, 16, v84
    v_and_b32 v5, s52, v84
    v_add_f32 v120, v120, v4
    v_add_f32 v121, v121, v5
    v_lshlrev_b32 v6, 16, v85
    v_and_b32 v7, s52, v85
    v_add_f32 v122, v122, v6
    v_add_f32 v123, v123, v7
    v_lshlrev_b32 v4, 16, v86
    v_and_b32 v5, s52, v86
    v_add_f32 v124, v124, v4
    v_add_f32 v125, v125, v5
    v_lshlrev_b32 v6, 16, v87
    v_and_b32 v7, s52, v87
    v_add_f32 v126, v126, v6
    v_add_f32 v127, v127, v7
    v_mul_f32 v120, v120, v31
    v_mul_f32 v121, v121, v31
    v_mul_f32 v122, v122, v31
    v_mul_f32 v123, v123, v31
    v_mul_f32 v124, v124, v31
    v_mul_f32 v125, v125, v31
    v_mul_f32 v126, v126, v31
    v_mul_f32 v127, v127, v31
    v_cvt_pk_bf16_f32 v120, v120, v121
    v_cvt_pk_bf16_f32 v121, v122, v123
    v_cvt_pk_bf16_f32 v122, v124, v125
    v_cvt_pk_bf16_f32 v123, v126, v127
    s_nop 0
    v_permlane32_swap_b32 v120, v122
    v_permlane32_swap_b32 v121, v123
    buffer_store_dwordx4 v[120:123], v24, s[80:83], 0 offen offset:256
    s_endpgm
L_roleA:
    s_cmp_ge_u32 s31, 8
    s_cbranch_scc1 L_helperA
    s_waitcnt lgkmcnt(0)
    s_mov_b32 s16, s76
    s_mov_b32 s17, s77
    s_mov_b32 s18, 35946496
    s_mov_b32 s19, 0x20000
    s_or_b32 s51, s78, 1
    s_setprio 2
    v_bfe_u32 v3, v1, 4, 5
    v_lshrrev_b32 v4, 9, v1
    v_bfe_u32 v5, v1, 5, 3
    v_xor_b32 v4, v4, v5
    s_lshl_b32 s34, s32, 12
    s_add_u32 s34, s34, 122880
    v_lshlrev_b32 v3, 7, v3
    v_add_u32 v3, s34, v3
    v_xor_b32 v5, 0, v4
    v_lshl_add_u32 v8, v5, 4, v3
    v_xor_b32 v5, 2, v4
    v_lshl_add_u32 v9, v5, 4, v3
    v_xor_b32 v5, 4, v4
    v_lshl_add_u32 v10, v5, 4, v3
    v_xor_b32 v5, 6, v4
    v_lshl_add_u32 v11, v5, 4, v3
    v_lshrrev_b32 v3, 9, v1
    v_bfe_u32 v4, v1, 6, 2
    v_lshl_add_u32 v3, v3, 2, v4
    v_mul_u32_u24 v3, 448, v3
    v_bfe_u32 v5, v1, 8, 1
    v_lshl_add_u32 v3, v5, 5, v3
    v_bfe_u32 v5, v1, 4, 2
    v_lshl_add_u32 v3, v5, 3, v3
    s_mul_i32 s34, s33, 14336
    v_add_u32 v2, s34, v3
    s_lshl_b32 s34, s28, 2
    s_add_u32 s34, s34, s29
    s_lshl_b32 s34, s34, 15
    s_add_u32 s44, s34, 28311552
    s_lshl_b32 s34, s28, 4
    s_add_u32 s34, s34, s48
    s_lshl_b32 s34, s34, 11
    s_add_u32 s88, s34, 33325056
    s_mul_i32 s34, s33, 19456
    s_add_u32 s44, s44, s34
    s_mov_b32 s53, s31
    s_barrier
    ds_read_b128 v[44:47], v8 offset:0
    ds_read_b128 v[48:51], v9 offset:0
    ds_read_b64_tr_b16 v[16:17], v2 offset:0
    ds_read_b64_tr_b16 v[18:19], v2 offset:3584
    ds_read_b64_tr_b16 v[20:21], v2 offset:64
    ds_read_b64_tr_b16 v[22:23], v2 offset:3648
    ds_read_b64_tr_b16 v[24:25], v2 offset:128
    ds_read_b64_tr_b16 v[26:27], v2 offset:3712
    ds_read_b64_tr_b16 v[28:29], v2 offset:192
    ds_read_b64_tr_b16 v[30:31], v2 offset:3776
    ds_read_b64_tr_b16 v[32:33], v2 offset:256
    ds_read_b64_tr_b16 v[34:35], v2 offset:3840
    ds_read_b64_tr_b16 v[36:37], v2 offset:320
    ds_read_b64_tr_b16 v[38:39], v2 offset:3904
    ds_read_b64_tr_b16 v[40:41], v2 offset:384
    ds_read_b64_tr_b16 v[42:43], v2 offset:3968
    s_waitcnt lgkmcnt(15)
    s_waitcnt lgkmcnt(12)
    v_mfma_f32_32x32x16_bf16 v[56:71], v[16:19], v[44:47], 0
    ds_read_b64_tr_b16 v[16:17], v2 offset:7168
    ds_read_b64_tr_b16 v[18:19], v2 offset:10752
    s_waitcnt lgkmcnt(12)
    v_mfma_f32_32x32x16_bf16 v[72:87], v[20:23], v[44:47], 0
    ds_read_b64_tr_b16 v[20:21], v2 offset:7232
    ds_read_b64_tr_b16 v[22:23], v2 offset:10816
    s_waitcnt lgkmcnt(12)
    v_mfma_f32_32x32x16_bf16 v[88:103], v[24:27], v[44:47], 0
    ds_read_b64_tr_b16 v[24:25], v2 offset:7296
    ds_read_b64_tr_b16 v[26:27], v2 offset:10880
    s_waitcnt lgkmcnt(12)
    v_mfma_f32_32x32x16_bf16 v[104:119], v[28:31], v[44:47], 0
    ds_read_b64_tr_b16 v[28:29], v2 offset:7360
    ds_read_b64_tr_b16 v[30:31], v2 offset:10944
    s_waitcnt lgkmcnt(12)
    v_mfma_f32_32x32x16_bf16 v[120:135], v[32:35], v[44:47], 0
    ds_read_b64_tr_b16 v[32:33], v2 offset:7424
    ds_read_b64_tr_b16 v[34:35], v2 offset:11008
    s_waitcnt lgkmcnt(12)
    v_mfma_f32_32x32x16_bf16 v[136:151], v[36:39], v[44:47], 0
    ds_read_b64_tr_b16 v[36:37], v2 offset:7488
    ds_read_b64_tr_b16 v[38:39], v2 offset:11072
    s_waitcnt lgkmcnt(12)
    v_mfma_f32_32x32x16_bf16 v[152:167], v[40:43], v[44:47], 0
    ds_read_b64_tr_b16 v[40:41], v2 offset:7552
    ds_read_b64_tr_b16 v[42:43], v2 offset:11136
    s_waitcnt lgkmcnt(12)
    v_mfma_f32_32x32x16_bf16 v[56:71], v[16:19], v[48:51], v[56:71]
    s_barrier
    ds_read_b128 v[44:47], v10 offset:0
    ds_read_b64_tr_b16 v[16:17], v2 offset:28672
    ds_read_b64_tr_b16 v[18:19], v2 offset:32256
    s_waitcnt lgkmcnt(13)
    v_mfma_f32_32x32x16_bf16 v[72:87], v[20:23], v[48:51], v[72:87]
    ds_read_b64_tr_b16 v[20:21], v2 offset:28736
    ds_read_b64_tr_b16 v[22:23], v2 offset:32320
    s_waitcnt lgkmcnt(13)
    v_mfma_f32_32x32x16_bf16 v[88:103], v[24:27], v[48:51], v[88:103]
    ds_read_b64_tr_b16 v[24:25], v2 offset:28800
    ds_read_b64_tr_b16 v[26:27], v2 offset:32384
    s_waitcnt lgkmcnt(13)
    v_mfma_f32_32x32x16_bf16 v[104:119], v[28:31], v[48:51], v[104:119]
    ds_read_b64_tr_b16 v[28:29], v2 offset:28864
    ds_read_b64_tr_b16 v[30:31], v2 offset:32448
    s_waitcnt lgkmcnt(13)
    v_mfma_f32_32x32x16_bf16 v[120:135], v[32:35], v[48:51], v[120:135]
    ds_read_b64_tr_b16 v[32:33], v2 offset:28928
    ds_read_b64_tr_b16 v[34:35], v2 offset:32512
    s_waitcnt lgkmcnt(13)
    v_mfma_f32_32x32x16_bf16 v[136:151], v[36:39], v[48:51], v[136:151]
    ds_read_b64_tr_b16 v[36:37], v2 offset:28992
    ds_read_b64_tr_b16 v[38:39], v2 offset:32576
    s_waitcnt lgkmcnt(13)
    v_mfma_f32_32x32x16_bf16 v[152:167], v[40:43], v[48:51], v[152:167]
    ds_read_b64_tr_b16 v[40:41], v2 offset:29056
    ds_read_b64_tr_b16 v[42:43], v2 offset:32640
    ds_read_b128 v[48:51], v11 offset:0
    s_waitcnt lgkmcnt(15)
    s_waitcnt lgkmcnt(13)
    v_mfma_f32_32x32x16_bf16 v[56:71], v[16:19], v[44:47], v[56:71]
    ds_read_b64_tr_b16 v[16:17], v2 offset:35840
    ds_read_b64_tr_b16 v[18:19], v2 offset:39424
    s_waitcnt lgkmcnt(13)
    v_mfma_f32_32x32x16_bf16 v[72:87], v[20:23], v[44:47], v[72:87]
    ds_read_b64_tr_b16 v[20:21], v2 offset:35904
    ds_read_b64_tr_b16 v[22:23], v2 offset:39488
    s_waitcnt lgkmcnt(13)
    v_mfma_f32_32x32x16_bf16 v[88:103], v[24:27], v[44:47], v[88:103]
    ds_read_b64_tr_b16 v[24:25], v2 offset:35968
    ds_read_b64_tr_b16 v[26:27], v2 offset:39552
    s_waitcnt lgkmcnt(13)
    v_mfma_f32_32x32x16_bf16 v[104:119], v[28:31], v[44:47], v[104:119]
    ds_read_b64_tr_b16 v[28:29], v2 offset:36032
    ds_read_b64_tr_b16 v[30:31], v2 offset:39616
    s_waitcnt lgkmcnt(13)
    v_mfma_f32_32x32x16_bf16 v[120:135], v[32:35], v[44:47], v[120:135]
    ds_read_b64_tr_b16 v[32:33], v2 offset:36096
    ds_read_b64_tr_b16 v[34:35], v2 offset:39680
    s_waitcnt lgkmcnt(13)
    v_mfma_f32_32x32x16_bf16 v[136:151], v[36:39], v[44:47], v[136:151]
    ds_read_b64_tr_b16 v[36:37], v2 offset:36160
    ds_read_b64_tr_b16 v[38:39], v2 offset:39744
    s_waitcnt lgkmcnt(13)
    v_mfma_f32_32x32x16_bf16 v[152:167], v[40:43], v[44:47], v[152:167]
    ds_read_b64_tr_b16 v[40:41], v2 offset:36224
    ds_read_b64_tr_b16 v[42:43], v2 offset:39808
    s_waitcnt lgkmcnt(14)
    s_waitcnt lgkmcnt(12)
    v_mfma_f32_32x32x16_bf16 v[56:71], v[16:19], v[48:51], v[56:71]
    s_barrier
    v_add_u32 v2, 57344, v2
    ds_read_b128 v[44:47], v8 offset:16384
    ds_read_b64_tr_b16 v[16:17], v2 offset:0
    ds_read_b64_tr_b16 v[18:19], v2 offset:3584
    s_waitcnt lgkmcnt(13)
    v_mfma_f32_32x32x16_bf16 v[72:87], v[20:23], v[48:51], v[72:87]
    ds_read_b64_tr_b16 v[20:21], v2 offset:64
    ds_read_b64_tr_b16 v[22:23], v2 offset:3648
    s_waitcnt lgkmcnt(13)
    v_mfma_f32_32x32x16_bf16 v[88:103], v[24:27], v[48:51], v[88:103]
    ds_read_b64_tr_b16 v[24:25], v2 offset:128
    ds_read_b64_tr_b16 v[26:27], v2 offset:3712
    s_waitcnt lgkmcnt(13)
    v_mfma_f32_32x32x16_bf16 v[104:119], v[28:31], v[48:51], v[104:119]
    ds_read_b64_tr_b16 v[28:29], v2 offset:192
    ds_read_b64_tr_b16 v[30:31], v2 offset:3776
    s_waitcnt lgkmcnt(13)
    v_mfma_f32_32x32x16_bf16 v[120:135], v[32:35], v[48:51], v[120:135]
    ds_read_b64_tr_b16 v[32:33], v2 offset:256
    ds_read_b64_tr_b16 v[34:35], v2 offset:3840
    s_waitcnt lgkmcnt(13)
    v_mfma_f32_32x32x16_bf16 v[136:151], v[36:39], v[48:51], v[136:151]
    ds_read_b64_tr_b16 v[36:37], v2 offset:320
    ds_read_b64_tr_b16 v[38:39], v2 offset:3904
    s_waitcnt lgkmcnt(13)
    v_mfma_f32_32x32x16_bf16 v[152:167], v[40:43], v[48:51], v[152:167]
    ds_read_b64_tr_b16 v[40:41], v2 offset:384
    ds_read_b64_tr_b16 v[42:43], v2 offset:3968
    ds_read_b128 v[48:51], v9 offset:16384
    s_waitcnt lgkmcnt(15)
    s_waitcnt lgkmcnt(13)
    v_mfma_f32_32x32x16_bf16 v[56:71], v[16:19], v[44:47], v[56:71]
    ds_read_b64_tr_b16 v[16:17], v2 offset:7168
    ds_read_b64_tr_b16 v[18:19], v2 offset:10752
    s_waitcnt lgkmcnt(13)
    v_mfma_f32_32x32x16_bf16 v[72:87], v[20:23], v[44:47], v[72:87]
    ds_read_b64_tr_b16 v[20:21], v2 offset:7232
    ds_read_b64_tr_b16 v[22:23], v2 offset:10816
    s_waitcnt lgkmcnt(13)
    v_mfma_f32_32x32x16_bf16 v[88:103], v[24:27], v[44:47], v[88:103]
    ds_read_b64_tr_b16 v[24:25], v2 offset:7296
    ds_read_b64_tr_b16 v[26:27], v2 offset:10880
    s_waitcnt lgkmcnt(13)
    v_mfma_f32_32x32x16_bf16 v[104:119], v[28:31], v[44:47], v[104:119]
    ds_read_b64_tr_b16 v[28:29], v2 offset:7360
    ds_read_b64_tr_b16 v[30:31], v2 offset:10944
    s_waitcnt lgkmcnt(13)
    v_mfma_f32_32x32x16_bf16 v[120:135], v[32:35], v[44:47], v[120:135]
    ds_read_b64_tr_b16 v[32:33], v2 offset:7424
    ds_read_b64_tr_b16 v[34:35], v2 offset:11008
    s_waitcnt lgkmcnt(13)
    v_mfma_f32_32x32x16_bf16 v[136:151], v[36:39], v[44:47], v[136:151]
    ds_read_b64_tr_b16 v[36:37], v2 offset:7488
    ds_read_b64_tr_b16 v[38:39], v2 offset:11072
    s_waitcnt lgkmcnt(13)
    v_mfma_f32_32x32x16_bf16 v[152:167], v[40:43], v[44:47], v[152:167]
    ds_read_b64_tr_b16 v[40:41], v2 offset:7552
    ds_read_b64_tr_b16 v[42:43], v2 offset:11136
    s_waitcnt lgkmcnt(14)
    s_waitcnt lgkmcnt(12)
    v_mfma_f32_32x32x16_bf16 v[56:71], v[16:19], v[48:51], v[56:71]
    s_barrier
    ds_read_b128 v[44:47], v10 offset:16384
    ds_read_b64_tr_b16 v[16:17], v2 offset:28672
    ds_read_b64_tr_b16 v[18:19], v2 offset:32256
    s_waitcnt lgkmcnt(13)
    v_mfma_f32_32x32x16_bf16 v[72:87], v[20:23], v[48:51], v[72:87]
    ds_read_b64_tr_b16 v[20:21], v2 offset:28736
    ds_read_b64_tr_b16 v[22:23], v2 offset:32320
    s_waitcnt lgkmcnt(13)
    v_mfma_f32_32x32x16_bf16 v[88:103], v[24:27], v[48:51], v[88:103]
    ds_read_b64_tr_b16 v[24:25], v2 offset:28800
    ds_read_b64_tr_b16 v[26:27], v2 offset:32384
    s_waitcnt lgkmcnt(13)
    v_mfma_f32_32x32x16_bf16 v[104:119], v[28:31], v[48:51], v[104:119]
    ds_read_b64_tr_b16 v[28:29], v2 offset:28864
    ds_read_b64_tr_b16 v[30:31], v2 offset:32448
    s_waitcnt lgkmcnt(13)
    v_mfma_f32_32x32x16_bf16 v[120:135], v[32:35], v[48:51], v[120:135]
    ds_read_b64_tr_b16 v[32:33], v2 offset:28928
    ds_read_b64_tr_b16 v[34:35], v2 offset:32512
    s_waitcnt lgkmcnt(13)
    v_mfma_f32_32x32x16_bf16 v[136:151], v[36:39], v[48:51], v[136:151]
    ds_read_b64_tr_b16 v[36:37], v2 offset:28992
    ds_read_b64_tr_b16 v[38:39], v2 offset:32576
    s_waitcnt lgkmcnt(13)
    v_mfma_f32_32x32x16_bf16 v[152:167], v[40:43], v[48:51], v[152:167]
    ds_read_b64_tr_b16 v[40:41], v2 offset:29056
    ds_read_b64_tr_b16 v[42:43], v2 offset:32640
    ds_read_b128 v[48:51], v11 offset:16384
    s_waitcnt lgkmcnt(15)
    s_waitcnt lgkmcnt(13)
    v_mfma_f32_32x32x16_bf16 v[56:71], v[16:19], v[44:47], v[56:71]
    ds_read_b64_tr_b16 v[16:17], v2 offset:35840
    ds_read_b64_tr_b16 v[18:19], v2 offset:39424
    s_waitcnt lgkmcnt(13)
    v_mfma_f32_32x32x16_bf16 v[72:87], v[20:23], v[44:47], v[72:87]
    ds_read_b64_tr_b16 v[20:21], v2 offset:35904
    ds_read_b64_tr_b16 v[22:23], v2 offset:39488
    s_waitcnt lgkmcnt(13)
    v_mfma_f32_32x32x16_bf16 v[88:103], v[24:27], v[44:47], v[88:103]
    ds_read_b64_tr_b16 v[24:25], v2 offset:35968
    ds_read_b64_tr_b16 v[26:27], v2 offset:39552
    s_waitcnt lgkmcnt(13)
    v_mfma_f32_32x32x16_bf16 v[104:119], v[28:31], v[44:47], v[104:119]
    ds_read_b64_tr_b16 v[28:29], v2 offset:36032
    ds_read_b64_tr_b16 v[30:31], v2 offset:39616
    s_waitcnt lgkmcnt(13)
    v_mfma_f32_32x32x16_bf16 v[120:135], v[32:35], v[44:47], v[120:135]
    ds_read_b64_tr_b16 v[32:33], v2 offset:36096
    ds_read_b64_tr_b16 v[34:35], v2 offset:39680
    s_waitcnt lgkmcnt(13)
    v_mfma_f32_32x32x16_bf16 v[136:151], v[36:39], v[44:47], v[136:151]
    ds_read_b64_tr_b16 v[36:37], v2 offset:36160
    ds_read_b64_tr_b16 v[38:39], v2 offset:39744
    s_waitcnt lgkmcnt(13)
    v_mfma_f32_32x32x16_bf16 v[152:167], v[40:43], v[44:47], v[152:167]
    ds_read_b64_tr_b16 v[40:41], v2 offset:36224
    ds_read_b64_tr_b16 v[42:43], v2 offset:39808
    s_waitcnt lgkmcnt(14)
    s_waitcnt lgkmcnt(12)
    v_mfma_f32_32x32x16_bf16 v[56:71], v[16:19], v[48:51], v[56:71]
    s_barrier
    v_add_u32 v2, -57344, v2
    ds_read_b128 v[44:47], v8 offset:0
    ds_read_b64_tr_b16 v[16:17], v2 offset:0
    ds_read_b64_tr_b16 v[18:19], v2 offset:3584
    s_waitcnt lgkmcnt(13)
    v_mfma_f32_32x32x16_bf16 v[72:87], v[20:23], v[48:51], v[72:87]
    ds_read_b64_tr_b16 v[20:21], v2 offset:64
    ds_read_b64_tr_b16 v[22:23], v2 offset:3648
    s_waitcnt lgkmcnt(13)
    v_mfma_f32_32x32x16_bf16 v[88:103], v[24:27], v[48:51], v[88:103]
    ds_read_b64_tr_b16 v[24:25], v2 offset:128
    ds_read_b64_tr_b16 v[26:27], v2 offset:3712
    s_waitcnt lgkmcnt(13)
    v_mfma_f32_32x32x16_bf16 v[104:119], v[28:31], v[48:51], v[104:119]
    ds_read_b64_tr_b16 v[28:29], v2 offset:192
    ds_read_b64_tr_b16 v[30:31], v2 offset:3776
    s_waitcnt lgkmcnt(13)
    v_mfma_f32_32x32x16_bf16 v[120:135], v[32:35], v[48:51], v[120:135]
    ds_read_b64_tr_b16 v[32:33], v2 offset:256
    ds_read_b64_tr_b16 v[34:35], v2 offset:3840
    s_waitcnt lgkmcnt(13)
    v_mfma_f32_32x32x16_bf16 v[136:151], v[36:39], v[48:51], v[136:151]
    ds_read_b64_tr_b16 v[36:37], v2 offset:320
    ds_read_b64_tr_b16 v[38:39], v2 offset:3904
    s_waitcnt lgkmcnt(13)
    v_mfma_f32_32x32x16_bf16 v[152:167], v[40:43], v[48:51], v[152:167]
    ds_read_b64_tr_b16 v[40:41], v2 offset:384
    ds_read_b64_tr_b16 v[42:43], v2 offset:3968
    ds_read_b128 v[48:51], v9 offset:0
    s_waitcnt lgkmcnt(15)
    s_waitcnt lgkmcnt(13)
    v_mfma_f32_32x32x16_bf16 v[56:71], v[16:19], v[44:47], v[56:71]
    ds_read_b64_tr_b16 v[16:17], v2 offset:7168
    ds_read_b64_tr_b16 v[18:19], v2 offset:10752
    s_waitcnt lgkmcnt(13)
    v_mfma_f32_32x32x16_bf16 v[72:87], v[20:23], v[44:47], v[72:87]
    ds_read_b64_tr_b16 v[20:21], v2 offset:7232
    ds_read_b64_tr_b16 v[22:23], v2 offset:10816
    s_waitcnt lgkmcnt(13)
    v_mfma_f32_32x32x16_bf16 v[88:103], v[24:27], v[44:47], v[88:103]
    ds_read_b64_tr_b16 v[24:25], v2 offset:7296
    ds_read_b64_tr_b16 v[26:27], v2 offset:10880
    s_waitcnt lgkmcnt(13)
    v_mfma_f32_32x32x16_bf16 v[104:119], v[28:31], v[44:47], v[104:119]
    ds_read_b64_tr_b16 v[28:29], v2 offset:7360
    ds_read_b64_tr_b16 v[30:31], v2 offset:10944
    s_waitcnt lgkmcnt(13)
    v_mfma_f32_32x32x16_bf16 v[120:135], v[32:35], v[44:47], v[120:135]
    ds_read_b64_tr_b16 v[32:33], v2 offset:7424
    ds_read_b64_tr_b16 v[34:35], v2 offset:11008
    s_waitcnt lgkmcnt(13)
    v_mfma_f32_32x32x16_bf16 v[136:151], v[36:39], v[44:47], v[136:151]
    ds_read_b64_tr_b16 v[36:37], v2 offset:7488
    ds_read_b64_tr_b16 v[38:39], v2 offset:11072
    s_waitcnt lgkmcnt(13)
    v_mfma_f32_32x32x16_bf16 v[152:167], v[40:43], v[44:47], v[152:167]
    ds_read_b64_tr_b16 v[40:41], v2 offset:7552
    ds_read_b64_tr_b16 v[42:43], v2 offset:11136
    s_waitcnt lgkmcnt(14)
    s_waitcnt lgkmcnt(12)
    v_mfma_f32_32x32x16_bf16 v[56:71], v[16:19], v[48:51], v[56:71]
    s_barrier
    ds_read_b128 v[44:47], v10 offset:0
    ds_read_b64_tr_b16 v[16:17], v2 offset:28672
    ds_read_b64_tr_b16 v[18:19], v2 offset:32256
    s_waitcnt lgkmcnt(13)
    v_mfma_f32_32x32x16_bf16 v[72:87], v[20:23], v[48:51], v[72:87]
    ds_read_b64_tr_b16 v[20:21], v2 offset:28736
    ds_read_b64_tr_b16 v[22:23], v2 offset:32320
    s_waitcnt lgkmcnt(13)
    v_mfma_f32_32x32x16_bf16 v[88:103], v[24:27], v[48:51], v[88:103]
    ds_read_b64_tr_b16 v[24:25], v2 offset:28800
    ds_read_b64_tr_b16 v[26:27], v2 offset:32384
    s_waitcnt lgkmcnt(13)
    v_mfma_f32_32x32x16_bf16 v[104:119], v[28:31], v[48:51], v[104:119]
    ds_read_b64_tr_b16 v[28:29], v2 offset:28864
    ds_read_b64_tr_b16 v[30:31], v2 offset:32448
    s_waitcnt lgkmcnt(13)
    v_mfma_f32_32x32x16_bf16 v[120:135], v[32:35], v[48:51], v[120:135]
    ds_read_b64_tr_b16 v[32:33], v2 offset:28928
    ds_read_b64_tr_b16 v[34:35], v2 offset:32512
    s_waitcnt lgkmcnt(13)
    v_mfma_f32_32x32x16_bf16 v[136:151], v[36:39], v[48:51], v[136:151]
    ds_read_b64_tr_b16 v[36:37], v2 offset:28992
    ds_read_b64_tr_b16 v[38:39], v2 offset:32576
    s_waitcnt lgkmcnt(13)
    v_mfma_f32_32x32x16_bf16 v[152:167], v[40:43], v[48:51], v[152:167]
    ds_read_b64_tr_b16 v[40:41], v2 offset:29056
    ds_read_b64_tr_b16 v[42:43], v2 offset:32640
    ds_read_b128 v[48:51], v11 offset:0
    s_waitcnt lgkmcnt(15)
    s_waitcnt lgkmcnt(13)
    v_mfma_f32_32x32x16_bf16 v[56:71], v[16:19], v[44:47], v[56:71]
    ds_read_b64_tr_b16 v[16:17], v2 offset:35840
    ds_read_b64_tr_b16 v[18:19], v2 offset:39424
    s_waitcnt lgkmcnt(13)
    v_mfma_f32_32x32x16_bf16 v[72:87], v[20:23], v[44:47], v[72:87]
    ds_read_b64_tr_b16 v[20:21], v2 offset:35904
    ds_read_b64_tr_b16 v[22:23], v2 offset:39488
    s_waitcnt lgkmcnt(13)
    v_mfma_f32_32x32x16_bf16 v[88:103], v[24:27], v[44:47], v[88:103]
    ds_read_b64_tr_b16 v[24:25], v2 offset:35968
    ds_read_b64_tr_b16 v[26:27], v2 offset:39552
    s_waitcnt lgkmcnt(13)
    v_mfma_f32_32x32x16_bf16 v[104:119], v[28:31], v[44:47], v[104:119]
    ds_read_b64_tr_b16 v[28:29], v2 offset:36032
    ds_read_b64_tr_b16 v[30:31], v2 offset:39616
    s_waitcnt lgkmcnt(13)
    v_mfma_f32_32x32x16_bf16 v[120:135], v[32:35], v[44:47], v[120:135]
    ds_read_b64_tr_b16 v[32:33], v2 offset:36096
    ds_read_b64_tr_b16 v[34:35], v2 offset:39680
    s_waitcnt lgkmcnt(13)
    v_mfma_f32_32x32x16_bf16 v[136:151], v[36:39], v[44:47], v[136:151]
    ds_read_b64_tr_b16 v[36:37], v2 offset:36160
    ds_read_b64_tr_b16 v[38:39], v2 offset:39744
    s_waitcnt lgkmcnt(13)
    v_mfma_f32_32x32x16_bf16 v[152:167], v[40:43], v[44:47], v[152:167]
    ds_read_b64_tr_b16 v[40:41], v2 offset:36224
    ds_read_b64_tr_b16 v[42:43], v2 offset:39808
    s_waitcnt lgkmcnt(14)
    s_waitcnt lgkmcnt(12)
    v_mfma_f32_32x32x16_bf16 v[56:71], v[16:19], v[48:51], v[56:71]
    s_barrier
    v_add_u32 v2, 57344, v2
    ds_read_b128 v[44:47], v8 offset:16384
    ds_read_b64_tr_b16 v[16:17], v2 offset:0
    ds_read_b64_tr_b16 v[18:19], v2 offset:3584
    s_waitcnt lgkmcnt(13)
    v_mfma_f32_32x32x16_bf16 v[72:87], v[20:23], v[48:51], v[72:87]
    ds_read_b64_tr_b16 v[20:21], v2 offset:64
    ds_read_b64_tr_b16 v[22:23], v2 offset:3648
    s_waitcnt lgkmcnt(13)
    v_mfma_f32_32x32x16_bf16 v[88:103], v[24:27], v[48:51], v[88:103]
    ds_read_b64_tr_b16 v[24:25], v2 offset:128
    ds_read_b64_tr_b16 v[26:27], v2 offset:3712
    s_waitcnt lgkmcnt(13)
    v_mfma_f32_32x32x16_bf16 v[104:119], v[28:31], v[48:51], v[104:119]
    ds_read_b64_tr_b16 v[28:29], v2 offset:192
    ds_read_b64_tr_b16 v[30:31], v2 offset:3776
    s_waitcnt lgkmcnt(13)
    v_mfma_f32_32x32x16_bf16 v[120:135], v[32:35], v[48:51], v[120:135]
    ds_read_b64_tr_b16 v[32:33], v2 offset:256
    ds_read_b64_tr_b16 v[34:35], v2 offset:3840
    s_waitcnt lgkmcnt(13)
    v_mfma_f32_32x32x16_bf16 v[136:151], v[36:39], v[48:51], v[136:151]
    ds_read_b64_tr_b16 v[36:37], v2 offset:320
    ds_read_b64_tr_b16 v[38:39], v2 offset:3904
    s_waitcnt lgkmcnt(13)
    v_mfma_f32_32x32x16_bf16 v[152:167], v[40:43], v[48:51], v[152:167]
    ds_read_b64_tr_b16 v[40:41], v2 offset:384
    ds_read_b64_tr_b16 v[42:43], v2 offset:3968
    ds_read_b128 v[48:51], v9 offset:16384
    s_waitcnt lgkmcnt(15)
    s_waitcnt lgkmcnt(13)
    v_mfma_f32_32x32x16_bf16 v[56:71], v[16:19], v[44:47], v[56:71]
    ds_read_b64_tr_b16 v[16:17], v2 offset:7168
    ds_read_b64_tr_b16 v[18:19], v2 offset:10752
    s_waitcnt lgkmcnt(13)
    v_mfma_f32_32x32x16_bf16 v[72:87], v[20:23], v[44:47], v[72:87]
    ds_read_b64_tr_b16 v[20:21], v2 offset:7232
    ds_read_b64_tr_b16 v[22:23], v2 offset:10816
    s_waitcnt lgkmcnt(13)
    v_mfma_f32_32x32x16_bf16 v[88:103], v[24:27], v[44:47], v[88:103]
    ds_read_b64_tr_b16 v[24:25], v2 offset:7296
    ds_read_b64_tr_b16 v[26:27], v2 offset:10880
    s_waitcnt lgkmcnt(13)
    v_mfma_f32_32x32x16_bf16 v[104:119], v[28:31], v[44:47], v[104:119]
    ds_read_b64_tr_b16 v[28:29], v2 offset:7360
    ds_read_b64_tr_b16 v[30:31], v2 offset:10944
    s_waitcnt lgkmcnt(13)
    v_mfma_f32_32x32x16_bf16 v[120:135], v[32:35], v[44:47], v[120:135]
    ds_read_b64_tr_b16 v[32:33], v2 offset:7424
    ds_read_b64_tr_b16 v[34:35], v2 offset:11008
    s_waitcnt lgkmcnt(13)
    v_mfma_f32_32x32x16_bf16 v[136:151], v[36:39], v[44:47], v[136:151]
    ds_read_b64_tr_b16 v[36:37], v2 offset:7488
    ds_read_b64_tr_b16 v[38:39], v2 offset:11072
    s_waitcnt lgkmcnt(13)
    v_mfma_f32_32x32x16_bf16 v[152:167], v[40:43], v[44:47], v[152:167]
    ds_read_b64_tr_b16 v[40:41], v2 offset:7552
    ds_read_b64_tr_b16 v[42:43], v2 offset:11136
    s_waitcnt lgkmcnt(14)
    s_waitcnt lgkmcnt(12)
    v_mfma_f32_32x32x16_bf16 v[56:71], v[16:19], v[48:51], v[56:71]
    s_barrier
    ds_read_b128 v[44:47], v10 offset:16384
    ds_read_b64_tr_b16 v[16:17], v2 offset:28672
    ds_read_b64_tr_b16 v[18:19], v2 offset:32256
    s_waitcnt lgkmcnt(13)
    v_mfma_f32_32x32x16_bf16 v[72:87], v[20:23], v[48:51], v[72:87]
    ds_read_b64_tr_b16 v[20:21], v2 offset:28736
    ds_read_b64_tr_b16 v[22:23], v2 offset:32320
    s_waitcnt lgkmcnt(13)
    v_mfma_f32_32x32x16_bf16 v[88:103], v[24:27], v[48:51], v[88:103]
    ds_read_b64_tr_b16 v[24:25], v2 offset:28800
    ds_read_b64_tr_b16 v[26:27], v2 offset:32384
    s_waitcnt lgkmcnt(13)
    v_mfma_f32_32x32x16_bf16 v[104:119], v[28:31], v[48:51], v[104:119]
    ds_read_b64_tr_b16 v[28:29], v2 offset:28864
    ds_read_b64_tr_b16 v[30:31], v2 offset:32448
    s_waitcnt lgkmcnt(13)
    v_mfma_f32_32x32x16_bf16 v[120:135], v[32:35], v[48:51], v[120:135]
    ds_read_b64_tr_b16 v[32:33], v2 offset:28928
    ds_read_b64_tr_b16 v[34:35], v2 offset:32512
    s_waitcnt lgkmcnt(13)
    v_mfma_f32_32x32x16_bf16 v[136:151], v[36:39], v[48:51], v[136:151]
    ds_read_b64_tr_b16 v[36:37], v2 offset:28992
    ds_read_b64_tr_b16 v[38:39], v2 offset:32576
    s_waitcnt lgkmcnt(13)
    v_mfma_f32_32x32x16_bf16 v[152:167], v[40:43], v[48:51], v[152:167]
    ds_read_b64_tr_b16 v[40:41], v2 offset:29056
    ds_read_b64_tr_b16 v[42:43], v2 offset:32640
    ds_read_b128 v[48:51], v11 offset:16384
    s_waitcnt lgkmcnt(15)
    s_waitcnt lgkmcnt(13)
    v_mfma_f32_32x32x16_bf16 v[56:71], v[16:19], v[44:47], v[56:71]
    ds_read_b64_tr_b16 v[16:17], v2 offset:35840
    ds_read_b64_tr_b16 v[18:19], v2 offset:39424
    s_waitcnt lgkmcnt(13)
    v_mfma_f32_32x32x16_bf16 v[72:87], v[20:23], v[44:47], v[72:87]
    ds_read_b64_tr_b16 v[20:21], v2 offset:35904
    ds_read_b64_tr_b16 v[22:23], v2 offset:39488
    s_waitcnt lgkmcnt(13)
    v_mfma_f32_32x32x16_bf16 v[88:103], v[24:27], v[44:47], v[88:103]
    ds_read_b64_tr_b16 v[24:25], v2 offset:35968
    ds_read_b64_tr_b16 v[26:27], v2 offset:39552
    s_waitcnt lgkmcnt(13)
    v_mfma_f32_32x32x16_bf16 v[104:119], v[28:31], v[44:47], v[104:119]
    ds_read_b64_tr_b16 v[28:29], v2 offset:36032
    ds_read_b64_tr_b16 v[30:31], v2 offset:39616
    s_waitcnt lgkmcnt(13)
    v_mfma_f32_32x32x16_bf16 v[120:135], v[32:35], v[44:47], v[120:135]
    ds_read_b64_tr_b16 v[32:33], v2 offset:36096
    ds_read_b64_tr_b16 v[34:35], v2 offset:39680
    s_waitcnt lgkmcnt(13)
    v_mfma_f32_32x32x16_bf16 v[136:151], v[36:39], v[44:47], v[136:151]
    ds_read_b64_tr_b16 v[36:37], v2 offset:36160
    ds_read_b64_tr_b16 v[38:39], v2 offset:39744
    s_waitcnt lgkmcnt(13)
    v_mfma_f32_32x32x16_bf16 v[152:167], v[40:43], v[44:47], v[152:167]
    ds_read_b64_tr_b16 v[40:41], v2 offset:36224
    ds_read_b64_tr_b16 v[42:43], v2 offset:39808
    s_waitcnt lgkmcnt(14)
    s_waitcnt lgkmcnt(12)
    v_mfma_f32_32x32x16_bf16 v[56:71], v[16:19], v[48:51], v[56:71]
    s_barrier
    v_add_u32 v2, -57344, v2
    ds_read_b128 v[44:47], v8 offset:0
    ds_read_b64_tr_b16 v[16:17], v2 offset:0
    ds_read_b64_tr_b16 v[18:19], v2 offset:3584
    s_waitcnt lgkmcnt(13)
    v_mfma_f32_32x32x16_bf16 v[72:87], v[20:23], v[48:51], v[72:87]
    ds_read_b64_tr_b16 v[20:21], v2 offset:64
    ds_read_b64_tr_b16 v[22:23], v2 offset:3648
    s_waitcnt lgkmcnt(13)
    v_mfma_f32_32x32x16_bf16 v[88:103], v[24:27], v[48:51], v[88:103]
    ds_read_b64_tr_b16 v[24:25], v2 offset:128
    ds_read_b64_tr_b16 v[26:27], v2 offset:3712
    s_waitcnt lgkmcnt(13)
    v_mfma_f32_32x32x16_bf16 v[104:119], v[28:31], v[48:51], v[104:119]
    ds_read_b64_tr_b16 v[28:29], v2 offset:192
    ds_read_b64_tr_b16 v[30:31], v2 offset:3776
    s_waitcnt lgkmcnt(13)
    v_mfma_f32_32x32x16_bf16 v[120:135], v[32:35], v[48:51], v[120:135]
    ds_read_b64_tr_b16 v[32:33], v2 offset:256
    ds_read_b64_tr_b16 v[34:35], v2 offset:3840
    s_waitcnt lgkmcnt(13)
    v_mfma_f32_32x32x16_bf16 v[136:151], v[36:39], v[48:51], v[136:151]
    ds_read_b64_tr_b16 v[36:37], v2 offset:320
    ds_read_b64_tr_b16 v[38:39], v2 offset:3904
    s_waitcnt lgkmcnt(13)
    v_mfma_f32_32x32x16_bf16 v[152:167], v[40:43], v[48:51], v[152:167]
    ds_read_b64_tr_b16 v[40:41], v2 offset:384
    ds_read_b64_tr_b16 v[42:43], v2 offset:3968
    ds_read_b128 v[48:51], v9 offset:0
    s_waitcnt lgkmcnt(15)
    s_waitcnt lgkmcnt(13)
    v_mfma_f32_32x32x16_bf16 v[56:71], v[16:19], v[44:47], v[56:71]
    ds_read_b64_tr_b16 v[16:17], v2 offset:7168
    ds_read_b64_tr_b16 v[18:19], v2 offset:10752
    s_waitcnt lgkmcnt(13)
    v_mfma_f32_32x32x16_bf16 v[72:87], v[20:23], v[44:47], v[72:87]
    ds_read_b64_tr_b16 v[20:21], v2 offset:7232
    ds_read_b64_tr_b16 v[22:23], v2 offset:10816
    s_waitcnt lgkmcnt(13)
    v_mfma_f32_32x32x16_bf16 v[88:103], v[24:27], v[44:47], v[88:103]
    ds_read_b64_tr_b16 v[24:25], v2 offset:7296
    ds_read_b64_tr_b16 v[26:27], v2 offset:10880
    s_waitcnt lgkmcnt(13)
    v_mfma_f32_32x32x16_bf16 v[104:119], v[28:31], v[44:47], v[104:119]
    ds_read_b64_tr_b16 v[28:29], v2 offset:7360
    ds_read_b64_tr_b16 v[30:31], v2 offset:10944
    s_waitcnt lgkmcnt(13)
    v_mfma_f32_32x32x16_bf16 v[120:135], v[32:35], v[44:47], v[120:135]
    ds_read_b64_tr_b16 v[32:33], v2 offset:7424
    ds_read_b64_tr_b16 v[34:35], v2 offset:11008
    s_waitcnt lgkmcnt(13)
    v_mfma_f32_32x32x16_bf16 v[136:151], v[36:39], v[44:47], v[136:151]
    ds_read_b64_tr_b16 v[36:37], v2 offset:7488
    ds_read_b64_tr_b16 v[38:39], v2 offset:11072
    s_waitcnt lgkmcnt(13)
    v_mfma_f32_32x32x16_bf16 v[152:167], v[40:43], v[44:47], v[152:167]
    ds_read_b64_tr_b16 v[40:41], v2 offset:7552
    ds_read_b64_tr_b16 v[42:43], v2 offset:11136
    s_waitcnt lgkmcnt(14)
    s_waitcnt lgkmcnt(12)
    v_mfma_f32_32x32x16_bf16 v[56:71], v[16:19], v[48:51], v[56:71]
    s_barrier
    ds_read_b128 v[44:47], v10 offset:0
    ds_read_b64_tr_b16 v[16:17], v2 offset:28672
    ds_read_b64_tr_b16 v[18:19], v2 offset:32256
    s_waitcnt lgkmcnt(13)
    v_mfma_f32_32x32x16_bf16 v[72:87], v[20:23], v[48:51], v[72:87]
    ds_read_b64_tr_b16 v[20:21], v2 offset:28736
    ds_read_b64_tr_b16 v[22:23], v2 offset:32320
    s_waitcnt lgkmcnt(13)
    v_mfma_f32_32x32x16_bf16 v[88:103], v[24:27], v[48:51], v[88:103]
    ds_read_b64_tr_b16 v[24:25], v2 offset:28800
    ds_read_b64_tr_b16 v[26:27], v2 offset:32384
    s_waitcnt lgkmcnt(13)
    v_mfma_f32_32x32x16_bf16 v[104:119], v[28:31], v[48:51], v[104:119]
    ds_read_b64_tr_b16 v[28:29], v2 offset:28864
    ds_read_b64_tr_b16 v[30:31], v2 offset:32448
    s_waitcnt lgkmcnt(13)
    v_mfma_f32_32x32x16_bf16 v[120:135], v[32:35], v[48:51], v[120:135]
    ds_read_b64_tr_b16 v[32:33], v2 offset:28928
    ds_read_b64_tr_b16 v[34:35], v2 offset:32512
    s_waitcnt lgkmcnt(13)
    v_mfma_f32_32x32x16_bf16 v[136:151], v[36:39], v[48:51], v[136:151]
    ds_read_b64_tr_b16 v[36:37], v2 offset:28992
    ds_read_b64_tr_b16 v[38:39], v2 offset:32576
    s_waitcnt lgkmcnt(13)
    v_mfma_f32_32x32x16_bf16 v[152:167], v[40:43], v[48:51], v[152:167]
    ds_read_b64_tr_b16 v[40:41], v2 offset:29056
    ds_read_b64_tr_b16 v[42:43], v2 offset:32640
    ds_read_b128 v[48:51], v11 offset:0
    s_waitcnt lgkmcnt(15)
    s_waitcnt lgkmcnt(13)
    v_mfma_f32_32x32x16_bf16 v[56:71], v[16:19], v[44:47], v[56:71]
    ds_read_b64_tr_b16 v[16:17], v2 offset:35840
    ds_read_b64_tr_b16 v[18:19], v2 offset:39424
    s_waitcnt lgkmcnt(13)
    v_mfma_f32_32x32x16_bf16 v[72:87], v[20:23], v[44:47], v[72:87]
    ds_read_b64_tr_b16 v[20:21], v2 offset:35904
    ds_read_b64_tr_b16 v[22:23], v2 offset:39488
    s_waitcnt lgkmcnt(13)
    v_mfma_f32_32x32x16_bf16 v[88:103], v[24:27], v[44:47], v[88:103]
    ds_read_b64_tr_b16 v[24:25], v2 offset:35968
    ds_read_b64_tr_b16 v[26:27], v2 offset:39552
    s_waitcnt lgkmcnt(13)
    v_mfma_f32_32x32x16_bf16 v[104:119], v[28:31], v[44:47], v[104:119]
    ds_read_b64_tr_b16 v[28:29], v2 offset:36032
    ds_read_b64_tr_b16 v[30:31], v2 offset:39616
    s_waitcnt lgkmcnt(13)
    v_mfma_f32_32x32x16_bf16 v[120:135], v[32:35], v[44:47], v[120:135]
    ds_read_b64_tr_b16 v[32:33], v2 offset:36096
    ds_read_b64_tr_b16 v[34:35], v2 offset:39680
    s_waitcnt lgkmcnt(13)
    v_mfma_f32_32x32x16_bf16 v[136:151], v[36:39], v[44:47], v[136:151]
    ds_read_b64_tr_b16 v[36:37], v2 offset:36160
    ds_read_b64_tr_b16 v[38:39], v2 offset:39744
    s_waitcnt lgkmcnt(13)
    v_mfma_f32_32x32x16_bf16 v[152:167], v[40:43], v[44:47], v[152:167]
    ds_read_b64_tr_b16 v[40:41], v2 offset:36224
    ds_read_b64_tr_b16 v[42:43], v2 offset:39808
    s_waitcnt lgkmcnt(14)
    s_waitcnt lgkmcnt(12)
    v_mfma_f32_32x32x16_bf16 v[56:71], v[16:19], v[48:51], v[56:71]
    s_barrier
    v_add_u32 v2, 57344, v2
    ds_read_b128 v[44:47], v8 offset:16384
    ds_read_b64_tr_b16 v[16:17], v2 offset:0
    ds_read_b64_tr_b16 v[18:19], v2 offset:3584
    s_waitcnt lgkmcnt(13)
    v_mfma_f32_32x32x16_bf16 v[72:87], v[20:23], v[48:51], v[72:87]
    ds_read_b64_tr_b16 v[20:21], v2 offset:64
    ds_read_b64_tr_b16 v[22:23], v2 offset:3648
    s_waitcnt lgkmcnt(13)
    v_mfma_f32_32x32x16_bf16 v[88:103], v[24:27], v[48:51], v[88:103]
    ds_read_b64_tr_b16 v[24:25], v2 offset:128
    ds_read_b64_tr_b16 v[26:27], v2 offset:3712
    s_waitcnt lgkmcnt(13)
    v_mfma_f32_32x32x16_bf16 v[104:119], v[28:31], v[48:51], v[104:119]
    ds_read_b64_tr_b16 v[28:29], v2 offset:192
    ds_read_b64_tr_b16 v[30:31], v2 offset:3776
    s_waitcnt lgkmcnt(13)
    v_mfma_f32_32x32x16_bf16 v[120:135], v[32:35], v[48:51], v[120:135]
    ds_read_b64_tr_b16 v[32:33], v2 offset:256
    ds_read_b64_tr_b16 v[34:35], v2 offset:3840
    s_waitcnt lgkmcnt(13)
    v_mfma_f32_32x32x16_bf16 v[136:151], v[36:39], v[48:51], v[136:151]
    ds_read_b64_tr_b16 v[36:37], v2 offset:320
    ds_read_b64_tr_b16 v[38:39], v2 offset:3904
    s_waitcnt lgkmcnt(13)
    v_mfma_f32_32x32x16_bf16 v[152:167], v[40:43], v[48:51], v[152:167]
    ds_read_b64_tr_b16 v[40:41], v2 offset:384
    ds_read_b64_tr_b16 v[42:43], v2 offset:3968
    ds_read_b128 v[48:51], v9 offset:16384
    s_waitcnt lgkmcnt(15)
    s_waitcnt lgkmcnt(13)
    v_mfma_f32_32x32x16_bf16 v[56:71], v[16:19], v[44:47], v[56:71]
    ds_read_b64_tr_b16 v[16:17], v2 offset:7168
    ds_read_b64_tr_b16 v[18:19], v2 offset:10752
    s_waitcnt lgkmcnt(13)
    v_mfma_f32_32x32x16_bf16 v[72:87], v[20:23], v[44:47], v[72:87]
    ds_read_b64_tr_b16 v[20:21], v2 offset:7232
    ds_read_b64_tr_b16 v[22:23], v2 offset:10816
    s_waitcnt lgkmcnt(13)
    v_mfma_f32_32x32x16_bf16 v[88:103], v[24:27], v[44:47], v[88:103]
    ds_read_b64_tr_b16 v[24:25], v2 offset:7296
    ds_read_b64_tr_b16 v[26:27], v2 offset:10880
    s_waitcnt lgkmcnt(13)
    v_mfma_f32_32x32x16_bf16 v[104:119], v[28:31], v[44:47], v[104:119]
    ds_read_b64_tr_b16 v[28:29], v2 offset:7360
    ds_read_b64_tr_b16 v[30:31], v2 offset:10944
    s_waitcnt lgkmcnt(13)
    v_mfma_f32_32x32x16_bf16 v[120:135], v[32:35], v[44:47], v[120:135]
    ds_read_b64_tr_b16 v[32:33], v2 offset:7424
    ds_read_b64_tr_b16 v[34:35], v2 offset:11008
    s_waitcnt lgkmcnt(13)
    v_mfma_f32_32x32x16_bf16 v[136:151], v[36:39], v[44:47], v[136:151]
    ds_read_b64_tr_b16 v[36:37], v2 offset:7488
    ds_read_b64_tr_b16 v[38:39], v2 offset:11072
    s_waitcnt lgkmcnt(13)
    v_mfma_f32_32x32x16_bf16 v[152:167], v[40:43], v[44:47], v[152:167]
    ds_read_b64_tr_b16 v[40:41], v2 offset:7552
    ds_read_b64_tr_b16 v[42:43], v2 offset:11136
    s_waitcnt lgkmcnt(14)
    s_waitcnt lgkmcnt(12)
    v_mfma_f32_32x32x16_bf16 v[56:71], v[16:19], v[48:51], v[56:71]
    s_barrier
    ds_read_b128 v[44:47], v10 offset:16384
    ds_read_b64_tr_b16 v[16:17], v2 offset:28672
    ds_read_b64_tr_b16 v[18:19], v2 offset:32256
    s_waitcnt lgkmcnt(13)
    v_mfma_f32_32x32x16_bf16 v[72:87], v[20:23], v[48:51], v[72:87]
    ds_read_b64_tr_b16 v[20:21], v2 offset:28736
    ds_read_b64_tr_b16 v[22:23], v2 offset:32320
    s_waitcnt lgkmcnt(13)
    v_mfma_f32_32x32x16_bf16 v[88:103], v[24:27], v[48:51], v[88:103]
    ds_read_b64_tr_b16 v[24:25], v2 offset:28800
    ds_read_b64_tr_b16 v[26:27], v2 offset:32384
    s_waitcnt lgkmcnt(13)
    v_mfma_f32_32x32x16_bf16 v[104:119], v[28:31], v[48:51], v[104:119]
    ds_read_b64_tr_b16 v[28:29], v2 offset:28864
    ds_read_b64_tr_b16 v[30:31], v2 offset:32448
    s_waitcnt lgkmcnt(13)
    v_mfma_f32_32x32x16_bf16 v[120:135], v[32:35], v[48:51], v[120:135]
    ds_read_b64_tr_b16 v[32:33], v2 offset:28928
    ds_read_b64_tr_b16 v[34:35], v2 offset:32512
    s_waitcnt lgkmcnt(13)
    v_mfma_f32_32x32x16_bf16 v[136:151], v[36:39], v[48:51], v[136:151]
    ds_read_b64_tr_b16 v[36:37], v2 offset:28992
    ds_read_b64_tr_b16 v[38:39], v2 offset:32576
    s_waitcnt lgkmcnt(13)
    v_mfma_f32_32x32x16_bf16 v[152:167], v[40:43], v[48:51], v[152:167]
    ds_read_b64_tr_b16 v[40:41], v2 offset:29056
    ds_read_b64_tr_b16 v[42:43], v2 offset:32640
    ds_read_b128 v[48:51], v11 offset:16384
    s_waitcnt lgkmcnt(15)
    s_waitcnt lgkmcnt(13)
    v_mfma_f32_32x32x16_bf16 v[56:71], v[16:19], v[44:47], v[56:71]
    ds_read_b64_tr_b16 v[16:17], v2 offset:35840
    ds_read_b64_tr_b16 v[18:19], v2 offset:39424
    s_waitcnt lgkmcnt(13)
    v_mfma_f32_32x32x16_bf16 v[72:87], v[20:23], v[44:47], v[72:87]
    ds_read_b64_tr_b16 v[20:21], v2 offset:35904
    ds_read_b64_tr_b16 v[22:23], v2 offset:39488
    s_waitcnt lgkmcnt(13)
    v_mfma_f32_32x32x16_bf16 v[88:103], v[24:27], v[44:47], v[88:103]
    ds_read_b64_tr_b16 v[24:25], v2 offset:35968
    ds_read_b64_tr_b16 v[26:27], v2 offset:39552
    s_waitcnt lgkmcnt(13)
    v_mfma_f32_32x32x16_bf16 v[104:119], v[28:31], v[44:47], v[104:119]
    ds_read_b64_tr_b16 v[28:29], v2 offset:36032
    ds_read_b64_tr_b16 v[30:31], v2 offset:39616
    s_waitcnt lgkmcnt(13)
    v_mfma_f32_32x32x16_bf16 v[120:135], v[32:35], v[44:47], v[120:135]
    ds_read_b64_tr_b16 v[32:33], v2 offset:36096
    ds_read_b64_tr_b16 v[34:35], v2 offset:39680
    s_waitcnt lgkmcnt(13)
    v_mfma_f32_32x32x16_bf16 v[136:151], v[36:39], v[44:47], v[136:151]
    ds_read_b64_tr_b16 v[36:37], v2 offset:36160
    ds_read_b64_tr_b16 v[38:39], v2 offset:39744
    s_waitcnt lgkmcnt(13)
    v_mfma_f32_32x32x16_bf16 v[152:167], v[40:43], v[44:47], v[152:167]
    ds_read_b64_tr_b16 v[40:41], v2 offset:36224
    ds_read_b64_tr_b16 v[42:43], v2 offset:39808
    s_waitcnt lgkmcnt(14)
    s_waitcnt lgkmcnt(12)
    v_mfma_f32_32x32x16_bf16 v[56:71], v[16:19], v[48:51], v[56:71]
    s_barrier
    v_add_u32 v2, -57344, v2
    ds_read_b128 v[44:47], v8 offset:0
    ds_read_b64_tr_b16 v[16:17], v2 offset:0
    ds_read_b64_tr_b16 v[18:19], v2 offset:3584
    s_waitcnt lgkmcnt(13)
    v_mfma_f32_32x32x16_bf16 v[72:87], v[20:23], v[48:51], v[72:87]
    ds_read_b64_tr_b16 v[20:21], v2 offset:64
    ds_read_b64_tr_b16 v[22:23], v2 offset:3648
    s_waitcnt lgkmcnt(13)
    v_mfma_f32_32x32x16_bf16 v[88:103], v[24:27], v[48:51], v[88:103]
    ds_read_b64_tr_b16 v[24:25], v2 offset:128
    ds_read_b64_tr_b16 v[26:27], v2 offset:3712
    s_waitcnt lgkmcnt(13)
    v_mfma_f32_32x32x16_bf16 v[104:119], v[28:31], v[48:51], v[104:119]
    ds_read_b64_tr_b16 v[28:29], v2 offset:192
    ds_read_b64_tr_b16 v[30:31], v2 offset:3776
    s_waitcnt lgkmcnt(13)
    v_mfma_f32_32x32x16_bf16 v[120:135], v[32:35], v[48:51], v[120:135]
    ds_read_b64_tr_b16 v[32:33], v2 offset:256
    ds_read_b64_tr_b16 v[34:35], v2 offset:3840
    s_waitcnt lgkmcnt(13)
    v_mfma_f32_32x32x16_bf16 v[136:151], v[36:39], v[48:51], v[136:151]
    ds_read_b64_tr_b16 v[36:37], v2 offset:320
    ds_read_b64_tr_b16 v[38:39], v2 offset:3904
    s_waitcnt lgkmcnt(13)
    v_mfma_f32_32x32x16_bf16 v[152:167], v[40:43], v[48:51], v[152:167]
    ds_read_b64_tr_b16 v[40:41], v2 offset:384
    ds_read_b64_tr_b16 v[42:43], v2 offset:3968
    ds_read_b128 v[48:51], v9 offset:0
    s_waitcnt lgkmcnt(15)
    s_waitcnt lgkmcnt(13)
    v_mfma_f32_32x32x16_bf16 v[56:71], v[16:19], v[44:47], v[56:71]
    ds_read_b64_tr_b16 v[16:17], v2 offset:7168
    ds_read_b64_tr_b16 v[18:19], v2 offset:10752
    s_waitcnt lgkmcnt(13)
    v_mfma_f32_32x32x16_bf16 v[72:87], v[20:23], v[44:47], v[72:87]
    ds_read_b64_tr_b16 v[20:21], v2 offset:7232
    ds_read_b64_tr_b16 v[22:23], v2 offset:10816
    s_waitcnt lgkmcnt(13)
    v_mfma_f32_32x32x16_bf16 v[88:103], v[24:27], v[44:47], v[88:103]
    ds_read_b64_tr_b16 v[24:25], v2 offset:7296
    ds_read_b64_tr_b16 v[26:27], v2 offset:10880
    s_waitcnt lgkmcnt(13)
    v_mfma_f32_32x32x16_bf16 v[104:119], v[28:31], v[44:47], v[104:119]
    ds_read_b64_tr_b16 v[28:29], v2 offset:7360
    ds_read_b64_tr_b16 v[30:31], v2 offset:10944
    s_waitcnt lgkmcnt(13)
    v_mfma_f32_32x32x16_bf16 v[120:135], v[32:35], v[44:47], v[120:135]
    ds_read_b64_tr_b16 v[32:33], v2 offset:7424
    ds_read_b64_tr_b16 v[34:35], v2 offset:11008
    s_waitcnt lgkmcnt(13)
    v_mfma_f32_32x32x16_bf16 v[136:151], v[36:39], v[44:47], v[136:151]
    ds_read_b64_tr_b16 v[36:37], v2 offset:7488
    ds_read_b64_tr_b16 v[38:39], v2 offset:11072
    s_waitcnt lgkmcnt(13)
    v_mfma_f32_32x32x16_bf16 v[152:167], v[40:43], v[44:47], v[152:167]
    ds_read_b64_tr_b16 v[40:41], v2 offset:7552
    ds_read_b64_tr_b16 v[42:43], v2 offset:11136
    s_waitcnt lgkmcnt(14)
    s_waitcnt lgkmcnt(12)
    v_mfma_f32_32x32x16_bf16 v[56:71], v[16:19], v[48:51], v[56:71]
    s_barrier
    ds_read_b128 v[44:47], v10 offset:0
    ds_read_b64_tr_b16 v[16:17], v2 offset:28672
    ds_read_b64_tr_b16 v[18:19], v2 offset:32256
    s_waitcnt lgkmcnt(13)
    v_mfma_f32_32x32x16_bf16 v[72:87], v[20:23], v[48:51], v[72:87]
    ds_read_b64_tr_b16 v[20:21], v2 offset:28736
    ds_read_b64_tr_b16 v[22:23], v2 offset:32320
    s_waitcnt lgkmcnt(13)
    v_mfma_f32_32x32x16_bf16 v[88:103], v[24:27], v[48:51], v[88:103]
    ds_read_b64_tr_b16 v[24:25], v2 offset:28800
    ds_read_b64_tr_b16 v[26:27], v2 offset:32384
    s_waitcnt lgkmcnt(13)
    v_mfma_f32_32x32x16_bf16 v[104:119], v[28:31], v[48:51], v[104:119]
    ds_read_b64_tr_b16 v[28:29], v2 offset:28864
    ds_read_b64_tr_b16 v[30:31], v2 offset:32448
    s_waitcnt lgkmcnt(13)
    v_mfma_f32_32x32x16_bf16 v[120:135], v[32:35], v[48:51], v[120:135]
    ds_read_b64_tr_b16 v[32:33], v2 offset:28928
    ds_read_b64_tr_b16 v[34:35], v2 offset:32512
    s_waitcnt lgkmcnt(13)
    v_mfma_f32_32x32x16_bf16 v[136:151], v[36:39], v[48:51], v[136:151]
    ds_read_b64_tr_b16 v[36:37], v2 offset:28992
    ds_read_b64_tr_b16 v[38:39], v2 offset:32576
    s_waitcnt lgkmcnt(13)
    v_mfma_f32_32x32x16_bf16 v[152:167], v[40:43], v[48:51], v[152:167]
    ds_read_b64_tr_b16 v[40:41], v2 offset:29056
    ds_read_b64_tr_b16 v[42:43], v2 offset:32640
    ds_read_b128 v[48:51], v11 offset:0
L_tgtA:
    s_waitcnt lgkmcnt(15)
    s_waitcnt lgkmcnt(13)
    v_mfma_f32_32x32x16_bf16 v[56:71], v[16:19], v[44:47], v[56:71]
    ds_read_b64_tr_b16 v[16:17], v2 offset:35840
    ds_read_b64_tr_b16 v[18:19], v2 offset:39424
    s_waitcnt lgkmcnt(13)
    v_mfma_f32_32x32x16_bf16 v[72:87], v[20:23], v[44:47], v[72:87]
    ds_read_b64_tr_b16 v[20:21], v2 offset:35904
    ds_read_b64_tr_b16 v[22:23], v2 offset:39488
    s_waitcnt lgkmcnt(13)
    v_mfma_f32_32x32x16_bf16 v[88:103], v[24:27], v[44:47], v[88:103]
    ds_read_b64_tr_b16 v[24:25], v2 offset:35968
    ds_read_b64_tr_b16 v[26:27], v2 offset:39552
    s_waitcnt lgkmcnt(13)
    v_mfma_f32_32x32x16_bf16 v[104:119], v[28:31], v[44:47], v[104:119]
    ds_read_b64_tr_b16 v[28:29], v2 offset:36032
    ds_read_b64_tr_b16 v[30:31], v2 offset:39616
    s_waitcnt lgkmcnt(13)
    v_mfma_f32_32x32x16_bf16 v[120:135], v[32:35], v[44:47], v[120:135]
    ds_read_b64_tr_b16 v[32:33], v2 offset:36096
    ds_read_b64_tr_b16 v[34:35], v2 offset:39680
    s_waitcnt lgkmcnt(13)
    v_mfma_f32_32x32x16_bf16 v[136:151], v[36:39], v[44:47], v[136:151]
    ds_read_b64_tr_b16 v[36:37], v2 offset:36160
    ds_read_b64_tr_b16 v[38:39], v2 offset:39744
    s_waitcnt lgkmcnt(13)
    v_mfma_f32_32x32x16_bf16 v[152:167], v[40:43], v[44:47], v[152:167]
    ds_read_b64_tr_b16 v[40:41], v2 offset:36224
    ds_read_b64_tr_b16 v[42:43], v2 offset:39808
    s_waitcnt lgkmcnt(14)
    s_waitcnt lgkmcnt(12)
    v_mfma_f32_32x32x16_bf16 v[56:71], v[16:19], v[48:51], v[56:71]
    s_barrier
    v_add_u32 v2, 57344, v2
    ds_read_b128 v[44:47], v8 offset:16384
    ds_read_b64_tr_b16 v[16:17], v2 offset:0
    ds_read_b64_tr_b16 v[18:19], v2 offset:3584
    s_waitcnt lgkmcnt(13)
    v_mfma_f32_32x32x16_bf16 v[72:87], v[20:23], v[48:51], v[72:87]
    ds_read_b64_tr_b16 v[20:21], v2 offset:64
    ds_read_b64_tr_b16 v[22:23], v2 offset:3648
    s_waitcnt lgkmcnt(13)
    v_mfma_f32_32x32x16_bf16 v[88:103], v[24:27], v[48:51], v[88:103]
    ds_read_b64_tr_b16 v[24:25], v2 offset:128
    ds_read_b64_tr_b16 v[26:27], v2 offset:3712
    s_waitcnt lgkmcnt(13)
    v_mfma_f32_32x32x16_bf16 v[104:119], v[28:31], v[48:51], v[104:119]
    ds_read_b64_tr_b16 v[28:29], v2 offset:192
    ds_read_b64_tr_b16 v[30:31], v2 offset:3776
    s_waitcnt lgkmcnt(13)
    v_mfma_f32_32x32x16_bf16 v[120:135], v[32:35], v[48:51], v[120:135]
    ds_read_b64_tr_b16 v[32:33], v2 offset:256
    ds_read_b64_tr_b16 v[34:35], v2 offset:3840
    s_waitcnt lgkmcnt(13)
    v_mfma_f32_32x32x16_bf16 v[136:151], v[36:39], v[48:51], v[136:151]
    ds_read_b64_tr_b16 v[36:37], v2 offset:320
    ds_read_b64_tr_b16 v[38:39], v2 offset:3904
    s_waitcnt lgkmcnt(13)
    v_mfma_f32_32x32x16_bf16 v[152:167], v[40:43], v[48:51], v[152:167]
    ds_read_b64_tr_b16 v[40:41], v2 offset:384
    ds_read_b64_tr_b16 v[42:43], v2 offset:3968
    ds_read_b128 v[48:51], v9 offset:16384
    s_waitcnt lgkmcnt(15)
    s_waitcnt lgkmcnt(13)
    v_mfma_f32_32x32x16_bf16 v[56:71], v[16:19], v[44:47], v[56:71]
    ds_read_b64_tr_b16 v[16:17], v2 offset:7168
    ds_read_b64_tr_b16 v[18:19], v2 offset:10752
    s_waitcnt lgkmcnt(13)
    v_mfma_f32_32x32x16_bf16 v[72:87], v[20:23], v[44:47], v[72:87]
    ds_read_b64_tr_b16 v[20:21], v2 offset:7232
    ds_read_b64_tr_b16 v[22:23], v2 offset:10816
    s_waitcnt lgkmcnt(13)
    v_mfma_f32_32x32x16_bf16 v[88:103], v[24:27], v[44:47], v[88:103]
    ds_read_b64_tr_b16 v[24:25], v2 offset:7296
    ds_read_b64_tr_b16 v[26:27], v2 offset:10880
    s_waitcnt lgkmcnt(13)
    v_mfma_f32_32x32x16_bf16 v[104:119], v[28:31], v[44:47], v[104:119]
    ds_read_b64_tr_b16 v[28:29], v2 offset:7360
    ds_read_b64_tr_b16 v[30:31], v2 offset:10944
    s_waitcnt lgkmcnt(13)
    v_mfma_f32_32x32x16_bf16 v[120:135], v[32:35], v[44:47], v[120:135]
    ds_read_b64_tr_b16 v[32:33], v2 offset:7424
    ds_read_b64_tr_b16 v[34:35], v2 offset:11008
    s_waitcnt lgkmcnt(13)
    v_mfma_f32_32x32x16_bf16 v[136:151], v[36:39], v[44:47], v[136:151]
    ds_read_b64_tr_b16 v[36:37], v2 offset:7488
    ds_read_b64_tr_b16 v[38:39], v2 offset:11072
    s_waitcnt lgkmcnt(13)
    v_mfma_f32_32x32x16_bf16 v[152:167], v[40:43], v[44:47], v[152:167]
    ds_read_b64_tr_b16 v[40:41], v2 offset:7552
    ds_read_b64_tr_b16 v[42:43], v2 offset:11136
    s_waitcnt lgkmcnt(14)
    s_waitcnt lgkmcnt(12)
    v_mfma_f32_32x32x16_bf16 v[56:71], v[16:19], v[48:51], v[56:71]
    s_barrier
    ds_read_b128 v[44:47], v10 offset:16384
    ds_read_b64_tr_b16 v[16:17], v2 offset:28672
    ds_read_b64_tr_b16 v[18:19], v2 offset:32256
    s_waitcnt lgkmcnt(13)
    v_mfma_f32_32x32x16_bf16 v[72:87], v[20:23], v[48:51], v[72:87]
    ds_read_b64_tr_b16 v[20:21], v2 offset:28736
    ds_read_b64_tr_b16 v[22:23], v2 offset:32320
    s_waitcnt lgkmcnt(13)
    v_mfma_f32_32x32x16_bf16 v[88:103], v[24:27], v[48:51], v[88:103]
    ds_read_b64_tr_b16 v[24:25], v2 offset:28800
    ds_read_b64_tr_b16 v[26:27], v2 offset:32384
    s_waitcnt lgkmcnt(13)
    v_mfma_f32_32x32x16_bf16 v[104:119], v[28:31], v[48:51], v[104:119]
    ds_read_b64_tr_b16 v[28:29], v2 offset:28864
    ds_read_b64_tr_b16 v[30:31], v2 offset:32448
    s_waitcnt lgkmcnt(13)
    v_mfma_f32_32x32x16_bf16 v[120:135], v[32:35], v[48:51], v[120:135]
    ds_read_b64_tr_b16 v[32:33], v2 offset:28928
    ds_read_b64_tr_b16 v[34:35], v2 offset:32512
    s_waitcnt lgkmcnt(13)
    v_mfma_f32_32x32x16_bf16 v[136:151], v[36:39], v[48:51], v[136:151]
    ds_read_b64_tr_b16 v[36:37], v2 offset:28992
    ds_read_b64_tr_b16 v[38:39], v2 offset:32576
    s_waitcnt lgkmcnt(13)
    v_mfma_f32_32x32x16_bf16 v[152:167], v[40:43], v[48:51], v[152:167]
    ds_read_b64_tr_b16 v[40:41], v2 offset:29056
    ds_read_b64_tr_b16 v[42:43], v2 offset:32640
    ds_read_b128 v[48:51], v11 offset:16384
    s_waitcnt lgkmcnt(15)
    s_waitcnt lgkmcnt(13)
    v_mfma_f32_32x32x16_bf16 v[56:71], v[16:19], v[44:47], v[56:71]
    ds_read_b64_tr_b16 v[16:17], v2 offset:35840
    ds_read_b64_tr_b16 v[18:19], v2 offset:39424
    s_waitcnt lgkmcnt(13)
    v_mfma_f32_32x32x16_bf16 v[72:87], v[20:23], v[44:47], v[72:87]
    ds_read_b64_tr_b16 v[20:21], v2 offset:35904
    ds_read_b64_tr_b16 v[22:23], v2 offset:39488
    s_waitcnt lgkmcnt(13)
    v_mfma_f32_32x32x16_bf16 v[88:103], v[24:27], v[44:47], v[88:103]
    ds_read_b64_tr_b16 v[24:25], v2 offset:35968
    ds_read_b64_tr_b16 v[26:27], v2 offset:39552
    s_waitcnt lgkmcnt(13)
    v_mfma_f32_32x32x16_bf16 v[104:119], v[28:31], v[44:47], v[104:119]
    ds_read_b64_tr_b16 v[28:29], v2 offset:36032
    ds_read_b64_tr_b16 v[30:31], v2 offset:39616
    s_waitcnt lgkmcnt(13)
    v_mfma_f32_32x32x16_bf16 v[120:135], v[32:35], v[44:47], v[120:135]
    ds_read_b64_tr_b16 v[32:33], v2 offset:36096
    ds_read_b64_tr_b16 v[34:35], v2 offset:39680
    s_waitcnt lgkmcnt(13)
    v_mfma_f32_32x32x16_bf16 v[136:151], v[36:39], v[44:47], v[136:151]
    ds_read_b64_tr_b16 v[36:37], v2 offset:36160
    ds_read_b64_tr_b16 v[38:39], v2 offset:39744
    s_waitcnt lgkmcnt(13)
    v_mfma_f32_32x32x16_bf16 v[152:167], v[40:43], v[44:47], v[152:167]
    ds_read_b64_tr_b16 v[40:41], v2 offset:36224
    ds_read_b64_tr_b16 v[42:43], v2 offset:39808
    s_waitcnt lgkmcnt(14)
    s_waitcnt lgkmcnt(12)
    v_mfma_f32_32x32x16_bf16 v[56:71], v[16:19], v[48:51], v[56:71]
    s_barrier
    v_add_u32 v2, -57344, v2
    ds_read_b128 v[44:47], v8 offset:0
    ds_read_b64_tr_b16 v[16:17], v2 offset:0
    ds_read_b64_tr_b16 v[18:19], v2 offset:3584
    s_waitcnt lgkmcnt(13)
    v_mfma_f32_32x32x16_bf16 v[72:87], v[20:23], v[48:51], v[72:87]
    ds_read_b64_tr_b16 v[20:21], v2 offset:64
    ds_read_b64_tr_b16 v[22:23], v2 offset:3648
    s_waitcnt lgkmcnt(13)
    v_mfma_f32_32x32x16_bf16 v[88:103], v[24:27], v[48:51], v[88:103]
    ds_read_b64_tr_b16 v[24:25], v2 offset:128
    ds_read_b64_tr_b16 v[26:27], v2 offset:3712
    s_waitcnt lgkmcnt(13)
    v_mfma_f32_32x32x16_bf16 v[104:119], v[28:31], v[48:51], v[104:119]
    ds_read_b64_tr_b16 v[28:29], v2 offset:192
    ds_read_b64_tr_b16 v[30:31], v2 offset:3776
    s_waitcnt lgkmcnt(13)
    v_mfma_f32_32x32x16_bf16 v[120:135], v[32:35], v[48:51], v[120:135]
    ds_read_b64_tr_b16 v[32:33], v2 offset:256
    ds_read_b64_tr_b16 v[34:35], v2 offset:3840
    s_waitcnt lgkmcnt(13)
    v_mfma_f32_32x32x16_bf16 v[136:151], v[36:39], v[48:51], v[136:151]
    ds_read_b64_tr_b16 v[36:37], v2 offset:320
    ds_read_b64_tr_b16 v[38:39], v2 offset:3904
    s_waitcnt lgkmcnt(13)
    v_mfma_f32_32x32x16_bf16 v[152:167], v[40:43], v[48:51], v[152:167]
    ds_read_b64_tr_b16 v[40:41], v2 offset:384
    ds_read_b64_tr_b16 v[42:43], v2 offset:3968
    ds_read_b128 v[48:51], v9 offset:0
    s_waitcnt lgkmcnt(15)
    s_waitcnt lgkmcnt(13)
    v_mfma_f32_32x32x16_bf16 v[56:71], v[16:19], v[44:47], v[56:71]
    ds_read_b64_tr_b16 v[16:17], v2 offset:7168
    ds_read_b64_tr_b16 v[18:19], v2 offset:10752
    v_bfe_u32 v4, v1, 4, 5
    v_lshrrev_b32 v3, 9, v1
    v_mul_u32_u24 v3, 3584, v3
    v_lshl_add_u32 v3, v4, 2, v3
    s_mul_i32 s34, s33, 896
    s_waitcnt lgkmcnt(13)
    v_mfma_f32_32x32x16_bf16 v[72:87], v[20:23], v[44:47], v[72:87]
    ds_read_b64_tr_b16 v[20:21], v2 offset:7232
    ds_read_b64_tr_b16 v[22:23], v2 offset:10816
    s_add_u32 s34, s34, 156672
    v_add_u32 v3, s34, v3
    s_lshl_b32 s34, s32, 8
    s_add_u32 s34, s34, 155648
    v_lshlrev_b32 v5, 3, v4
    s_waitcnt lgkmcnt(13)
    v_mfma_f32_32x32x16_bf16 v[88:103], v[24:27], v[44:47], v[88:103]
    ds_read_b64_tr_b16 v[24:25], v2 offset:7296
    ds_read_b64_tr_b16 v[26:27], v2 offset:10880
    v_add_u32 v5, s34, v5
    ds_read_b64 v[14:15], v5
    v_mov_b32 v13, v3
    v_mov_b32 v4, 114688
    ds_read_b32 v3, v4
    s_waitcnt lgkmcnt(15)
    v_mfma_f32_32x32x16_bf16 v[104:119], v[28:31], v[44:47], v[104:119]
    ds_read_b64_tr_b16 v[28:29], v2 offset:7360
    ds_read_b64_tr_b16 v[30:31], v2 offset:10944
    s_waitcnt lgkmcnt(2)
    v_readfirstlane_b32 s46, v3
    v_rsq_f32 v12, v15
    v_xor_b32 v3, 0x80000000, v14
    v_mul_f32 v4, v15, v12
    v_mfma_f32_32x32x16_bf16 v[120:135], v[32:35], v[44:47], v[120:135]
    ds_read_b64_tr_b16 v[32:33], v2 offset:7424
    ds_read_b64_tr_b16 v[34:35], v2 offset:11008
    v_and_b32 v7, s52, v3
    v_sub_f32 v5, v3, v7
    v_and_b32 v7, s52, v5
    v_sub_f32 v6, v5, v7
    v_perm_b32 v52, v5, v3, s50
    v_mfma_f32_32x32x16_bf16 v[136:151], v[36:39], v[44:47], v[136:151]
    ds_read_b64_tr_b16 v[36:37], v2 offset:7488
    ds_read_b64_tr_b16 v[38:39], v2 offset:11072
    v_perm_b32 v53, v6, v3, s50
    v_and_b32 v7, s52, v4
    v_sub_f32 v3, v4, v7
    v_mov_b32 v54, v52
    v_and_b32 v7, s52, v3
    v_mfma_f32_32x32x16_bf16 v[152:167], v[40:43], v[44:47], v[152:167]
    ds_read_b64_tr_b16 v[40:41], v2 offset:7552
    ds_read_b64_tr_b16 v[42:43], v2 offset:11136
    v_sub_f32 v6, v3, v7
    v_perm_b32 v7, v3, v4, s50
    v_lshrrev_b32 v6, 16, v6
    v_cmp_gt_u32 vcc, 512, v1
    s_nop 1
    v_cndmask_b32 v55, v6, v7, vcc
    v_mfma_f32_32x32x16_bf16 v[56:71], v[16:19], v[48:51], v[56:71]
    s_barrier
    ds_read_b128 v[44:47], v10 offset:0
    ds_read_b64_tr_b16 v[16:17], v2 offset:28672
    ds_read_b64_tr_b16 v[18:19], v2 offset:32256
    s_not_b32 s47, s46
    v_mfma_f32_32x32x16_bf16 v[72:87], v[20:23], v[48:51], v[72:87]
    ds_read_b64_tr_b16 v[20:21], v2 offset:28736
    ds_read_b64_tr_b16 v[22:23], v2 offset:32320
    v_mfma_f32_32x32x16_bf16 v[88:103], v[24:27], v[48:51], v[88:103]
    ds_read_b64_tr_b16 v[24:25], v2 offset:28800
    ds_read_b64_tr_b16 v[26:27], v2 offset:32384
    s_waitcnt lgkmcnt(13)
    v_mfma_f32_32x32x16_bf16 v[104:119], v[28:31], v[48:51], v[104:119]
    ds_read_b64_tr_b16 v[28:29], v2 offset:28864
    ds_read_b64_tr_b16 v[30:31], v2 offset:32448
    s_waitcnt lgkmcnt(13)
    v_mfma_f32_32x32x16_bf16 v[120:135], v[32:35], v[48:51], v[120:135]
    ds_read_b64_tr_b16 v[32:33], v2 offset:28928
    ds_read_b64_tr_b16 v[34:35], v2 offset:32512
    s_waitcnt lgkmcnt(13)
    v_mfma_f32_32x32x16_bf16 v[136:151], v[36:39], v[48:51], v[136:151]
    ds_read_b64_tr_b16 v[36:37], v2 offset:28992
    ds_read_b64_tr_b16 v[38:39], v2 offset:32576
    s_waitcnt lgkmcnt(13)
    v_mfma_f32_32x32x16_bf16 v[152:167], v[40:43], v[48:51], v[152:167]
    ds_read_b64_tr_b16 v[40:41], v2 offset:29056
    ds_read_b64_tr_b16 v[42:43], v2 offset:32640
    ds_read_b128 v[48:51], v11 offset:0
    s_waitcnt lgkmcnt(15)
    s_waitcnt lgkmcnt(13)
    v_mfma_f32_32x32x16_bf16 v[56:71], v[16:19], v[44:47], v[56:71]
    ds_read_b64_tr_b16 v[16:17], v2 offset:35840
    ds_read_b64_tr_b16 v[18:19], v2 offset:39424
    s_waitcnt lgkmcnt(13)
    v_mfma_f32_32x32x16_bf16 v[72:87], v[20:23], v[44:47], v[72:87]
    ds_read_b64_tr_b16 v[20:21], v2 offset:35904
    ds_read_b64_tr_b16 v[22:23], v2 offset:39488
    s_waitcnt lgkmcnt(13)
    v_mfma_f32_32x32x16_bf16 v[88:103], v[24:27], v[44:47], v[88:103]
    ds_read_b64_tr_b16 v[24:25], v2 offset:35968
    ds_read_b64_tr_b16 v[26:27], v2 offset:39552
    s_waitcnt lgkmcnt(13)
    v_mfma_f32_32x32x16_bf16 v[104:119], v[28:31], v[44:47], v[104:119]
    ds_read_b64_tr_b16 v[28:29], v2 offset:36032
    ds_read_b64_tr_b16 v[30:31], v2 offset:39616
    s_waitcnt lgkmcnt(13)
    v_mfma_f32_32x32x16_bf16 v[120:135], v[32:35], v[44:47], v[120:135]
    ds_read_b64_tr_b16 v[32:33], v2 offset:36096
    ds_read_b64_tr_b16 v[34:35], v2 offset:39680
    s_waitcnt lgkmcnt(13)
    v_mfma_f32_32x32x16_bf16 v[136:151], v[36:39], v[44:47], v[136:151]
    ds_read_b64_tr_b16 v[36:37], v2 offset:36160
    ds_read_b64_tr_b16 v[38:39], v2 offset:39744
    s_waitcnt lgkmcnt(13)
    v_mfma_f32_32x32x16_bf16 v[152:167], v[40:43], v[44:47], v[152:167]
    ds_read_b64_tr_b16 v[40:41], v2 offset:36224
    ds_read_b64_tr_b16 v[42:43], v2 offset:39808
    s_waitcnt lgkmcnt(14)
    s_waitcnt lgkmcnt(12)
    v_mfma_f32_32x32x16_bf16 v[56:71], v[16:19], v[48:51], v[56:71]
    s_waitcnt lgkmcnt(10)
    v_mfma_f32_32x32x16_bf16 v[72:87], v[20:23], v[48:51], v[72:87]
    s_waitcnt lgkmcnt(8)
    v_mfma_f32_32x32x16_bf16 v[88:103], v[24:27], v[48:51], v[88:103]
    s_waitcnt lgkmcnt(6)
    v_mfma_f32_32x32x16_bf16 v[104:119], v[28:31], v[48:51], v[104:119]
    s_waitcnt lgkmcnt(4)
    v_mfma_f32_32x32x16_bf16 v[120:135], v[32:35], v[48:51], v[120:135]
    s_waitcnt lgkmcnt(2)
    v_mfma_f32_32x32x16_bf16 v[136:151], v[36:39], v[48:51], v[136:151]
    s_waitcnt lgkmcnt(0)
    v_mfma_f32_32x32x16_bf16 v[152:167], v[40:43], v[48:51], v[152:167]
    ds_read_b32 v16, v13 offset:0
    ds_read_b32 v17, v13 offset:1792
    ds_read_b32 v18, v13 offset:128
    ds_read_b32 v19, v13 offset:1920
    ds_read_b32 v20, v13 offset:256
    ds_read_b32 v21, v13 offset:2048
    ds_read_b32 v22, v13 offset:384
    ds_read_b32 v23, v13 offset:2176
    ds_read_b32 v24, v13 offset:512
    ds_read_b32 v25, v13 offset:2304
    ds_read_b32 v26, v13 offset:640
    ds_read_b32 v27, v13 offset:2432
    ds_read_b32 v28, v13 offset:768
    ds_read_b32 v29, v13 offset:2560
    v_bfe_u32 v6, v1, 4, 5
    s_lshl_b32 s34, s32, 5
    v_add_u32 v6, s34, v6
    v_mul_u32_u24 v6, 328, v6
    v_lshrrev_b32 v7, 9, v1
    v_lshl_add_u32 v8, v7, 3, v6
    v_lshl_add_u32 v9, v7, 2, v8
    v_add_u32 v10, 94464, v8
    v_add_u32 v11, 94464, v9
    s_waitcnt lgkmcnt(0)
    s_barrier
    v_add_f32 v16, v16, v17
    v_add_f32 v18, v18, v19
    v_add_f32 v20, v20, v21
    v_add_f32 v22, v22, v23
    v_add_f32 v24, v24, v25
    v_add_f32 v26, v26, v27
    v_add_f32 v28, v28, v29
    v_and_b32 v3, s52, v16
    v_sub_f32 v4, v16, v3
    v_and_b32 v3, s52, v4
    v_sub_f32 v5, v4, v3
    v_perm_b32 v32, v16, v16, s50
    v_perm_b32 v33, v16, v4, s50
    v_perm_b32 v34, v4, v5, s50
    v_mov_b32 v35, 0
    s_nop 1
    v_mfma_f32_32x32x16_bf16 v[56:71], v[32:35], v[52:55], v[56:71]
    v_and_b32 v3, s52, v18
    v_sub_f32 v4, v18, v3
    v_and_b32 v3, s52, v4
    v_sub_f32 v5, v4, v3
    v_perm_b32 v32, v18, v18, s50
    v_perm_b32 v33, v18, v4, s50
    v_perm_b32 v34, v4, v5, s50
    v_mov_b32 v35, 0
    s_nop 1
    v_mfma_f32_32x32x16_bf16 v[72:87], v[32:35], v[52:55], v[72:87]
    v_and_b32 v3, s52, v20
    v_sub_f32 v4, v20, v3
    v_and_b32 v3, s52, v4
    v_sub_f32 v5, v4, v3
    v_perm_b32 v32, v20, v20, s50
    v_perm_b32 v33, v20, v4, s50
    v_perm_b32 v34, v4, v5, s50
    v_mov_b32 v35, 0
    s_nop 1
    v_mfma_f32_32x32x16_bf16 v[88:103], v[32:35], v[52:55], v[88:103]
    v_and_b32 v3, s52, v22
    v_sub_f32 v4, v22, v3
    v_and_b32 v3, s52, v4
    v_sub_f32 v5, v4, v3
    v_perm_b32 v32, v22, v22, s50
    v_perm_b32 v33, v22, v4, s50
    v_perm_b32 v34, v4, v5, s50
    v_mov_b32 v35, 0
    s_nop 1
    v_mfma_f32_32x32x16_bf16 v[104:119], v[32:35], v[52:55], v[104:119]
    v_and_b32 v3, s52, v24
    v_sub_f32 v4, v24, v3
    v_and_b32 v3, s52, v4
    v_sub_f32 v5, v4, v3
    v_perm_b32 v32, v24, v24, s50
    v_perm_b32 v33, v24, v4, s50
    v_perm_b32 v34, v4, v5, s50
    v_mov_b32 v35, 0
    s_nop 1
    v_mfma_f32_32x32x16_bf16 v[120:135], v[32:35], v[52:55], v[120:135]
    v_and_b32 v3, s52, v26
    v_sub_f32 v4, v26, v3
    v_and_b32 v3, s52, v4
    v_sub_f32 v5, v4, v3
    v_perm_b32 v32, v26, v26, s50
    v_perm_b32 v33, v26, v4, s50
    v_perm_b32 v34, v4, v5, s50
    v_mov_b32 v35, 0
    s_nop 1
    v_mfma_f32_32x32x16_bf16 v[136:151], v[32:35], v[52:55], v[136:151]
    v_and_b32 v3, s52, v28
    v_sub_f32 v4, v28, v3
    v_and_b32 v3, s52, v4
    v_sub_f32 v5, v4, v3
    v_perm_b32 v32, v28, v28, s50
    v_perm_b32 v33, v28, v4, s50
    v_perm_b32 v34, v4, v5, s50
    v_mov_b32 v35, 0
    s_nop 1
    v_mfma_f32_32x32x16_bf16 v[152:167], v[32:35], v[52:55], v[152:167]
    v_mul_f32 v56, v56, v12
    v_mul_f32 v57, v57, v12
    v_cvt_pk_bf16_f32 v56, v56, v57
    v_mul_f32 v58, v58, v12
    v_mul_f32 v59, v59, v12
    v_cvt_pk_bf16_f32 v57, v58, v59
    v_mul_f32 v60, v60, v12
    v_mul_f32 v61, v61, v12
    v_cvt_pk_bf16_f32 v58, v60, v61
    v_mul_f32 v62, v62, v12
    v_mul_f32 v63, v63, v12
    v_cvt_pk_bf16_f32 v60, v62, v63
    v_mul_f32 v64, v64, v12
    v_mul_f32 v65, v65, v12
    v_cvt_pk_bf16_f32 v61, v64, v65
    v_mul_f32 v66, v66, v12
    v_mul_f32 v67, v67, v12
    v_cvt_pk_bf16_f32 v62, v66, v67
    v_mul_f32 v68, v68, v12
    v_mul_f32 v69, v69, v12
    v_cvt_pk_bf16_f32 v64, v68, v69
    v_mul_f32 v70, v70, v12
    v_mul_f32 v71, v71, v12
    v_cvt_pk_bf16_f32 v65, v70, v71
    v_mul_f32 v72, v72, v12
    v_mul_f32 v73, v73, v12
    v_cvt_pk_bf16_f32 v66, v72, v73
    v_mul_f32 v74, v74, v12
    v_mul_f32 v75, v75, v12
    v_cvt_pk_bf16_f32 v68, v74, v75
    v_mul_f32 v76, v76, v12
    v_mul_f32 v77, v77, v12
    v_cvt_pk_bf16_f32 v69, v76, v77
    v_mul_f32 v78, v78, v12
    v_mul_f32 v79, v79, v12
    v_cvt_pk_bf16_f32 v70, v78, v79
    v_mul_f32 v80, v80, v12
    v_mul_f32 v81, v81, v12
    v_cvt_pk_bf16_f32 v72, v80, v81
    v_mul_f32 v82, v82, v12
    v_mul_f32 v83, v83, v12
    v_cvt_pk_bf16_f32 v73, v82, v83
    v_mul_f32 v84, v84, v12
    v_mul_f32 v85, v85, v12
    v_cvt_pk_bf16_f32 v74, v84, v85
    v_mul_f32 v86, v86, v12
    v_mul_f32 v87, v87, v12
    v_cvt_pk_bf16_f32 v76, v86, v87
    v_mul_f32 v88, v88, v12
    v_mul_f32 v89, v89, v12
    v_cvt_pk_bf16_f32 v77, v88, v89
    v_mul_f32 v90, v90, v12
    v_mul_f32 v91, v91, v12
    v_cvt_pk_bf16_f32 v78, v90, v91
    v_mul_f32 v92, v92, v12
    v_mul_f32 v93, v93, v12
    v_cvt_pk_bf16_f32 v80, v92, v93
    v_mul_f32 v94, v94, v12
    v_mul_f32 v95, v95, v12
    v_cvt_pk_bf16_f32 v81, v94, v95
    v_mul_f32 v96, v96, v12
    v_mul_f32 v97, v97, v12
    v_cvt_pk_bf16_f32 v82, v96, v97
    v_mul_f32 v98, v98, v12
    v_mul_f32 v99, v99, v12
    v_cvt_pk_bf16_f32 v84, v98, v99
    v_mul_f32 v100, v100, v12
    v_mul_f32 v101, v101, v12
    v_cvt_pk_bf16_f32 v85, v100, v101
    v_mul_f32 v102, v102, v12
    v_mul_f32 v103, v103, v12
    v_cvt_pk_bf16_f32 v86, v102, v103
    v_mul_f32 v104, v104, v12
    v_mul_f32 v105, v105, v12
    v_cvt_pk_bf16_f32 v88, v104, v105
    v_mul_f32 v106, v106, v12
    v_mul_f32 v107, v107, v12
    v_cvt_pk_bf16_f32 v89, v106, v107
    v_mul_f32 v108, v108, v12
    v_mul_f32 v109, v109, v12
    v_cvt_pk_bf16_f32 v90, v108, v109
    v_mul_f32 v110, v110, v12
    v_mul_f32 v111, v111, v12
    v_cvt_pk_bf16_f32 v92, v110, v111
    v_mul_f32 v112, v112, v12
    v_mul_f32 v113, v113, v12
    v_cvt_pk_bf16_f32 v93, v112, v113
    v_mul_f32 v114, v114, v12
    v_mul_f32 v115, v115, v12
    v_cvt_pk_bf16_f32 v94, v114, v115
    v_mul_f32 v116, v116, v12
    v_mul_f32 v117, v117, v12
    v_cvt_pk_bf16_f32 v96, v116, v117
    v_mul_f32 v118, v118, v12
    v_mul_f32 v119, v119, v12
    v_cvt_pk_bf16_f32 v97, v118, v119
    v_mul_f32 v120, v120, v12
    v_mul_f32 v121, v121, v12
    v_cvt_pk_bf16_f32 v98, v120, v121
    v_mul_f32 v122, v122, v12
    v_mul_f32 v123, v123, v12
    v_cvt_pk_bf16_f32 v100, v122, v123
    v_mul_f32 v124, v124, v12
    v_mul_f32 v125, v125, v12
    v_cvt_pk_bf16_f32 v101, v124, v125
    v_mul_f32 v126, v126, v12
    v_mul_f32 v127, v127, v12
    v_cvt_pk_bf16_f32 v102, v126, v127
    v_mul_f32 v128, v128, v12
    v_mul_f32 v129, v129, v12
    v_cvt_pk_bf16_f32 v104, v128, v129
    v_mul_f32 v130, v130, v12
    v_mul_f32 v131, v131, v12
    v_cvt_pk_bf16_f32 v105, v130, v131
    v_mul_f32 v132, v132, v12
    v_mul_f32 v133, v133, v12
    v_cvt_pk_bf16_f32 v106, v132, v133
    v_mul_f32 v134, v134, v12
    v_mul_f32 v135, v135, v12
    v_cvt_pk_bf16_f32 v108, v134, v135
    v_mul_f32 v136, v136, v12
    v_mul_f32 v137, v137, v12
    v_cvt_pk_bf16_f32 v109, v136, v137
    v_mul_f32 v138, v138, v12
    v_mul_f32 v139, v139, v12
    v_cvt_pk_bf16_f32 v110, v138, v139
    v_mul_f32 v140, v140, v12
    v_mul_f32 v141, v141, v12
    v_cvt_pk_bf16_f32 v112, v140, v141
    v_mul_f32 v142, v142, v12
    v_mul_f32 v143, v143, v12
    v_cvt_pk_bf16_f32 v113, v142, v143
    v_mul_f32 v144, v144, v12
    v_mul_f32 v145, v145, v12
    v_cvt_pk_bf16_f32 v114, v144, v145
    v_mul_f32 v146, v146, v12
    v_mul_f32 v147, v147, v12
    v_cvt_pk_bf16_f32 v116, v146, v147
    v_mul_f32 v148, v148, v12
    v_mul_f32 v149, v149, v12
    v_cvt_pk_bf16_f32 v117, v148, v149
    v_mul_f32 v150, v150, v12
    v_mul_f32 v151, v151, v12
    v_cvt_pk_bf16_f32 v118, v150, v151
    v_mul_f32 v152, v152, v12
    v_mul_f32 v153, v153, v12
    v_cvt_pk_bf16_f32 v120, v152, v153
    v_mul_f32 v154, v154, v12
    v_mul_f32 v155, v155, v12
    v_cvt_pk_bf16_f32 v121, v154, v155
    v_mul_f32 v156, v156, v12
    v_mul_f32 v157, v157, v12
    v_cvt_pk_bf16_f32 v122, v156, v157
    v_mul_f32 v158, v158, v12
    v_mul_f32 v159, v159, v12
    v_cvt_pk_bf16_f32 v124, v158, v159
    v_mul_f32 v160, v160, v12
    v_mul_f32 v161, v161, v12
    v_cvt_pk_bf16_f32 v125, v160, v161
    v_mul_f32 v162, v162, v12
    v_mul_f32 v163, v163, v12
    v_cvt_pk_bf16_f32 v126, v162, v163
    v_mul_f32 v164, v164, v12
    v_mul_f32 v165, v165, v12
    v_cvt_pk_bf16_f32 v128, v164, v165
    v_mul_f32 v166, v166, v12
    v_mul_f32 v167, v167, v12
    v_cvt_pk_bf16_f32 v129, v166, v167
    s_cmp_lg_u32 s32, 3
    s_nop 1
    s_cbranch_scc1 L_apub_done
    v_mov_b32 v59, s46
    v_mov_b32 v63, s46
    v_mov_b32 v67, s46
    v_mov_b32 v71, s46
    v_mov_b32 v75, s46
    v_mov_b32 v79, s46
    v_mov_b32 v83, s46
    v_mov_b32 v87, s46
    v_mov_b32 v91, s46
    v_mov_b32 v95, s46
    v_mov_b32 v99, s46
    v_mov_b32 v103, s46
    v_mov_b32 v107, s46
    v_mov_b32 v111, s46
    v_mov_b32 v115, s46
    v_mov_b32 v119, s46
    v_mov_b32 v123, s46
    v_mov_b32 v127, s46
    v_mov_b32 v131, s46
    s_mov_b32 exec_lo, 0xffff0000
    s_mov_b32 exec_hi, 0xffff0000
    s_add_u32 s37, s44, 0
    buffer_store_dwordx4 v[56:59], v1, s[16:19], s37 offen offset:0 sc1
    buffer_store_dwordx4 v[60:63], v1, s[16:19], s37 offen offset:1024 sc1
    buffer_store_dwordx4 v[64:67], v1, s[16:19], s37 offen offset:2048 sc1
    buffer_store_dwordx4 v[68:71], v1, s[16:19], s37 offen offset:3072 sc1
    s_add_u32 s37, s44, 4096
    buffer_store_dwordx4 v[72:75], v1, s[16:19], s37 offen offset:0 sc1
    buffer_store_dwordx4 v[76:79], v1, s[16:19], s37 offen offset:1024 sc1
    s_cmp_eq_u32 s33, 1
    s_cbranch_scc1 L_apub_x
    buffer_store_dwordx4 v[80:83], v1, s[16:19], s37 offen offset:2048 sc1
    buffer_store_dwordx4 v[84:87], v1, s[16:19], s37 offen offset:3072 sc1
    s_add_u32 s37, s44, 8192
    buffer_store_dwordx4 v[88:91], v1, s[16:19], s37 offen offset:0 sc1
    buffer_store_dwordx4 v[92:95], v1, s[16:19], s37 offen offset:1024 sc1
    buffer_store_dwordx4 v[96:99], v1, s[16:19], s37 offen offset:2048 sc1
    buffer_store_dwordx4 v[100:103], v1, s[16:19], s37 offen offset:3072 sc1
    s_add_u32 s37, s44, 12288
    buffer_store_dwordx4 v[104:107], v1, s[16:19], s37 offen offset:0 sc1
    buffer_store_dwordx4 v[108:111], v1, s[16:19], s37 offen offset:1024 sc1
    buffer_store_dwordx4 v[112:115], v1, s[16:19], s37 offen offset:2048 sc1
    buffer_store_dwordx4 v[116:119], v1, s[16:19], s37 offen offset:3072 sc1
    s_add_u32 s37, s44, 16384
    buffer_store_dwordx4 v[120:123], v1, s[16:19], s37 offen offset:0 sc1
    buffer_store_dwordx4 v[124:127], v1, s[16:19], s37 offen offset:1024 sc1
    buffer_store_dwordx4 v[128:131], v1, s[16:19], s37 offen offset:2048 sc1
L_apub_x:
    s_mov_b64 exec, -1
    s_nop 0
L_apub_done:
    s_cmp_eq_u32 s33, 1
    s_cbranch_scc1 L_aw1
    ds_write_b32 v8, v56 offset:5248
    ds_write_b32 v8, v57 offset:5252
    ds_write_b32 v8, v58 offset:5264
    ds_write_b32 v8, v60 offset:5268
    ds_write_b32 v9, v61 offset:5280
    ds_write_b32 v8, v62 offset:5288
    ds_write_b32 v8, v64 offset:5300
    ds_write_b32 v8, v65 offset:5304
    ds_write_b32 v9, v66 offset:5316
    ds_write_b32 v9, v68 offset:5320
    ds_write_b32 v8, v69 offset:5336
    ds_write_b32 v8, v70 offset:5340
    ds_write_b32 v8, v72 offset:5352
    ds_write_b32 v9, v73 offset:5356
    ds_write_b32 v8, v74 offset:5372
    ds_write_b32 v8, v76 offset:5376
    ds_write_b32 v8, v77 offset:5388
    ds_write_b32 v8, v78 offset:5392
    ds_write_b32 v8, v80 offset:5408
    ds_write_b32 v8, v81 offset:5412
    ds_write_b32 v8, v82 offset:5424
    ds_write_b32 v8, v84 offset:5428
    ds_write_b32 v9, v85 offset:5440
    ds_write_b32 v8, v86 offset:5448
    ds_write_b32 v8, v88 offset:5460
    ds_write_b32 v8, v89 offset:5464
    ds_write_b32 v9, v90 offset:5476
    ds_write_b32 v9, v92 offset:5480
    ds_write_b32 v8, v93 offset:5496
    ds_write_b32 v8, v94 offset:5500
    ds_write_b32 v8, v96 offset:5512
    ds_write_b32 v9, v97 offset:5516
    ds_write_b32 v8, v98 offset:5532
    ds_write_b32 v8, v100 offset:5536
    ds_write_b32 v8, v101 offset:5548
    ds_write_b32 v8, v102 offset:5552
    ds_write_b32 v8, v104 offset:52480
    ds_write_b32 v8, v105 offset:52484
    ds_write_b32 v8, v106 offset:52496
    ds_write_b32 v8, v108 offset:52500
    ds_write_b32 v9, v109 offset:52512
    ds_write_b32 v8, v110 offset:52520
    ds_write_b32 v8, v112 offset:52532
    ds_write_b32 v8, v113 offset:52536
    ds_write_b32 v9, v114 offset:52548
    ds_write_b32 v9, v116 offset:52552
    ds_write_b32 v8, v117 offset:52568
    ds_write_b32 v8, v118 offset:52572
    ds_write_b32 v8, v120 offset:52584
    ds_write_b32 v9, v121 offset:52588
    ds_write_b32 v8, v122 offset:52604
    ds_write_b32 v8, v124 offset:52608
    ds_write_b32 v8, v125 offset:52620
    ds_write_b32 v8, v126 offset:52624
    ds_write_b32 v8, v128 offset:52640
    ds_write_b32 v8, v129 offset:52644
    s_branch L_aw2
L_aw1:
    ds_write_b32 v8, v56 offset:52656
    ds_write_b32 v8, v57 offset:52660
    ds_write_b32 v9, v58 offset:52672
    ds_write_b32 v8, v60 offset:52680
    ds_write_b32 v8, v61 offset:52692
    ds_write_b32 v8, v62 offset:52696
    ds_write_b32 v9, v64 offset:52708
    ds_write_b32 v9, v65 offset:52712
    ds_write_b32 v8, v66 offset:52728
    ds_write_b32 v8, v68 offset:52732
    ds_write_b32 v8, v69 offset:52744
    ds_write_b32 v9, v70 offset:52748
    ds_write_b32 v8, v72 offset:52764
    ds_write_b32 v8, v73 offset:52768
    ds_write_b32 v8, v74 offset:52780
    ds_write_b32 v8, v76 offset:52784
    ds_write_b32 v10, v77 offset:0
    ds_write_b32 v10, v78 offset:4
    ds_write_b32 v10, v80 offset:16
    ds_write_b32 v10, v81 offset:20
    ds_write_b32 v11, v82 offset:32
    ds_write_b32 v10, v84 offset:40
    ds_write_b32 v10, v85 offset:52
    ds_write_b32 v10, v86 offset:56
    ds_write_b32 v11, v88 offset:68
    ds_write_b32 v11, v89 offset:72
    ds_write_b32 v10, v90 offset:88
    ds_write_b32 v10, v92 offset:92
    ds_write_b32 v10, v93 offset:104
    ds_write_b32 v11, v94 offset:108
    ds_write_b32 v10, v96 offset:124
    ds_write_b32 v10, v97 offset:128
    ds_write_b32 v10, v98 offset:140
    ds_write_b32 v10, v100 offset:144
    ds_write_b32 v10, v101 offset:160
    ds_write_b32 v10, v102 offset:164
    ds_write_b32 v10, v104 offset:176
    ds_write_b32 v10, v105 offset:180
    ds_write_b32 v11, v106 offset:192
    ds_write_b32 v10, v108 offset:200
    ds_write_b32 v10, v109 offset:212
    ds_write_b32 v10, v110 offset:216
    ds_write_b32 v11, v112 offset:228
    ds_write_b32 v11, v113 offset:232
    ds_write_b32 v10, v114 offset:248
    ds_write_b32 v10, v116 offset:252
    ds_write_b32 v10, v117 offset:264
    ds_write_b32 v11, v118 offset:268
    ds_write_b32 v10, v120 offset:284
    ds_write_b32 v10, v121 offset:288
    ds_write_b32 v10, v122 offset:300
    ds_write_b32 v10, v124 offset:304
L_aw2:
    s_waitcnt lgkmcnt(0)
    s_barrier
    s_cmp_eq_u32 s31, 0
    s_cbranch_scc1 L_aend
L_attn:
    v_bfe_u32 v3, v1, 4, 3
    v_bfe_u32 v4, v1, 7, 1
    v_lshrrev_b32 v5, 8, v1
    v_lshl_add_u32 v4, v5, 2, v4
    s_lshl_b32 s34, s53, 4
    v_add_u32 v11, s34, v4
    v_mul_u32_u24 v4, 328, v11
    v_mul_u32_u24 v5, 40, v3
    v_add_u32 v8, v4, v5
    v_add_u32 v9, 94464, v8
    ds_read_b64 v[146:147], v9 offset:0
    ds_read_b64 v[148:149], v9 offset:8
    ds_read_b64 v[150:151], v9 offset:16
    ds_read_b64 v[152:153], v9 offset:24
    ds_read_b64 v[154:155], v9 offset:32
    ds_read_b64 v[156:157], v9 offset:656
    ds_read_b64 v[158:159], v9 offset:664
    ds_read_b64 v[160:161], v9 offset:672
    ds_read_b64 v[162:163], v9 offset:680
    ds_read_b64 v[164:165], v9 offset:688
    ds_read_b64 v[56:57], v8 offset:5904
    ds_read_b64 v[58:59], v8 offset:5912
    ds_read_b64 v[60:61], v8 offset:5920
    ds_read_b64 v[62:63], v8 offset:5928
    ds_read_b64 v[64:65], v8 offset:5936
    ds_read_b64 v[66:67], v8 offset:5248
    ds_read_b64 v[68:69], v8 offset:5256
    ds_read_b64 v[70:71], v8 offset:5264
    ds_read_b64 v[72:73], v8 offset:5272
    ds_read_b64 v[74:75], v8 offset:5280
    ds_read_b64 v[76:77], v8 offset:4592
    ds_read_b64 v[78:79], v8 offset:4600
    ds_read_b64 v[80:81], v8 offset:4608
    ds_read_b64 v[82:83], v8 offset:4616
    ds_read_b64 v[84:85], v8 offset:4624
    ds_read_b64 v[86:87], v8 offset:3936
    ds_read_b64 v[88:89], v8 offset:3944
    ds_read_b64 v[90:91], v8 offset:3952
    ds_read_b64 v[92:93], v8 offset:3960
    ds_read_b64 v[94:95], v8 offset:3968
    ds_read_b64 v[96:97], v8 offset:3280
    ds_read_b64 v[98:99], v8 offset:3288
    ds_read_b64 v[100:101], v8 offset:3296
    ds_read_b64 v[102:103], v8 offset:3304
    ds_read_b64 v[104:105], v8 offset:3312
    ds_read_b64 v[106:107], v8 offset:2624
    ds_read_b64 v[108:109], v8 offset:2632
    ds_read_b64 v[110:111], v8 offset:2640
    ds_read_b64 v[112:113], v8 offset:2648
    ds_read_b64 v[114:115], v8 offset:2656
    ds_read_b64 v[116:117], v8 offset:1968
    ds_read_b64 v[118:119], v8 offset:1976
    ds_read_b64 v[120:121], v8 offset:1984
    ds_read_b64 v[122:123], v8 offset:1992
    ds_read_b64 v[124:125], v8 offset:2000
    ds_read_b64 v[126:127], v8 offset:1312
    ds_read_b64 v[128:129], v8 offset:1320
    ds_read_b64 v[130:131], v8 offset:1328
    ds_read_b64 v[132:133], v8 offset:1336
    ds_read_b64 v[134:135], v8 offset:1344
    ds_read_b64 v[136:137], v8 offset:656
    ds_read_b64 v[138:139], v8 offset:664
    ds_read_b64 v[140:141], v8 offset:672
    ds_read_b64 v[142:143], v8 offset:680
    ds_read_b64 v[144:145], v8 offset:688
    v_mul_u32_u24 v5, 36, v3
    v_add_u32 v10, v4, v5
    v_add_u32 v10, 94464, v10
    v_lshlrev_b32 v4, 3, v11
    v_add_u32 v4, 155652, v4
    ds_read_b32 v12, v4
    ds_read_b32 v13, v4 offset:16
    v_mov_b32 v2, 0
    v_mov_b32 v16, 0
    v_mov_b32 v17, 0
    v_mov_b32 v18, 0
    v_mov_b32 v19, 0
    v_mov_b32 v20, 0
    v_mov_b32 v21, 0
    v_mov_b32 v22, 0
    v_mov_b32 v23, 0
    v_mov_b32 v24, 0
    v_mov_b32 v25, 0
    v_mov_b32 v26, 0
    v_mov_b32 v27, 0
    v_mov_b32 v28, 0
    v_mov_b32 v29, 0
    v_mov_b32 v30, 0
    v_mov_b32 v31, 0
    s_waitcnt lgkmcnt(15)
    v_dot2c_f32_bf16 v24, v156, v56
    v_dot2c_f32_bf16 v24, v157, v57
    v_dot2c_f32_bf16 v24, v158, v58
    v_dot2c_f32_bf16 v24, v159, v59
    v_dot2c_f32_bf16 v24, v160, v60
    v_dot2c_f32_bf16 v24, v161, v61
    v_dot2c_f32_bf16 v24, v162, v62
    v_dot2c_f32_bf16 v24, v163, v63
    v_dot2c_f32_bf16 v24, v164, v64
    ds_read_b64 v[56:57], v8 offset:53136
    ds_read_b64 v[58:59], v8 offset:53144
    ds_read_b64 v[60:61], v8 offset:53152
    ds_read_b64 v[62:63], v8 offset:53160
    ds_read_b64 v[64:65], v8 offset:53168
    v_dot2c_f32_bf16 v16, v146, v66
    v_dot2c_f32_bf16 v25, v156, v66
    v_dot2c_f32_bf16 v16, v147, v67
    v_dot2c_f32_bf16 v25, v157, v67
    v_dot2c_f32_bf16 v16, v148, v68
    v_dot2c_f32_bf16 v25, v158, v68
    v_dot2c_f32_bf16 v16, v149, v69
    v_dot2c_f32_bf16 v25, v159, v69
    v_dot2c_f32_bf16 v16, v150, v70
    v_dot2c_f32_bf16 v25, v160, v70
    v_dot2c_f32_bf16 v16, v151, v71
    v_dot2c_f32_bf16 v25, v161, v71
    v_dot2c_f32_bf16 v16, v152, v72
    v_dot2c_f32_bf16 v25, v162, v72
    v_dot2c_f32_bf16 v16, v153, v73
    v_dot2c_f32_bf16 v25, v163, v73
    v_dot2c_f32_bf16 v16, v154, v74
    v_dot2c_f32_bf16 v25, v164, v74
    ds_read_b64 v[66:67], v8 offset:52480
    ds_read_b64 v[68:69], v8 offset:52488
    ds_read_b64 v[70:71], v8 offset:52496
    ds_read_b64 v[72:73], v8 offset:52504
    ds_read_b64 v[74:75], v8 offset:52512
    v_dot2c_f32_bf16 v17, v146, v76
    v_dot2c_f32_bf16 v26, v156, v76
    v_dot2c_f32_bf16 v17, v147, v77
    v_dot2c_f32_bf16 v26, v157, v77
    v_dot2c_f32_bf16 v17, v148, v78
    v_dot2c_f32_bf16 v26, v158, v78
    v_dot2c_f32_bf16 v17, v149, v79
    v_dot2c_f32_bf16 v26, v159, v79
    v_dot2c_f32_bf16 v17, v150, v80
    v_dot2c_f32_bf16 v26, v160, v80
    v_dot2c_f32_bf16 v17, v151, v81
    v_dot2c_f32_bf16 v26, v161, v81
    v_dot2c_f32_bf16 v17, v152, v82
    v_dot2c_f32_bf16 v26, v162, v82
    v_dot2c_f32_bf16 v17, v153, v83
    v_dot2c_f32_bf16 v26, v163, v83
    v_dot2c_f32_bf16 v17, v154, v84
    v_dot2c_f32_bf16 v26, v164, v84
    ds_read_b64 v[76:77], v8 offset:51824
    ds_read_b64 v[78:79], v8 offset:51832
    ds_read_b64 v[80:81], v8 offset:51840
    ds_read_b64 v[82:83], v8 offset:51848
    ds_read_b64 v[84:85], v8 offset:51856
    v_dot2c_f32_bf16 v18, v146, v86
    v_dot2c_f32_bf16 v27, v156, v86
    v_dot2c_f32_bf16 v18, v147, v87
    v_dot2c_f32_bf16 v27, v157, v87
    v_dot2c_f32_bf16 v18, v148, v88
    v_dot2c_f32_bf16 v27, v158, v88
    v_dot2c_f32_bf16 v18, v149, v89
    v_dot2c_f32_bf16 v27, v159, v89
    v_dot2c_f32_bf16 v18, v150, v90
    v_dot2c_f32_bf16 v27, v160, v90
    v_dot2c_f32_bf16 v18, v151, v91
    v_dot2c_f32_bf16 v27, v161, v91
    v_dot2c_f32_bf16 v18, v152, v92
    v_dot2c_f32_bf16 v27, v162, v92
    v_dot2c_f32_bf16 v18, v153, v93
    v_dot2c_f32_bf16 v27, v163, v93
    v_dot2c_f32_bf16 v18, v154, v94
    v_dot2c_f32_bf16 v27, v164, v94
    ds_read_b64 v[86:87], v8 offset:51168
    ds_read_b64 v[88:89], v8 offset:51176
    ds_read_b64 v[90:91], v8 offset:51184
    ds_read_b64 v[92:93], v8 offset:51192
    ds_read_b64 v[94:95], v8 offset:51200
    v_dot2c_f32_bf16 v19, v146, v96
    v_dot2c_f32_bf16 v28, v156, v96
    v_dot2c_f32_bf16 v19, v147, v97
    v_dot2c_f32_bf16 v28, v157, v97
    v_dot2c_f32_bf16 v19, v148, v98
    v_dot2c_f32_bf16 v28, v158, v98
    v_dot2c_f32_bf16 v19, v149, v99
    v_dot2c_f32_bf16 v28, v159, v99
    v_dot2c_f32_bf16 v19, v150, v100
    v_dot2c_f32_bf16 v28, v160, v100
    v_dot2c_f32_bf16 v19, v151, v101
    v_dot2c_f32_bf16 v28, v161, v101
    v_dot2c_f32_bf16 v19, v152, v102
    v_dot2c_f32_bf16 v28, v162, v102
    v_dot2c_f32_bf16 v19, v153, v103
    v_dot2c_f32_bf16 v28, v163, v103
    v_dot2c_f32_bf16 v19, v154, v104
    v_dot2c_f32_bf16 v28, v164, v104
    ds_read_b64 v[96:97], v8 offset:50512
    ds_read_b64 v[98:99], v8 offset:50520
    ds_read_b64 v[100:101], v8 offset:50528
    ds_read_b64 v[102:103], v8 offset:50536
    ds_read_b64 v[104:105], v8 offset:50544
    v_dot2c_f32_bf16 v20, v146, v106
    v_dot2c_f32_bf16 v29, v156, v106
    v_dot2c_f32_bf16 v20, v147, v107
    v_dot2c_f32_bf16 v29, v157, v107
    v_dot2c_f32_bf16 v20, v148, v108
    v_dot2c_f32_bf16 v29, v158, v108
    v_dot2c_f32_bf16 v20, v149, v109
    v_dot2c_f32_bf16 v29, v159, v109
    v_dot2c_f32_bf16 v20, v150, v110
    v_dot2c_f32_bf16 v29, v160, v110
    v_dot2c_f32_bf16 v20, v151, v111
    v_dot2c_f32_bf16 v29, v161, v111
    v_dot2c_f32_bf16 v20, v152, v112
    v_dot2c_f32_bf16 v29, v162, v112
    v_dot2c_f32_bf16 v20, v153, v113
    v_dot2c_f32_bf16 v29, v163, v113
    v_dot2c_f32_bf16 v20, v154, v114
    v_dot2c_f32_bf16 v29, v164, v114
    ds_read_b64 v[106:107], v8 offset:49856
    ds_read_b64 v[108:109], v8 offset:49864
    ds_read_b64 v[110:111], v8 offset:49872
    ds_read_b64 v[112:113], v8 offset:49880
    ds_read_b64 v[114:115], v8 offset:49888
    s_waitcnt lgkmcnt(15)
    v_dot2c_f32_bf16 v21, v146, v116
    v_dot2c_f32_bf16 v30, v156, v116
    v_dot2c_f32_bf16 v21, v147, v117
    v_dot2c_f32_bf16 v30, v157, v117
    v_dot2c_f32_bf16 v21, v148, v118
    v_dot2c_f32_bf16 v30, v158, v118
    v_dot2c_f32_bf16 v21, v149, v119
    v_dot2c_f32_bf16 v30, v159, v119
    v_dot2c_f32_bf16 v21, v150, v120
    v_dot2c_f32_bf16 v30, v160, v120
    v_dot2c_f32_bf16 v21, v151, v121
    v_dot2c_f32_bf16 v30, v161, v121
    v_dot2c_f32_bf16 v21, v152, v122
    v_dot2c_f32_bf16 v30, v162, v122
    v_dot2c_f32_bf16 v21, v153, v123
    v_dot2c_f32_bf16 v30, v163, v123
    v_dot2c_f32_bf16 v21, v154, v124
    v_dot2c_f32_bf16 v30, v164, v124
    ds_read_b64 v[116:117], v8 offset:49200
    ds_read_b64 v[118:119], v8 offset:49208
    ds_read_b64 v[120:121], v8 offset:49216
    ds_read_b64 v[122:123], v8 offset:49224
    ds_read_b64 v[124:125], v8 offset:49232
    v_dot2c_f32_bf16 v22, v146, v126
    v_dot2c_f32_bf16 v31, v156, v126
    v_dot2c_f32_bf16 v22, v147, v127
    v_dot2c_f32_bf16 v31, v157, v127
    v_dot2c_f32_bf16 v22, v148, v128
    v_dot2c_f32_bf16 v31, v158, v128
    v_dot2c_f32_bf16 v22, v149, v129
    v_dot2c_f32_bf16 v31, v159, v129
    v_dot2c_f32_bf16 v22, v150, v130
    v_dot2c_f32_bf16 v31, v160, v130
    v_dot2c_f32_bf16 v22, v151, v131
    v_dot2c_f32_bf16 v31, v161, v131
    v_dot2c_f32_bf16 v22, v152, v132
    v_dot2c_f32_bf16 v31, v162, v132
    v_dot2c_f32_bf16 v22, v153, v133
    v_dot2c_f32_bf16 v31, v163, v133
    v_dot2c_f32_bf16 v22, v154, v134
    v_dot2c_f32_bf16 v31, v164, v134
    ds_read_b64 v[126:127], v8 offset:48544
    ds_read_b64 v[128:129], v8 offset:48552
    ds_read_b64 v[130:131], v8 offset:48560
    ds_read_b64 v[132:133], v8 offset:48568
    ds_read_b64 v[134:135], v8 offset:48576
    v_dot2c_f32_bf16 v23, v146, v136
    v_dot2c_f32_bf16 v23, v147, v137
    v_dot2c_f32_bf16 v23, v148, v138
    v_dot2c_f32_bf16 v23, v149, v139
    v_dot2c_f32_bf16 v23, v150, v140
    v_dot2c_f32_bf16 v23, v151, v141
    v_dot2c_f32_bf16 v23, v152, v142
    v_dot2c_f32_bf16 v23, v153, v143
    v_dot2c_f32_bf16 v23, v154, v144
    ds_read_b64 v[136:137], v8 offset:47888
    ds_read_b64 v[138:139], v8 offset:47896
    ds_read_b64 v[140:141], v8 offset:47904
    ds_read_b64 v[142:143], v8 offset:47912
    ds_read_b64 v[144:145], v8 offset:47920
    s_or_b32 s34, s28, s53
    s_cmp_lg_u32 s34, 0
    s_cbranch_scc1 L_anomask
    v_mov_b32 v3, 0xf149f2ca
    v_cmp_gt_u32 vcc, 2, v11
    s_nop 1
    v_cndmask_b32 v17, v17, v3, vcc
    v_cmp_gt_u32 vcc, 4, v11
    s_nop 1
    v_cndmask_b32 v18, v18, v3, vcc
    v_cmp_gt_u32 vcc, 6, v11
    s_nop 1
    v_cndmask_b32 v19, v19, v3, vcc
    v_cmp_gt_u32 vcc, 8, v11
    s_nop 1
    v_cndmask_b32 v20, v20, v3, vcc
    v_cmp_gt_u32 vcc, 10, v11
    s_nop 1
    v_cndmask_b32 v21, v21, v3, vcc
    v_cmp_gt_u32 vcc, 12, v11
    s_nop 1
    v_cndmask_b32 v22, v22, v3, vcc
    v_cmp_gt_u32 vcc, 14, v11
    s_nop 1
    v_cndmask_b32 v23, v23, v3, vcc
    v_cmp_gt_u32 vcc, 2, v11
    s_nop 1
    v_cndmask_b32 v26, v26, v3, vcc
    v_cmp_gt_u32 vcc, 4, v11
    s_nop 1
    v_cndmask_b32 v27, v27, v3, vcc
    v_cmp_gt_u32 vcc, 6, v11
    s_nop 1
    v_cndmask_b32 v28, v28, v3, vcc
    v_cmp_gt_u32 vcc, 8, v11
    s_nop 1
    v_cndmask_b32 v29, v29, v3, vcc
    v_cmp_gt_u32 vcc, 10, v11
    s_nop 1
    v_cndmask_b32 v30, v30, v3, vcc
    v_cmp_gt_u32 vcc, 12, v11
    s_nop 1
    v_cndmask_b32 v31, v31, v3, vcc
    s_nop 2
L_anomask:
    s_mov_b32 s34, 0x3eae1a93
    v_max3_f32 v3, v16, v17, v18
    v_max3_f32 v3, v3, v19, v20
    v_max3_f32 v3, v3, v21, v22
    v_max_f32 v3, v3, v23
    v_sub_f32 v16, v16, v3
    v_sub_f32 v17, v17, v3
    v_sub_f32 v18, v18, v3
    v_sub_f32 v19, v19, v3
    v_sub_f32 v20, v20, v3
    v_sub_f32 v21, v21, v3
    v_sub_f32 v22, v22, v3
    v_sub_f32 v23, v23, v3
    v_mul_f32 v16, s34, v16
    v_mul_f32 v17, s34, v17
    v_mul_f32 v18, s34, v18
    v_mul_f32 v19, s34, v19
    v_mul_f32 v20, s34, v20
    v_mul_f32 v21, s34, v21
    v_mul_f32 v22, s34, v22
    v_mul_f32 v23, s34, v23
    v_exp_f32 v16, v16
    v_exp_f32 v17, v17
    v_exp_f32 v18, v18
    v_exp_f32 v19, v19
    v_exp_f32 v20, v20
    v_exp_f32 v21, v21
    v_exp_f32 v22, v22
    v_exp_f32 v23, v23
    v_add_f32 v4, v16, v17
    v_add_f32 v4, v4, v18
    v_add_f32 v4, v4, v19
    v_add_f32 v4, v4, v20
    v_add_f32 v4, v4, v21
    v_add_f32 v4, v4, v22
    v_add_f32 v4, v4, v23
    v_rcp_f32 v4, v4
    s_nop 0
    v_mul_f32 v4, v4, v12
    v_mul_f32 v16, v16, v4
    v_mul_f32 v17, v17, v4
    v_mul_f32 v18, v18, v4
    v_mul_f32 v19, v19, v4
    v_mul_f32 v20, v20, v4
    v_mul_f32 v21, v21, v4
    v_mul_f32 v22, v22, v4
    v_mul_f32 v23, v23, v4
    v_max3_f32 v5, v24, v25, v26
    v_max3_f32 v5, v5, v27, v28
    v_max3_f32 v5, v5, v29, v30
    v_max_f32 v5, v5, v31
    v_sub_f32 v24, v24, v5
    v_sub_f32 v25, v25, v5
    v_sub_f32 v26, v26, v5
    v_sub_f32 v27, v27, v5
    v_sub_f32 v28, v28, v5
    v_sub_f32 v29, v29, v5
    v_sub_f32 v30, v30, v5
    v_sub_f32 v31, v31, v5
    v_mul_f32 v24, s34, v24
    v_mul_f32 v25, s34, v25
    v_mul_f32 v26, s34, v26
    v_mul_f32 v27, s34, v27
    v_mul_f32 v28, s34, v28
    v_mul_f32 v29, s34, v29
    v_mul_f32 v30, s34, v30
    v_mul_f32 v31, s34, v31
    v_exp_f32 v24, v24
    v_exp_f32 v25, v25
    v_exp_f32 v26, v26
    v_exp_f32 v27, v27
    v_exp_f32 v28, v28
    v_exp_f32 v29, v29
    v_exp_f32 v30, v30
    v_exp_f32 v31, v31
    v_add_f32 v6, v24, v25
    v_add_f32 v6, v6, v26
    v_add_f32 v6, v6, v27
    v_add_f32 v6, v6, v28
    v_add_f32 v6, v6, v29
    v_add_f32 v6, v6, v30
    v_add_f32 v6, v6, v31
    v_rcp_f32 v6, v6
    s_nop 0
    v_mul_f32 v6, v6, v13
    v_mul_f32 v24, v24, v6
    v_mul_f32 v25, v25, v6
    v_mul_f32 v26, v26, v6
    v_mul_f32 v27, v27, v6
    v_mul_f32 v28, v28, v6
    v_mul_f32 v29, v29, v6
    v_mul_f32 v30, v30, v6
    v_mul_f32 v31, v31, v6
    v_lshlrev_b32 v52, 16, v56
    v_and_b32 v53, s52, v56
    v_mul_f32 v146, v24, v52
    v_mul_f32 v147, v24, v53
    v_lshlrev_b32 v54, 16, v57
    v_and_b32 v55, s52, v57
    v_mul_f32 v148, v24, v54
    v_mul_f32 v149, v24, v55
    v_lshlrev_b32 v52, 16, v58
    v_and_b32 v53, s52, v58
    v_mul_f32 v150, v24, v52
    v_mul_f32 v151, v24, v53
    v_lshlrev_b32 v54, 16, v59
    v_and_b32 v55, s52, v59
    v_mul_f32 v152, v24, v54
    v_mul_f32 v153, v24, v55
    v_lshlrev_b32 v52, 16, v60
    v_and_b32 v53, s52, v60
    v_mul_f32 v154, v24, v52
    v_mul_f32 v155, v24, v53
    v_lshlrev_b32 v54, 16, v61
    v_and_b32 v55, s52, v61
    v_mul_f32 v156, v24, v54
    v_mul_f32 v157, v24, v55
    v_lshlrev_b32 v52, 16, v62
    v_and_b32 v53, s52, v62
    v_mul_f32 v158, v24, v52
    v_mul_f32 v159, v24, v53
    v_lshlrev_b32 v54, 16, v63
    v_and_b32 v55, s52, v63
    v_mul_f32 v160, v24, v54
    v_mul_f32 v161, v24, v55
    v_lshlrev_b32 v52, 16, v64
    v_and_b32 v53, s52, v64
    v_mul_f32 v162, v24, v52
    v_mul_f32 v163, v24, v53
    v_lshlrev_b32 v52, 16, v66
    v_and_b32 v53, s52, v66
    v_mul_f32 v32, v16, v52
    v_mul_f32 v33, v16, v53
    v_fmac_f32 v146, v25, v52
    v_fmac_f32 v147, v25, v53
    v_lshlrev_b32 v54, 16, v67
    v_and_b32 v55, s52, v67
    v_mul_f32 v34, v16, v54
    v_mul_f32 v35, v16, v55
    v_fmac_f32 v148, v25, v54
    v_fmac_f32 v149, v25, v55
    v_lshlrev_b32 v52, 16, v68
    v_and_b32 v53, s52, v68
    v_mul_f32 v36, v16, v52
    v_mul_f32 v37, v16, v53
    v_fmac_f32 v150, v25, v52
    v_fmac_f32 v151, v25, v53
    v_lshlrev_b32 v54, 16, v69
    v_and_b32 v55, s52, v69
    v_mul_f32 v38, v16, v54
    v_mul_f32 v39, v16, v55
    v_fmac_f32 v152, v25, v54
    v_fmac_f32 v153, v25, v55
    v_lshlrev_b32 v52, 16, v70
    v_and_b32 v53, s52, v70
    v_mul_f32 v40, v16, v52
    v_mul_f32 v41, v16, v53
    v_fmac_f32 v154, v25, v52
    v_fmac_f32 v155, v25, v53
    v_lshlrev_b32 v54, 16, v71
    v_and_b32 v55, s52, v71
    v_mul_f32 v42, v16, v54
    v_mul_f32 v43, v16, v55
    v_fmac_f32 v156, v25, v54
    v_fmac_f32 v157, v25, v55
    v_lshlrev_b32 v52, 16, v72
    v_and_b32 v53, s52, v72
    v_mul_f32 v44, v16, v52
    v_mul_f32 v45, v16, v53
    v_fmac_f32 v158, v25, v52
    v_fmac_f32 v159, v25, v53
    v_lshlrev_b32 v54, 16, v73
    v_and_b32 v55, s52, v73
    v_mul_f32 v46, v16, v54
    v_mul_f32 v47, v16, v55
    v_fmac_f32 v160, v25, v54
    v_fmac_f32 v161, v25, v55
    v_lshlrev_b32 v52, 16, v74
    v_and_b32 v53, s52, v74
    v_mul_f32 v48, v16, v52
    v_mul_f32 v49, v16, v53
    v_fmac_f32 v162, v25, v52
    v_fmac_f32 v163, v25, v53
    v_lshlrev_b32 v52, 16, v76
    v_and_b32 v53, s52, v76
    v_fmac_f32 v32, v17, v52
    v_fmac_f32 v33, v17, v53
    v_fmac_f32 v146, v26, v52
    v_fmac_f32 v147, v26, v53
    v_lshlrev_b32 v54, 16, v77
    v_and_b32 v55, s52, v77
    v_fmac_f32 v34, v17, v54
    v_fmac_f32 v35, v17, v55
    v_fmac_f32 v148, v26, v54
    v_fmac_f32 v149, v26, v55
    v_lshlrev_b32 v52, 16, v78
    v_and_b32 v53, s52, v78
    v_fmac_f32 v36, v17, v52
    v_fmac_f32 v37, v17, v53
    v_fmac_f32 v150, v26, v52
    v_fmac_f32 v151, v26, v53
    v_lshlrev_b32 v54, 16, v79
    v_and_b32 v55, s52, v79
    v_fmac_f32 v38, v17, v54
    v_fmac_f32 v39, v17, v55
    v_fmac_f32 v152, v26, v54
    v_fmac_f32 v153, v26, v55
    v_lshlrev_b32 v52, 16, v80
    v_and_b32 v53, s52, v80
    v_fmac_f32 v40, v17, v52
    v_fmac_f32 v41, v17, v53
    v_fmac_f32 v154, v26, v52
    v_fmac_f32 v155, v26, v53
    v_lshlrev_b32 v54, 16, v81
    v_and_b32 v55, s52, v81
    v_fmac_f32 v42, v17, v54
    v_fmac_f32 v43, v17, v55
    v_fmac_f32 v156, v26, v54
    v_fmac_f32 v157, v26, v55
    v_lshlrev_b32 v52, 16, v82
    v_and_b32 v53, s52, v82
    v_fmac_f32 v44, v17, v52
    v_fmac_f32 v45, v17, v53
    v_fmac_f32 v158, v26, v52
    v_fmac_f32 v159, v26, v53
    v_lshlrev_b32 v54, 16, v83
    v_and_b32 v55, s52, v83
    v_fmac_f32 v46, v17, v54
    v_fmac_f32 v47, v17, v55
    v_fmac_f32 v160, v26, v54
    v_fmac_f32 v161, v26, v55
    v_lshlrev_b32 v52, 16, v84
    v_and_b32 v53, s52, v84
    v_fmac_f32 v48, v17, v52
    v_fmac_f32 v49, v17, v53
    v_fmac_f32 v162, v26, v52
    v_fmac_f32 v163, v26, v53
    s_waitcnt lgkmcnt(15)
    v_lshlrev_b32 v52, 16, v86
    v_and_b32 v53, s52, v86
    v_fmac_f32 v32, v18, v52
    v_fmac_f32 v33, v18, v53
    v_fmac_f32 v146, v27, v52
    v_fmac_f32 v147, v27, v53
    v_lshlrev_b32 v54, 16, v87
    v_and_b32 v55, s52, v87
    v_fmac_f32 v34, v18, v54
    v_fmac_f32 v35, v18, v55
    v_fmac_f32 v148, v27, v54
    v_fmac_f32 v149, v27, v55
    v_lshlrev_b32 v52, 16, v88
    v_and_b32 v53, s52, v88
    v_fmac_f32 v36, v18, v52
    v_fmac_f32 v37, v18, v53
    v_fmac_f32 v150, v27, v52
    v_fmac_f32 v151, v27, v53
    v_lshlrev_b32 v54, 16, v89
    v_and_b32 v55, s52, v89
    v_fmac_f32 v38, v18, v54
    v_fmac_f32 v39, v18, v55
    v_fmac_f32 v152, v27, v54
    v_fmac_f32 v153, v27, v55
    v_lshlrev_b32 v52, 16, v90
    v_and_b32 v53, s52, v90
    v_fmac_f32 v40, v18, v52
    v_fmac_f32 v41, v18, v53
    v_fmac_f32 v154, v27, v52
    v_fmac_f32 v155, v27, v53
    v_lshlrev_b32 v54, 16, v91
    v_and_b32 v55, s52, v91
    v_fmac_f32 v42, v18, v54
    v_fmac_f32 v43, v18, v55
    v_fmac_f32 v156, v27, v54
    v_fmac_f32 v157, v27, v55
    v_lshlrev_b32 v52, 16, v92
    v_and_b32 v53, s52, v92
    v_fmac_f32 v44, v18, v52
    v_fmac_f32 v45, v18, v53
    v_fmac_f32 v158, v27, v52
    v_fmac_f32 v159, v27, v53
    v_lshlrev_b32 v54, 16, v93
    v_and_b32 v55, s52, v93
    v_fmac_f32 v46, v18, v54
    v_fmac_f32 v47, v18, v55
    v_fmac_f32 v160, v27, v54
    v_fmac_f32 v161, v27, v55
    v_lshlrev_b32 v52, 16, v94
    v_and_b32 v53, s52, v94
    v_fmac_f32 v48, v18, v52
    v_fmac_f32 v49, v18, v53
    v_fmac_f32 v162, v27, v52
    v_fmac_f32 v163, v27, v53
    v_lshlrev_b32 v52, 16, v96
    v_and_b32 v53, s52, v96
    v_fmac_f32 v32, v19, v52
    v_fmac_f32 v33, v19, v53
    v_fmac_f32 v146, v28, v52
    v_fmac_f32 v147, v28, v53
    v_lshlrev_b32 v54, 16, v97
    v_and_b32 v55, s52, v97
    v_fmac_f32 v34, v19, v54
    v_fmac_f32 v35, v19, v55
    v_fmac_f32 v148, v28, v54
    v_fmac_f32 v149, v28, v55
    v_lshlrev_b32 v52, 16, v98
    v_and_b32 v53, s52, v98
    v_fmac_f32 v36, v19, v52
    v_fmac_f32 v37, v19, v53
    v_fmac_f32 v150, v28, v52
    v_fmac_f32 v151, v28, v53
    v_lshlrev_b32 v54, 16, v99
    v_and_b32 v55, s52, v99
    v_fmac_f32 v38, v19, v54
    v_fmac_f32 v39, v19, v55
    v_fmac_f32 v152, v28, v54
    v_fmac_f32 v153, v28, v55
    v_lshlrev_b32 v52, 16, v100
    v_and_b32 v53, s52, v100
    v_fmac_f32 v40, v19, v52
    v_fmac_f32 v41, v19, v53
    v_fmac_f32 v154, v28, v52
    v_fmac_f32 v155, v28, v53
    v_lshlrev_b32 v54, 16, v101
    v_and_b32 v55, s52, v101
    v_fmac_f32 v42, v19, v54
    v_fmac_f32 v43, v19, v55
    v_fmac_f32 v156, v28, v54
    v_fmac_f32 v157, v28, v55
    v_lshlrev_b32 v52, 16, v102
    v_and_b32 v53, s52, v102
    v_fmac_f32 v44, v19, v52
    v_fmac_f32 v45, v19, v53
    v_fmac_f32 v158, v28, v52
    v_fmac_f32 v159, v28, v53
    v_lshlrev_b32 v54, 16, v103
    v_and_b32 v55, s52, v103
    v_fmac_f32 v46, v19, v54
    v_fmac_f32 v47, v19, v55
    v_fmac_f32 v160, v28, v54
    v_fmac_f32 v161, v28, v55
    v_lshlrev_b32 v52, 16, v104
    v_and_b32 v53, s52, v104
    v_fmac_f32 v48, v19, v52
    v_fmac_f32 v49, v19, v53
    v_fmac_f32 v162, v28, v52
    v_fmac_f32 v163, v28, v53
    v_lshlrev_b32 v52, 16, v106
    v_and_b32 v53, s52, v106
    v_fmac_f32 v32, v20, v52
    v_fmac_f32 v33, v20, v53
    v_fmac_f32 v146, v29, v52
    v_fmac_f32 v147, v29, v53
    v_lshlrev_b32 v54, 16, v107
    v_and_b32 v55, s52, v107
    v_fmac_f32 v34, v20, v54
    v_fmac_f32 v35, v20, v55
    v_fmac_f32 v148, v29, v54
    v_fmac_f32 v149, v29, v55
    v_lshlrev_b32 v52, 16, v108
    v_and_b32 v53, s52, v108
    v_fmac_f32 v36, v20, v52
    v_fmac_f32 v37, v20, v53
    v_fmac_f32 v150, v29, v52
    v_fmac_f32 v151, v29, v53
    v_lshlrev_b32 v54, 16, v109
    v_and_b32 v55, s52, v109
    v_fmac_f32 v38, v20, v54
    v_fmac_f32 v39, v20, v55
    v_fmac_f32 v152, v29, v54
    v_fmac_f32 v153, v29, v55
    v_lshlrev_b32 v52, 16, v110
    v_and_b32 v53, s52, v110
    v_fmac_f32 v40, v20, v52
    v_fmac_f32 v41, v20, v53
    v_fmac_f32 v154, v29, v52
    v_fmac_f32 v155, v29, v53
    v_lshlrev_b32 v54, 16, v111
    v_and_b32 v55, s52, v111
    v_fmac_f32 v42, v20, v54
    v_fmac_f32 v43, v20, v55
    v_fmac_f32 v156, v29, v54
    v_fmac_f32 v157, v29, v55
    v_lshlrev_b32 v52, 16, v112
    v_and_b32 v53, s52, v112
    v_fmac_f32 v44, v20, v52
    v_fmac_f32 v45, v20, v53
    v_fmac_f32 v158, v29, v52
    v_fmac_f32 v159, v29, v53
    v_lshlrev_b32 v54, 16, v113
    v_and_b32 v55, s52, v113
    v_fmac_f32 v46, v20, v54
    v_fmac_f32 v47, v20, v55
    v_fmac_f32 v160, v29, v54
    v_fmac_f32 v161, v29, v55
    v_lshlrev_b32 v52, 16, v114
    v_and_b32 v53, s52, v114
    v_fmac_f32 v48, v20, v52
    v_fmac_f32 v49, v20, v53
    v_fmac_f32 v162, v29, v52
    v_fmac_f32 v163, v29, v53
    s_waitcnt lgkmcnt(10)
    v_lshlrev_b32 v52, 16, v116
    v_and_b32 v53, s52, v116
    v_fmac_f32 v32, v21, v52
    v_fmac_f32 v33, v21, v53
    v_fmac_f32 v146, v30, v52
    v_fmac_f32 v147, v30, v53
    v_lshlrev_b32 v54, 16, v117
    v_and_b32 v55, s52, v117
    v_fmac_f32 v34, v21, v54
    v_fmac_f32 v35, v21, v55
    v_fmac_f32 v148, v30, v54
    v_fmac_f32 v149, v30, v55
    v_lshlrev_b32 v52, 16, v118
    v_and_b32 v53, s52, v118
    v_fmac_f32 v36, v21, v52
    v_fmac_f32 v37, v21, v53
    v_fmac_f32 v150, v30, v52
    v_fmac_f32 v151, v30, v53
    v_lshlrev_b32 v54, 16, v119
    v_and_b32 v55, s52, v119
    v_fmac_f32 v38, v21, v54
    v_fmac_f32 v39, v21, v55
    v_fmac_f32 v152, v30, v54
    v_fmac_f32 v153, v30, v55
    v_lshlrev_b32 v52, 16, v120
    v_and_b32 v53, s52, v120
    v_fmac_f32 v40, v21, v52
    v_fmac_f32 v41, v21, v53
    v_fmac_f32 v154, v30, v52
    v_fmac_f32 v155, v30, v53
    v_lshlrev_b32 v54, 16, v121
    v_and_b32 v55, s52, v121
    v_fmac_f32 v42, v21, v54
    v_fmac_f32 v43, v21, v55
    v_fmac_f32 v156, v30, v54
    v_fmac_f32 v157, v30, v55
    v_lshlrev_b32 v52, 16, v122
    v_and_b32 v53, s52, v122
    v_fmac_f32 v44, v21, v52
    v_fmac_f32 v45, v21, v53
    v_fmac_f32 v158, v30, v52
    v_fmac_f32 v159, v30, v53
    v_lshlrev_b32 v54, 16, v123
    v_and_b32 v55, s52, v123
    v_fmac_f32 v46, v21, v54
    v_fmac_f32 v47, v21, v55
    v_fmac_f32 v160, v30, v54
    v_fmac_f32 v161, v30, v55
    v_lshlrev_b32 v52, 16, v124
    v_and_b32 v53, s52, v124
    v_fmac_f32 v48, v21, v52
    v_fmac_f32 v49, v21, v53
    v_fmac_f32 v162, v30, v52
    v_fmac_f32 v163, v30, v53
    s_waitcnt lgkmcnt(5)
    v_lshlrev_b32 v52, 16, v126
    v_and_b32 v53, s52, v126
    v_fmac_f32 v32, v22, v52
    v_fmac_f32 v33, v22, v53
    v_fmac_f32 v146, v31, v52
    v_fmac_f32 v147, v31, v53
    v_lshlrev_b32 v54, 16, v127
    v_and_b32 v55, s52, v127
    v_fmac_f32 v34, v22, v54
    v_fmac_f32 v35, v22, v55
    v_fmac_f32 v148, v31, v54
    v_fmac_f32 v149, v31, v55
    v_lshlrev_b32 v52, 16, v128
    v_and_b32 v53, s52, v128
    v_fmac_f32 v36, v22, v52
    v_fmac_f32 v37, v22, v53
    v_fmac_f32 v150, v31, v52
    v_fmac_f32 v151, v31, v53
    v_lshlrev_b32 v54, 16, v129
    v_and_b32 v55, s52, v129
    v_fmac_f32 v38, v22, v54
    v_fmac_f32 v39, v22, v55
    v_fmac_f32 v152, v31, v54
    v_fmac_f32 v153, v31, v55
    v_lshlrev_b32 v52, 16, v130
    v_and_b32 v53, s52, v130
    v_fmac_f32 v40, v22, v52
    v_fmac_f32 v41, v22, v53
    v_fmac_f32 v154, v31, v52
    v_fmac_f32 v155, v31, v53
    v_lshlrev_b32 v54, 16, v131
    v_and_b32 v55, s52, v131
    v_fmac_f32 v42, v22, v54
    v_fmac_f32 v43, v22, v55
    v_fmac_f32 v156, v31, v54
    v_fmac_f32 v157, v31, v55
    v_lshlrev_b32 v52, 16, v132
    v_and_b32 v53, s52, v132
    v_fmac_f32 v44, v22, v52
    v_fmac_f32 v45, v22, v53
    v_fmac_f32 v158, v31, v52
    v_fmac_f32 v159, v31, v53
    v_lshlrev_b32 v54, 16, v133
    v_and_b32 v55, s52, v133
    v_fmac_f32 v46, v22, v54
    v_fmac_f32 v47, v22, v55
    v_fmac_f32 v160, v31, v54
    v_fmac_f32 v161, v31, v55
    v_lshlrev_b32 v52, 16, v134
    v_and_b32 v53, s52, v134
    v_fmac_f32 v48, v22, v52
    v_fmac_f32 v49, v22, v53
    v_fmac_f32 v162, v31, v52
    v_fmac_f32 v163, v31, v53
    s_waitcnt lgkmcnt(0)
    v_lshlrev_b32 v52, 16, v136
    v_and_b32 v53, s52, v136
    v_fmac_f32 v32, v23, v52
    v_fmac_f32 v33, v23, v53
    v_lshlrev_b32 v54, 16, v137
    v_and_b32 v55, s52, v137
    v_fmac_f32 v34, v23, v54
    v_fmac_f32 v35, v23, v55
    v_lshlrev_b32 v52, 16, v138
    v_and_b32 v53, s52, v138
    v_fmac_f32 v36, v23, v52
    v_fmac_f32 v37, v23, v53
    v_lshlrev_b32 v54, 16, v139
    v_and_b32 v55, s52, v139
    v_fmac_f32 v38, v23, v54
    v_fmac_f32 v39, v23, v55
    v_lshlrev_b32 v52, 16, v140
    v_and_b32 v53, s52, v140
    v_fmac_f32 v40, v23, v52
    v_fmac_f32 v41, v23, v53
    v_lshlrev_b32 v54, 16, v141
    v_and_b32 v55, s52, v141
    v_fmac_f32 v42, v23, v54
    v_fmac_f32 v43, v23, v55
    v_lshlrev_b32 v52, 16, v142
    v_and_b32 v53, s52, v142
    v_fmac_f32 v44, v23, v52
    v_fmac_f32 v45, v23, v53
    v_lshlrev_b32 v54, 16, v143
    v_and_b32 v55, s52, v143
    v_fmac_f32 v46, v23, v54
    v_fmac_f32 v47, v23, v55
    v_lshlrev_b32 v52, 16, v144
    v_and_b32 v53, s52, v144
    v_fmac_f32 v48, v23, v52
    v_fmac_f32 v49, v23, v53
    v_cvt_pk_bf16_f32 v32, v32, v33
    ds_write_b32 v10, v32 offset:0
    v_cvt_pk_bf16_f32 v33, v34, v35
    ds_write_b32 v10, v33 offset:4
    v_cvt_pk_bf16_f32 v34, v36, v37
    ds_write_b32 v10, v34 offset:8
    v_cvt_pk_bf16_f32 v35, v38, v39
    ds_write_b32 v10, v35 offset:12
    v_cvt_pk_bf16_f32 v36, v40, v41
    ds_write_b32 v10, v36 offset:16
    v_cvt_pk_bf16_f32 v37, v42, v43
    ds_write_b32 v10, v37 offset:20
    v_cvt_pk_bf16_f32 v38, v44, v45
    ds_write_b32 v10, v38 offset:24
    v_cvt_pk_bf16_f32 v39, v46, v47
    ds_write_b32 v10, v39 offset:28
    v_cvt_pk_bf16_f32 v40, v48, v49
    ds_write_b32 v10, v40 offset:32
    v_cvt_pk_bf16_f32 v146, v146, v147
    ds_write_b32 v10, v146 offset:656
    v_cvt_pk_bf16_f32 v147, v148, v149
    ds_write_b32 v10, v147 offset:660
    v_cvt_pk_bf16_f32 v148, v150, v151
    ds_write_b32 v10, v148 offset:664
    v_cvt_pk_bf16_f32 v149, v152, v153
    ds_write_b32 v10, v149 offset:668
    v_cvt_pk_bf16_f32 v150, v154, v155
    ds_write_b32 v10, v150 offset:672
    v_cvt_pk_bf16_f32 v151, v156, v157
    ds_write_b32 v10, v151 offset:676
    v_cvt_pk_bf16_f32 v152, v158, v159
    ds_write_b32 v10, v152 offset:680
    v_cvt_pk_bf16_f32 v153, v160, v161
    ds_write_b32 v10, v153 offset:684
    v_cvt_pk_bf16_f32 v154, v162, v163
    ds_write_b32 v10, v154 offset:688
    v_bfe_u32 v3, v1, 4, 4
    v_bfe_u32 v4, v1, 8, 1
    v_lshrrev_b32 v5, 9, v1
    s_lshl_b32 s34, s53, 4
    v_add_u32 v6, s34, v3
    v_mul_u32_u24 v6, 328, v6
    v_lshl_add_u32 v6, v4, 3, v6
    v_lshl_add_u32 v6, v5, 5, v6
    v_add_u32 v6, 94464, v6
    s_and_b32 s34, s53, 1
    s_lshl_b32 s34, s34, 8
    v_lshlrev_b32 v3, 4, v3
    v_lshl_add_u32 v3, v4, 9, v3
    v_lshl_add_u32 v3, v5, 12, v3
    v_add_u32 v3, s34, v3
    s_lshl_b32 s34, s28, 2
    s_add_u32 s34, s34, s29
    s_mul_i32 s34, s34, 36
    s_lshr_b32 s35, s53, 1
    s_add_u32 s34, s34, s35
    s_lshl_b32 s34, s34, 10
    s_add_u32 s35, s34, 30408704
    s_lshl_b32 s34, s53, 7
    s_add_u32 s88, s88, s34
    s_waitcnt lgkmcnt(0)
    ds_read_b64 v[56:57], v6 offset:0
    ds_read_b64 v[58:59], v6 offset:16
    ds_read_b64 v[60:61], v6 offset:64
    ds_read_b64 v[62:63], v6 offset:80
    ds_read_b64 v[64:65], v6 offset:128
    ds_read_b64 v[66:67], v6 offset:144
    ds_read_b64 v[68:69], v6 offset:192
    ds_read_b64 v[70:71], v6 offset:208
    ds_read_b64 v[72:73], v6 offset:256
    ds_read_b64 v[74:75], v6 offset:272
    s_waitcnt lgkmcnt(8)
    s_add_u32 s37, s35, 0
    buffer_store_dwordx4 v[56:59], v3, s[16:19], s37 offen sc1
    s_waitcnt lgkmcnt(6)
    s_add_u32 s37, s35, 8192
    buffer_store_dwordx4 v[60:63], v3, s[16:19], s37 offen sc1
    s_waitcnt lgkmcnt(4)
    s_add_u32 s37, s35, 16384
    buffer_store_dwordx4 v[64:67], v3, s[16:19], s37 offen sc1
    s_waitcnt lgkmcnt(2)
    s_add_u32 s37, s35, 24576
    buffer_store_dwordx4 v[68:71], v3, s[16:19], s37 offen sc1
    s_waitcnt lgkmcnt(0)
    s_add_u32 s37, s35, 32768
    s_mov_b32 exec_hi, 0
    buffer_store_dwordx4 v[72:75], v3, s[16:19], s37 offen sc1
    s_mov_b32 exec_hi, -1
    s_waitcnt vmcnt(0) lgkmcnt(0)
    v_mov_b32 v50, s46
    s_add_u32 s54, s47, 1
    v_mov_b32 v51, s54
    s_mov_b64 exec, 1
    buffer_store_dwordx2 v[50:51], v2, s[16:19], s88 offen offset:0 sc1
    s_mov_b64 exec, -1
L_aend:
    s_endpgm
L_helperA:
    s_lshl_b32 s34, s28, 7
    s_lshl_b32 s35, s32, 4
    s_add_u32 s34, s34, s35
    s_mul_i32 s34, s34, 1152
    v_lshrrev_b32 v4, 3, v3
    v_mul_u32_u24 v4, 1152, v4
    v_add_u32 v4, s34, v4
    v_and_b32 v5, 7, v3
    v_lshrrev_b32 v6, 4, v3
    v_xor_b32 v5, v5, v6
    v_lshl_add_u32 v14, v5, 4, v4
    v_xor_b32 v5, 4, v5
    v_lshl_add_u32 v15, v5, 4, v4
    v_add_u32 v15, 9216, v15
    s_lshl_b32 s41, s32, 11
    s_add_u32 s41, s41, 122880
    s_lshr_b32 s37, s32, 1
    s_lshl_b32 s37, s37, 4
    s_and_b32 s35, s32, 1
    s_lshl_b32 s35, s35, 2
    s_add_u32 s37, s37, s35
    s_mul_i32 s40, s32, 3584
    s_mul_i32 s34, s37, 3456
    s_mul_i32 s55, s29, 288
    s_add_u32 s34, s34, s55
    v_mov_b32 v7, 2016
    v_mov_b32 v12, -576
    v_add_u32 v5, 0, v3
    v_mul_u32_u24 v4, 2341, v5
    v_lshrrev_b32 v4, 16, v4
    v_mul_u32_u24 v6, 28, v4
    v_sub_u32 v5, v5, v6
    v_and_b32 v6, 4, v4
    v_add_u32 v4, v4, v6
    v_mul_u32_u24 v4, 3456, v4
    v_add_u32 v4, s34, v4
    v_min_u32 v13, 53, v5
    v_mov_b32 v6, 1152
    v_cmp_lt_u32 vcc, 17, v13
    s_nop 1
    v_cndmask_b32 v6, v6, v7, vcc
    v_cmp_lt_u32 vcc, 35, v13
    s_nop 1
    v_cndmask_b32 v6, v6, v12, vcc
    v_lshl_add_u32 v13, v13, 4, v6
    v_add_u32 v20, v4, v13
    v_add_u32 v5, 28, v5
    v_min_u32 v13, 53, v5
    v_mov_b32 v6, 1152
    v_cmp_lt_u32 vcc, 17, v13
    s_nop 1
    v_cndmask_b32 v6, v6, v7, vcc
    v_cmp_lt_u32 vcc, 35, v13
    s_nop 1
    v_cndmask_b32 v6, v6, v12, vcc
    v_lshl_add_u32 v13, v13, 4, v6
    v_add_u32 v24, v4, v13
    v_add_u32 v5, 64, v3
    v_mul_u32_u24 v4, 2341, v5
    v_lshrrev_b32 v4, 16, v4
    v_mul_u32_u24 v6, 28, v4
    v_sub_u32 v5, v5, v6
    v_and_b32 v6, 4, v4
    v_add_u32 v4, v4, v6
    v_mul_u32_u24 v4, 3456, v4
    v_add_u32 v4, s34, v4
    v_min_u32 v13, 53, v5
    v_mov_b32 v6, 1152
    v_cmp_lt_u32 vcc, 17, v13
    s_nop 1
    v_cndmask_b32 v6, v6, v7, vcc
    v_cmp_lt_u32 vcc, 35, v13
    s_nop 1
    v_cndmask_b32 v6, v6, v12, vcc
    v_lshl_add_u32 v13, v13, 4, v6
    v_add_u32 v21, v4, v13
    v_add_u32 v5, 28, v5
    v_min_u32 v13, 53, v5
    v_mov_b32 v6, 1152
    v_cmp_lt_u32 vcc, 17, v13
    s_nop 1
    v_cndmask_b32 v6, v6, v7, vcc
    v_cmp_lt_u32 vcc, 35, v13
    s_nop 1
    v_cndmask_b32 v6, v6, v12, vcc
    v_lshl_add_u32 v13, v13, 4, v6
    v_add_u32 v25, v4, v13
    v_add_u32 v5, 128, v3
    v_mul_u32_u24 v4, 2341, v5
    v_lshrrev_b32 v4, 16, v4
    v_mul_u32_u24 v6, 28, v4
    v_sub_u32 v5, v5, v6
    v_and_b32 v6, 4, v4
    v_add_u32 v4, v4, v6
    v_mul_u32_u24 v4, 3456, v4
    v_add_u32 v4, s34, v4
    v_min_u32 v13, 53, v5
    v_mov_b32 v6, 1152
    v_cmp_lt_u32 vcc, 17, v13
    s_nop 1
    v_cndmask_b32 v6, v6, v7, vcc
    v_cmp_lt_u32 vcc, 35, v13
    s_nop 1
    v_cndmask_b32 v6, v6, v12, vcc
    v_lshl_add_u32 v13, v13, 4, v6
    v_add_u32 v22, v4, v13
    v_add_u32 v5, 28, v5
    v_min_u32 v13, 53, v5
    v_mov_b32 v6, 1152
    v_cmp_lt_u32 vcc, 17, v13
    s_nop 1
    v_cndmask_b32 v6, v6, v7, vcc
    v_cmp_lt_u32 vcc, 35, v13
    s_nop 1
    v_cndmask_b32 v6, v6, v12, vcc
    v_lshl_add_u32 v13, v13, 4, v6
    v_add_u32 v26, v4, v13
    v_add_u32 v5, 192, v3
    v_min_u32 v5, 223, v5
    v_mul_u32_u24 v4, 2341, v5
    v_lshrrev_b32 v4, 16, v4
    v_mul_u32_u24 v6, 28, v4
    v_sub_u32 v5, v5, v6
    v_and_b32 v6, 4, v4
    v_add_u32 v4, v4, v6
    v_mul_u32_u24 v4, 3456, v4
    v_add_u32 v4, s34, v4
    v_min_u32 v13, 53, v5
    v_mov_b32 v6, 1152
    v_cmp_lt_u32 vcc, 17, v13
    s_nop 1
    v_cndmask_b32 v6, v6, v7, vcc
    v_cmp_lt_u32 vcc, 35, v13
    s_nop 1
    v_cndmask_b32 v6, v6, v12, vcc
    v_lshl_add_u32 v13, v13, 4, v6
    v_add_u32 v23, v4, v13
    v_add_u32 v5, 28, v5
    v_min_u32 v13, 53, v5
    v_mov_b32 v6, 1152
    v_cmp_lt_u32 vcc, 17, v13
    s_nop 1
    v_cndmask_b32 v6, v6, v7, vcc
    v_cmp_lt_u32 vcc, 35, v13
    s_nop 1
    v_cndmask_b32 v6, v6, v12, vcc
    v_lshl_add_u32 v13, v13, 4, v6
    v_add_u32 v27, v4, v13
    s_waitcnt lgkmcnt(0)
    s_mov_b32 s4, s56
    s_mov_b32 s5, s57
    s_mov_b32 s6, 2359296
    s_mov_b32 s7, 0x20000
    s_mov_b32 s8, s58
    s_mov_b32 s9, s59
    s_mov_b32 s10, 1990656
    s_mov_b32 s11, 0x20000
    s_add_u32 m0, s41, 0
    s_mov_b32 s38, 0
    buffer_load_dwordx4 v14, s[4:7], s38 offen lds
    s_add_u32 m0, s41, 1024
    s_mov_b32 s38, 0
    buffer_load_dwordx4 v15, s[4:7], s38 offen lds
    s_add_u32 m0, s41, 8192
    s_mov_b32 s38, 73728
    buffer_load_dwordx4 v14, s[4:7], s38 offen lds
    s_add_u32 m0, s41, 9216
    s_mov_b32 s38, 73728
    buffer_load_dwordx4 v15, s[4:7], s38 offen lds
    s_mov_b32 s38, 0
    s_add_u32 m0, s40, 0
    s_nop 0
    buffer_load_dwordx4 v20, s[8:11], s38 offen lds
    s_add_u32 m0, s40, 1024
    s_nop 0
    buffer_load_dwordx4 v21, s[8:11], s38 offen lds
    s_add_u32 m0, s40, 2048
    s_nop 0
    buffer_load_dwordx4 v22, s[8:11], s38 offen lds
    s_add_u32 m0, s40, 3072
    s_mov_b32 exec_hi, 0
    buffer_load_dwordx4 v23, s[8:11], s38 offen lds
    s_mov_b32 exec_hi, -1
    s_add_u32 m0, s40, 14336
    s_nop 0
    buffer_load_dwordx4 v24, s[8:11], s38 offen lds
    s_add_u32 m0, s40, 15360
    s_nop 0
    buffer_load_dwordx4 v25, s[8:11], s38 offen lds
    s_add_u32 m0, s40, 16384
    s_nop 0
    buffer_load_dwordx4 v26, s[8:11], s38 offen lds
    s_add_u32 m0, s40, 17408
    s_mov_b32 exec_hi, 0
    buffer_load_dwordx4 v27, s[8:11], s38 offen lds
    s_mov_b32 exec_hi, -1
    v_min_u32 v13, 53, v3
    v_mov_b32 v6, 1152
    v_cmp_lt_u32 vcc, 17, v13
    s_nop 1
    v_cndmask_b32 v6, v6, v7, vcc
    v_cmp_lt_u32 vcc, 35, v13
    s_nop 1
    v_cndmask_b32 v6, v6, v12, vcc
    v_lshl_add_u32 v13, v13, 4, v6
    s_lshl_b32 s34, s28, 2
    s_add_u32 s34, s34, s32
    s_mul_i32 s34, s34, 3456
    s_add_u32 s34, s34, s55
    v_add_u32 v18, s34, v13
    v_mov_b32 v2, 0
    s_mov_b32 s24, s74
    s_mov_b32 s25, s75
    s_mov_b32 s26, 256
    s_mov_b32 s27, 0x20000
    s_mov_b32 s16, s76
    s_mov_b32 s17, s77
    s_mov_b32 s18, 35946496
    s_mov_b32 s19, 0x20000
    s_or_b32 s51, s78, 1
    s_lshl_b32 s34, s2, 2
    s_add_u32 s34, s34, s32
    s_lshl_b32 s34, s34, 12
    v_mov_b32 v4, s51
    s_mov_b64 exec, 1
    buffer_store_dword v4, v2, s[24:27], s34 offen sc1
    s_mov_b64 exec, -1
    s_lshl_b32 s34, s28, 4
    s_add_u32 s34, s34, s48
    s_lshl_b32 s35, s34, 2
    s_add_u32 s35, s35, s32
    s_lshl_b32 s35, s35, 1
    s_mul_i32 s49, s35, 1152
    s_lshl_b32 s35, s35, 4
    s_add_u32 s77, s35, 33292288
    s_lshl_b32 s34, s34, 11
    s_add_u32 s88, s34, 33325056
    s_lshl_b32 s34, s32, 7
    s_add_u32 s84, s88, s34
    v_lshrrev_b32 v4, 5, v3
    v_lshlrev_b32 v124, 4, v4
    v_mul_u32_u24 v4, 1152, v4
    v_and_b32 v5, 31, v3
    v_lshl_add_u32 v116, v5, 4, v4
    v_lshl_add_u32 v117, v5, 2, v4
    s_mul_i32 s34, s32, 1792
    s_add_u32 s34, s34, 156672
    v_lshlrev_b32 v4, 1, v1
    v_add_u32 v118, s34, v4
    v_add_u32 v19, s34, v1
    s_lshl_b32 s34, s32, 10
    v_add_u32 v7, s34, v1
    v_min_u32 v4, 1776, v7
    v_add_u32 v119, 156672, v4
    v_cmp_lt_u32 vcc, 2047, v7
    v_mov_b32 v12, 0x7fffff00
    s_nop 0
    v_cndmask_b32 v120, v7, v12, vcc
    s_lshl_b32 s85, s48, 15
    s_add_u32 s85, s85, 32768000
    s_lshl_b32 s34, s28, 11
    s_add_u32 s76, s85, s34
    s_lshl_b32 s34, s32, 13
    s_add_u32 s85, s85, s34
    s_lshl_b32 s34, s32, 6
    s_add_u32 s34, s34, s48
    s_lshl_b32 s34, s34, 11
    s_add_u32 s86, s34, 33326080
    v_and_b32 v4, 3, v3
    v_bfe_u32 v5, v3, 2, 1
    v_lshlrev_b32 v5, 7, v5
    v_lshl_add_u32 v121, v4, 15, v5
    s_lshl_b32 s34, s28, 2
    s_add_u32 s34, s34, s32
    s_lshl_b32 s34, s34, 9
    s_add_u32 s34, s34, 33292288
    v_and_b32 v4, 0x1f0, v1
    v_add_u32 v122, s34, v4
    v_lshrrev_b32 v4, 1, v4
    s_lshl_b32 s34, s32, 8
    s_add_u32 s34, s34, 155648
    v_add_u32 v123, s34, v4
    v_mov_b32 v115, 0
    s_mov_b32 s38, 110592
    s_add_u32 m0, s40, 28672
    s_nop 0
    buffer_load_dwordx4 v20, s[8:11], s38 offen lds
    s_add_u32 m0, s40, 29696
    s_nop 0
    buffer_load_dwordx4 v21, s[8:11], s38 offen lds
    s_add_u32 m0, s40, 30720
    s_nop 0
    buffer_load_dwordx4 v22, s[8:11], s38 offen lds
    s_add_u32 m0, s40, 31744
    s_mov_b32 exec_hi, 0
    buffer_load_dwordx4 v23, s[8:11], s38 offen lds
    s_mov_b32 exec_hi, -1
    s_add_u32 m0, s40, 43008
    s_nop 0
    buffer_load_dwordx4 v24, s[8:11], s38 offen lds
    s_add_u32 m0, s40, 44032
    s_nop 0
    buffer_load_dwordx4 v25, s[8:11], s38 offen lds
    s_add_u32 m0, s40, 45056
    s_nop 0
    buffer_load_dwordx4 v26, s[8:11], s38 offen lds
    s_add_u32 m0, s40, 46080
    s_mov_b32 exec_hi, 0
    buffer_load_dwordx4 v27, s[8:11], s38 offen lds
    s_mov_b32 exec_hi, -1
    s_add_u32 m0, s41, 16384
    s_mov_b32 s38, 128
    buffer_load_dwordx4 v14, s[4:7], s38 offen lds
    s_add_u32 m0, s41, 17408
    s_mov_b32 s38, 128
    buffer_load_dwordx4 v15, s[4:7], s38 offen lds
    s_add_u32 m0, s41, 24576
    s_mov_b32 s38, 73856
    buffer_load_dwordx4 v14, s[4:7], s38 offen lds
    s_add_u32 m0, s41, 25600
    s_mov_b32 s38, 73856
    buffer_load_dwordx4 v15, s[4:7], s38 offen lds
    s_waitcnt vmcnt(13)
    s_barrier
    s_mov_b32 s38, 221184
    s_add_u32 m0, s40, 57344
    s_nop 0
    buffer_load_dwordx4 v20, s[8:11], s38 offen lds
    s_add_u32 m0, s40, 58368
    s_nop 0
    buffer_load_dwordx4 v21, s[8:11], s38 offen lds
    s_add_u32 m0, s40, 59392
    s_nop 0
    buffer_load_dwordx4 v22, s[8:11], s38 offen lds
    s_add_u32 m0, s40, 60416
    s_mov_b32 exec_hi, 0
    buffer_load_dwordx4 v23, s[8:11], s38 offen lds
    s_mov_b32 exec_hi, -1
    s_add_u32 m0, s40, 71680
    s_nop 0
    buffer_load_dwordx4 v24, s[8:11], s38 offen lds
    s_add_u32 m0, s40, 72704
    s_nop 0
    buffer_load_dwordx4 v25, s[8:11], s38 offen lds
    s_add_u32 m0, s40, 73728
    s_nop 0
    buffer_load_dwordx4 v26, s[8:11], s38 offen lds
    s_add_u32 m0, s40, 74752
    s_mov_b32 exec_hi, 0
    buffer_load_dwordx4 v27, s[8:11], s38 offen lds
    s_mov_b32 exec_hi, -1
    buffer_load_dwordx4 v[100:103], v116, s[4:7], s49 offen
    buffer_load_dwordx4 v[104:107], v116, s[4:7], s49 offen offset:512
    buffer_load_dword v108, v117, s[4:7], s49 offen offset:1024
    s_mov_b32 s54, 221184
    buffer_load_dwordx4 v[56:59], v18, s[8:11], s54 offen
    s_mov_b32 s54, 442368
    buffer_load_dwordx4 v[60:63], v18, s[8:11], s54 offen
    s_mov_b32 s54, 663552
    buffer_load_dwordx4 v[64:67], v18, s[8:11], s54 offen
    s_waitcnt vmcnt(18)
    s_barrier
    s_mov_b32 s38, 331776
    s_add_u32 m0, s40, 86016
    s_nop 0
    buffer_load_dwordx4 v20, s[8:11], s38 offen lds
    s_add_u32 m0, s40, 87040
    s_nop 0
    buffer_load_dwordx4 v21, s[8:11], s38 offen lds
    s_add_u32 m0, s40, 88064
    s_nop 0
    buffer_load_dwordx4 v22, s[8:11], s38 offen lds
    s_add_u32 m0, s40, 89088
    s_mov_b32 exec_hi, 0
    buffer_load_dwordx4 v23, s[8:11], s38 offen lds
    s_mov_b32 exec_hi, -1
    s_add_u32 m0, s40, 100352
    s_nop 0
    buffer_load_dwordx4 v24, s[8:11], s38 offen lds
    s_add_u32 m0, s40, 101376
    s_nop 0
    buffer_load_dwordx4 v25, s[8:11], s38 offen lds
    s_add_u32 m0, s40, 102400
    s_nop 0
    buffer_load_dwordx4 v26, s[8:11], s38 offen lds
    s_add_u32 m0, s40, 103424
    s_mov_b32 exec_hi, 0
    buffer_load_dwordx4 v27, s[8:11], s38 offen lds
    s_mov_b32 exec_hi, -1
    s_waitcnt vmcnt(14)
    s_barrier
    s_add_u32 m0, s41, 0
    s_mov_b32 s38, 256
    buffer_load_dwordx4 v14, s[4:7], s38 offen lds
    s_add_u32 m0, s41, 1024
    s_mov_b32 s38, 256
    buffer_load_dwordx4 v15, s[4:7], s38 offen lds
    s_add_u32 m0, s41, 8192
    s_mov_b32 s38, 73984
    buffer_load_dwordx4 v14, s[4:7], s38 offen lds
    s_add_u32 m0, s41, 9216
    s_mov_b32 s38, 73984
    buffer_load_dwordx4 v15, s[4:7], s38 offen lds
    s_mov_b32 s38, 442368
    s_add_u32 m0, s40, 0
    s_nop 0
    buffer_load_dwordx4 v20, s[8:11], s38 offen lds
    s_add_u32 m0, s40, 1024
    s_nop 0
    buffer_load_dwordx4 v21, s[8:11], s38 offen lds
    s_add_u32 m0, s40, 2048
    s_nop 0
    buffer_load_dwordx4 v22, s[8:11], s38 offen lds
    s_add_u32 m0, s40, 3072
    s_mov_b32 exec_hi, 0
    buffer_load_dwordx4 v23, s[8:11], s38 offen lds
    s_mov_b32 exec_hi, -1
    s_add_u32 m0, s40, 14336
    s_nop 0
    buffer_load_dwordx4 v24, s[8:11], s38 offen lds
    s_add_u32 m0, s40, 15360
    s_nop 0
    buffer_load_dwordx4 v25, s[8:11], s38 offen lds
    s_add_u32 m0, s40, 16384
    s_nop 0
    buffer_load_dwordx4 v26, s[8:11], s38 offen lds
    s_add_u32 m0, s40, 17408
    s_mov_b32 exec_hi, 0
    buffer_load_dwordx4 v27, s[8:11], s38 offen lds
    s_mov_b32 exec_hi, -1
    s_mov_b32 s54, 884736
    buffer_load_dwordx4 v[68:71], v18, s[8:11], s54 offen
    s_mov_b32 s54, 1105920
    buffer_load_dwordx4 v[72:75], v18, s[8:11], s54 offen
    s_mov_b32 s54, 1327104
    buffer_load_dwordx4 v[76:79], v18, s[8:11], s54 offen
    s_mov_b32 s54, 1548288
    buffer_load_dwordx4 v[80:83], v18, s[8:11], s54 offen
    s_mov_b32 s54, 1769472
    buffer_load_dwordx4 v[84:87], v18, s[8:11], s54 offen
    s_mov_b32 s54, 0
    buffer_load_dwordx4 v[88:91], v18, s[8:11], s54 offen
    buffer_load_dword v114, v2, s[24:27], 0 offen sc1
    s_waitcnt vmcnt(19)
    s_barrier
    s_mov_b32 s38, 552960
    s_add_u32 m0, s40, 28672
    s_nop 0
    buffer_load_dwordx4 v20, s[8:11], s38 offen lds
    s_add_u32 m0, s40, 29696
    s_nop 0
    buffer_load_dwordx4 v21, s[8:11], s38 offen lds
    s_add_u32 m0, s40, 30720
    s_nop 0
    buffer_load_dwordx4 v22, s[8:11], s38 offen lds
    s_add_u32 m0, s40, 31744
    s_mov_b32 exec_hi, 0
    buffer_load_dwordx4 v23, s[8:11], s38 offen lds
    s_mov_b32 exec_hi, -1
    s_add_u32 m0, s40, 43008
    s_nop 0
    buffer_load_dwordx4 v24, s[8:11], s38 offen lds
    s_add_u32 m0, s40, 44032
    s_nop 0
    buffer_load_dwordx4 v25, s[8:11], s38 offen lds
    s_add_u32 m0, s40, 45056
    s_nop 0
    buffer_load_dwordx4 v26, s[8:11], s38 offen lds
    s_add_u32 m0, s40, 46080
    s_mov_b32 exec_hi, 0
    buffer_load_dwordx4 v27, s[8:11], s38 offen lds
    s_mov_b32 exec_hi, -1
    v_lshlrev_b32 v4, 16, v100
    v_and_b32 v5, s52, v100
    v_add_f32 v112, v4, v5
    v_mul_f32 v113, v4, v4
    v_fmac_f32 v113, v5, v5
    v_lshlrev_b32 v4, 16, v101
    v_and_b32 v5, s52, v101
    v_add_f32 v112, v112, v4
    v_fmac_f32 v113, v4, v4
    v_add_f32 v112, v112, v5
    v_fmac_f32 v113, v5, v5
    v_lshlrev_b32 v4, 16, v102
    v_and_b32 v5, s52, v102
    v_add_f32 v112, v112, v4
    v_fmac_f32 v113, v4, v4
    v_add_f32 v112, v112, v5
    v_fmac_f32 v113, v5, v5
    v_lshlrev_b32 v4, 16, v103
    v_and_b32 v5, s52, v103
    v_add_f32 v112, v112, v4
    v_fmac_f32 v113, v4, v4
    v_add_f32 v112, v112, v5
    v_fmac_f32 v113, v5, v5
    v_lshlrev_b32 v4, 16, v104
    v_and_b32 v5, s52, v104
    v_add_f32 v112, v112, v4
    v_fmac_f32 v113, v4, v4
    v_add_f32 v112, v112, v5
    v_fmac_f32 v113, v5, v5
    v_lshlrev_b32 v4, 16, v105
    v_and_b32 v5, s52, v105
    v_add_f32 v112, v112, v4
    v_fmac_f32 v113, v4, v4
    v_add_f32 v112, v112, v5
    v_fmac_f32 v113, v5, v5
    v_lshlrev_b32 v4, 16, v106
    v_and_b32 v5, s52, v106
    v_add_f32 v112, v112, v4
    v_fmac_f32 v113, v4, v4
    v_add_f32 v112, v112, v5
    v_fmac_f32 v113, v5, v5
    v_lshlrev_b32 v4, 16, v107
    v_and_b32 v5, s52, v107
    v_add_f32 v112, v112, v4
    v_fmac_f32 v113, v4, v4
    v_add_f32 v112, v112, v5
    v_fmac_f32 v113, v5, v5
    v_lshlrev_b32 v4, 16, v108
    v_and_b32 v5, s52, v108
    v_add_f32 v112, v112, v4
    v_fmac_f32 v113, v4, v4
    v_add_f32 v112, v112, v5
    v_fmac_f32 v113, v5, v5
    s_nop 0
    v_add_f32_dpp v112, v112, v112 quad_perm:[1,0,3,2] row_mask:0xf bank_mask:0xf
    v_add_f32_dpp v113, v113, v113 quad_perm:[1,0,3,2] row_mask:0xf bank_mask:0xf
    s_nop 0
    v_add_f32_dpp v112, v112, v112 quad_perm:[2,3,0,1] row_mask:0xf bank_mask:0xf
    v_add_f32_dpp v113, v113, v113 quad_perm:[2,3,0,1] row_mask:0xf bank_mask:0xf
    s_nop 0
    v_add_f32_dpp v112, v112, v112 row_half_mirror row_mask:0xf bank_mask:0xf
    v_add_f32_dpp v113, v113, v113 row_half_mirror row_mask:0xf bank_mask:0xf
    s_nop 0
    v_add_f32_dpp v112, v112, v112 row_mirror row_mask:0xf bank_mask:0xf
    v_add_f32_dpp v113, v113, v113 row_mirror row_mask:0xf bank_mask:0xf
    v_mov_b32 v6, v112
    v_mov_b32 v7, v113
    s_nop 0
    v_permlane16_swap_b32 v112, v6
    v_permlane16_swap_b32 v113, v7
    v_add_f32 v112, v112, v6
    v_add_f32 v113, v113, v7
    v_mul_f32 v112, 0x3ae38e39, v112
    v_mul_f32 v113, 0x3ae38e39, v113
    v_fma_f32 v113, -v112, v112, v113
    v_max_f32 v113, 0, v113
    v_add_f32 v113, 0x3727c5ac, v113
    s_waitcnt vmcnt(15)
    s_barrier
    s_add_u32 m0, s41, 16384
    s_mov_b32 s38, 384
    buffer_load_dwordx4 v14, s[4:7], s38 offen lds
    s_add_u32 m0, s41, 17408
    s_mov_b32 s38, 384
    buffer_load_dwordx4 v15, s[4:7], s38 offen lds
    s_add_u32 m0, s41, 24576
    s_mov_b32 s38, 74112
    buffer_load_dwordx4 v14, s[4:7], s38 offen lds
    s_add_u32 m0, s41, 25600
    s_mov_b32 s38, 74112
    buffer_load_dwordx4 v15, s[4:7], s38 offen lds
    s_mov_b32 s38, 663552
    s_add_u32 m0, s40, 57344
    s_nop 0
    buffer_load_dwordx4 v20, s[8:11], s38 offen lds
    s_add_u32 m0, s40, 58368
    s_nop 0
    buffer_load_dwordx4 v21, s[8:11], s38 offen lds
    s_add_u32 m0, s40, 59392
    s_nop 0
    buffer_load_dwordx4 v22, s[8:11], s38 offen lds
    s_add_u32 m0, s40, 60416
    s_mov_b32 exec_hi, 0
    buffer_load_dwordx4 v23, s[8:11], s38 offen lds
    s_mov_b32 exec_hi, -1
    s_add_u32 m0, s40, 71680
    s_nop 0
    buffer_load_dwordx4 v24, s[8:11], s38 offen lds
    s_add_u32 m0, s40, 72704
    s_nop 0
    buffer_load_dwordx4 v25, s[8:11], s38 offen lds
    s_add_u32 m0, s40, 73728
    s_nop 0
    buffer_load_dwordx4 v26, s[8:11], s38 offen lds
    s_add_u32 m0, s40, 74752
    s_mov_b32 exec_hi, 0
    buffer_load_dwordx4 v27, s[8:11], s38 offen lds
    s_mov_b32 exec_hi, -1
    s_waitcnt vmcnt(20)
    s_mov_b32 s55, 0
L_nl11:
    v_readfirstlane_b32 s46, v114
    s_add_u32 s55, s55, 1
    s_cmp_lg_u32 s46, 0
    s_cbranch_scc1 L_nw11
    s_cmp_ge_u32 s55, 1048576
    s_cbranch_scc1 L_nw11
    buffer_load_dword v114, v2, s[24:27], 0 offen sc1
    s_waitcnt vmcnt(0)
    s_branch L_nl11
L_nw11:
    s_not_b32 s47, s46
    s_mov_b32 exec_lo, 1
    s_mov_b32 exec_hi, 1
    buffer_store_dwordx4 v[112:115], v124, s[16:19], s77 offen sc1
    s_mov_b64 exec, -1
    v_lshlrev_b32 v92, 16, v56
    v_and_b32 v93, s52, v56
    v_lshlrev_b32 v94, 16, v57
    v_and_b32 v95, s52, v57
    v_lshlrev_b32 v96, 16, v58
    v_and_b32 v97, s52, v58
    v_lshlrev_b32 v98, 16, v59
    v_and_b32 v99, s52, v59
    v_lshlrev_b32 v4, 16, v60
    v_and_b32 v5, s52, v60
    v_add_f32 v92, v92, v4
    v_add_f32 v93, v93, v5
    v_lshlrev_b32 v6, 16, v61
    v_and_b32 v7, s52, v61
    v_add_f32 v94, v94, v6
    v_add_f32 v95, v95, v7
    v_lshlrev_b32 v4, 16, v62
    v_and_b32 v5, s52, v62
    v_add_f32 v96, v96, v4
    v_add_f32 v97, v97, v5
    v_lshlrev_b32 v6, 16, v63
    v_and_b32 v7, s52, v63
    v_add_f32 v98, v98, v6
    v_add_f32 v99, v99, v7
    v_lshlrev_b32 v4, 16, v64
    v_and_b32 v5, s52, v64
    v_add_f32 v92, v92, v4
    v_add_f32 v93, v93, v5
    v_lshlrev_b32 v6, 16, v65
    v_and_b32 v7, s52, v65
    v_add_f32 v94, v94, v6
    v_add_f32 v95, v95, v7
    v_lshlrev_b32 v4, 16, v66
    v_and_b32 v5, s52, v66
    v_add_f32 v96, v96, v4
    v_add_f32 v97, v97, v5
    v_lshlrev_b32 v6, 16, v67
    v_and_b32 v7, s52, v67
    v_add_f32 v98, v98, v6
    v_add_f32 v99, v99, v7
    s_waitcnt vmcnt(13)
    s_barrier
    s_mov_b32 s38, 774144
    s_add_u32 m0, s40, 86016
    s_nop 0
    buffer_load_dwordx4 v20, s[8:11], s38 offen lds
    s_add_u32 m0, s40, 87040
    s_nop 0
    buffer_load_dwordx4 v21, s[8:11], s38 offen lds
    s_add_u32 m0, s40, 88064
    s_nop 0
    buffer_load_dwordx4 v22, s[8:11], s38 offen lds
    s_add_u32 m0, s40, 89088
    s_mov_b32 exec_hi, 0
    buffer_load_dwordx4 v23, s[8:11], s38 offen lds
    s_mov_b32 exec_hi, -1
    s_add_u32 m0, s40, 100352
    s_nop 0
    buffer_load_dwordx4 v24, s[8:11], s38 offen lds
    s_add_u32 m0, s40, 101376
    s_nop 0
    buffer_load_dwordx4 v25, s[8:11], s38 offen lds
    s_add_u32 m0, s40, 102400
    s_nop 0
    buffer_load_dwordx4 v26, s[8:11], s38 offen lds
    s_add_u32 m0, s40, 103424
    s_mov_b32 exec_hi, 0
    buffer_load_dwordx4 v27, s[8:11], s38 offen lds
    s_mov_b32 exec_hi, -1
    v_lshlrev_b32 v4, 16, v68
    v_and_b32 v5, s52, v68
    v_add_f32 v92, v92, v4
    v_add_f32 v93, v93, v5
    v_lshlrev_b32 v6, 16, v69
    v_and_b32 v7, s52, v69
    v_add_f32 v94, v94, v6
    v_add_f32 v95, v95, v7
    v_lshlrev_b32 v4, 16, v70
    v_and_b32 v5, s52, v70
    v_add_f32 v96, v96, v4
    v_add_f32 v97, v97, v5
    v_lshlrev_b32 v6, 16, v71
    v_and_b32 v7, s52, v71
    v_add_f32 v98, v98, v6
    v_add_f32 v99, v99, v7
    v_lshlrev_b32 v4, 16, v72
    v_and_b32 v5, s52, v72
    v_add_f32 v92, v92, v4
    v_add_f32 v93, v93, v5
    v_lshlrev_b32 v6, 16, v73
    v_and_b32 v7, s52, v73
    v_add_f32 v94, v94, v6
    v_add_f32 v95, v95, v7
    v_lshlrev_b32 v4, 16, v74
    v_and_b32 v5, s52, v74
    v_add_f32 v96, v96, v4
    v_add_f32 v97, v97, v5
    v_lshlrev_b32 v6, 16, v75
    v_and_b32 v7, s52, v75
    v_add_f32 v98, v98, v6
    v_add_f32 v99, v99, v7
    v_lshlrev_b32 v4, 16, v76
    v_and_b32 v5, s52, v76
    v_add_f32 v92, v92, v4
    v_add_f32 v93, v93, v5
    v_lshlrev_b32 v6, 16, v77
    v_and_b32 v7, s52, v77
    v_add_f32 v94, v94, v6
    v_add_f32 v95, v95, v7
    v_lshlrev_b32 v4, 16, v78
    v_and_b32 v5, s52, v78
    v_add_f32 v96, v96, v4
    v_add_f32 v97, v97, v5
    v_lshlrev_b32 v6, 16, v79
    v_and_b32 v7, s52, v79
    v_add_f32 v98, v98, v6
    v_add_f32 v99, v99, v7
    v_lshlrev_b32 v4, 16, v80
    v_and_b32 v5, s52, v80
    v_add_f32 v92, v92, v4
    v_add_f32 v93, v93, v5
    v_lshlrev_b32 v6, 16, v81
    v_and_b32 v7, s52, v81
    v_add_f32 v94, v94, v6
    v_add_f32 v95, v95, v7
    v_lshlrev_b32 v4, 16, v82
    v_and_b32 v5, s52, v82
    v_add_f32 v96, v96, v4
    v_add_f32 v97, v97, v5
    v_lshlrev_b32 v6, 16, v83
    v_and_b32 v7, s52, v83
    v_add_f32 v98, v98, v6
    v_add_f32 v99, v99, v7
    s_waitcnt vmcnt(9)
    s_barrier
    s_add_u32 m0, s41, 0
    s_mov_b32 s38, 512
    buffer_load_dwordx4 v14, s[4:7], s38 offen lds
    s_add_u32 m0, s41, 1024
    s_mov_b32 s38, 512
    buffer_load_dwordx4 v15, s[4:7], s38 offen lds
    s_add_u32 m0, s41, 8192
    s_mov_b32 s38, 74240
    buffer_load_dwordx4 v14, s[4:7], s38 offen lds
    s_add_u32 m0, s41, 9216
    s_mov_b32 s38, 74240
    buffer_load_dwordx4 v15, s[4:7], s38 offen lds
    s_mov_b32 s38, 884736
    s_add_u32 m0, s40, 0
    s_nop 0
    buffer_load_dwordx4 v20, s[8:11], s38 offen lds
    s_add_u32 m0, s40, 1024
    s_nop 0
    buffer_load_dwordx4 v21, s[8:11], s38 offen lds
    s_add_u32 m0, s40, 2048
    s_nop 0
    buffer_load_dwordx4 v22, s[8:11], s38 offen lds
    s_add_u32 m0, s40, 3072
    s_mov_b32 exec_hi, 0
    buffer_load_dwordx4 v23, s[8:11], s38 offen lds
    s_mov_b32 exec_hi, -1
    s_add_u32 m0, s40, 14336
    s_nop 0
    buffer_load_dwordx4 v24, s[8:11], s38 offen lds
    s_add_u32 m0, s40, 15360
    s_nop 0
    buffer_load_dwordx4 v25, s[8:11], s38 offen lds
    s_add_u32 m0, s40, 16384
    s_nop 0
    buffer_load_dwordx4 v26, s[8:11], s38 offen lds
    s_add_u32 m0, s40, 17408
    s_mov_b32 exec_hi, 0
    buffer_load_dwordx4 v27, s[8:11], s38 offen lds
    s_mov_b32 exec_hi, -1
    v_lshlrev_b32 v4, 16, v84
    v_and_b32 v5, s52, v84
    v_add_f32 v92, v92, v4
    v_add_f32 v93, v93, v5
    v_lshlrev_b32 v6, 16, v85
    v_and_b32 v7, s52, v85
    v_add_f32 v94, v94, v6
    v_add_f32 v95, v95, v7
    v_lshlrev_b32 v4, 16, v86
    v_and_b32 v5, s52, v86
    v_add_f32 v96, v96, v4
    v_add_f32 v97, v97, v5
    v_lshlrev_b32 v6, 16, v87
    v_and_b32 v7, s52, v87
    v_add_f32 v98, v98, v6
    v_add_f32 v99, v99, v7
    v_lshlrev_b32 v4, 16, v88
    v_and_b32 v5, s52, v88
    v_add_f32 v92, v92, v4
    v_add_f32 v93, v93, v5
    v_lshlrev_b32 v6, 16, v89
    v_and_b32 v7, s52, v89
    v_add_f32 v94, v94, v6
    v_add_f32 v95, v95, v7
    v_lshlrev_b32 v4, 16, v90
    v_and_b32 v5, s52, v90
    v_add_f32 v96, v96, v4
    v_add_f32 v97, v97, v5
    v_lshlrev_b32 v6, 16, v91
    v_and_b32 v7, s52, v91
    v_add_f32 v98, v98, v6
    v_add_f32 v99, v99, v7
    s_mov_b32 exec_hi, 0xffffff
    ds_write_b128 v118, v[92:95]
    ds_write_b128 v118, v[96:99] offset:16
    s_mov_b32 exec_hi, -1
    s_waitcnt vmcnt(12) lgkmcnt(0)
    s_barrier
    ds_read_b128 v[56:59], v119 offset:0
    ds_read_b128 v[60:63], v119 offset:1792
    ds_read_b128 v[64:67], v119 offset:3584
    ds_read_b128 v[68:71], v119 offset:5376
    s_mov_b32 s38, 995328
    s_add_u32 m0, s40, 28672
    s_nop 0
    buffer_load_dwordx4 v20, s[8:11], s38 offen lds
    s_add_u32 m0, s40, 29696
    s_nop 0
    buffer_load_dwordx4 v21, s[8:11], s38 offen lds
    s_add_u32 m0, s40, 30720
    s_nop 0
    buffer_load_dwordx4 v22, s[8:11], s38 offen lds
    s_add_u32 m0, s40, 31744
    s_mov_b32 exec_hi, 0
    buffer_load_dwordx4 v23, s[8:11], s38 offen lds
    s_mov_b32 exec_hi, -1
    s_add_u32 m0, s40, 43008
    s_nop 0
    buffer_load_dwordx4 v24, s[8:11], s38 offen lds
    s_add_u32 m0, s40, 44032
    s_nop 0
    buffer_load_dwordx4 v25, s[8:11], s38 offen lds
    s_add_u32 m0, s40, 45056
    s_nop 0
    buffer_load_dwordx4 v26, s[8:11], s38 offen lds
    s_add_u32 m0, s40, 46080
    s_mov_b32 exec_hi, 0
    buffer_load_dwordx4 v27, s[8:11], s38 offen lds
    s_mov_b32 exec_hi, -1
    s_waitcnt lgkmcnt(0)
    v_add_f32 v56, v56, v60
    v_add_f32 v64, v64, v68
    v_add_f32 v57, v57, v61
    v_add_f32 v65, v65, v69
    v_add_f32 v58, v58, v62
    v_add_f32 v66, v66, v70
    v_add_f32 v59, v59, v63
    v_add_f32 v67, v67, v71
    v_add_f32 v56, v56, v64
    v_add_f32 v57, v57, v65
    v_add_f32 v58, v58, v66
    v_add_f32 v59, v59, v67
    buffer_store_dwordx4 v[56:59], v120, s[16:19], s76 offen sc1
    v_mov_b32 v29, 114688
    v_mov_b32 v30, s46
    ds_write_b32 v29, v30
    s_waitcnt vmcnt(9) lgkmcnt(0)
    s_barrier
    s_add_u32 m0, s41, 16384
    s_mov_b32 s38, 640
    buffer_load_dwordx4 v14, s[4:7], s38 offen lds
    s_add_u32 m0, s41, 17408
    s_mov_b32 s38, 640
    buffer_load_dwordx4 v15, s[4:7], s38 offen lds
    s_add_u32 m0, s41, 24576
    s_mov_b32 s38, 74368
    buffer_load_dwordx4 v14, s[4:7], s38 offen lds
    s_add_u32 m0, s41, 25600
    s_mov_b32 s38, 74368
    buffer_load_dwordx4 v15, s[4:7], s38 offen lds
    s_mov_b32 s38, 1105920
    s_add_u32 m0, s40, 57344
    s_nop 0
    buffer_load_dwordx4 v20, s[8:11], s38 offen lds
    s_add_u32 m0, s40, 58368
    s_nop 0
    buffer_load_dwordx4 v21, s[8:11], s38 offen lds
    s_add_u32 m0, s40, 59392
    s_nop 0
    buffer_load_dwordx4 v22, s[8:11], s38 offen lds
    s_add_u32 m0, s40, 60416
    s_mov_b32 exec_hi, 0
    buffer_load_dwordx4 v23, s[8:11], s38 offen lds
    s_mov_b32 exec_hi, -1
    s_add_u32 m0, s40, 71680
    s_nop 0
    buffer_load_dwordx4 v24, s[8:11], s38 offen lds
    s_add_u32 m0, s40, 72704
    s_nop 0
    buffer_load_dwordx4 v25, s[8:11], s38 offen lds
    s_add_u32 m0, s40, 73728
    s_nop 0
    buffer_load_dwordx4 v26, s[8:11], s38 offen lds
    s_add_u32 m0, s40, 74752
    s_mov_b32 exec_hi, 0
    buffer_load_dwordx4 v27, s[8:11], s38 offen lds
    s_mov_b32 exec_hi, -1
    s_waitcnt vmcnt(13)
    s_barrier
    s_mov_b32 s38, 1216512
    s_add_u32 m0, s40, 86016
    s_nop 0
    buffer_load_dwordx4 v20, s[8:11], s38 offen lds
    s_add_u32 m0, s40, 87040
    s_nop 0
    buffer_load_dwordx4 v21, s[8:11], s38 offen lds
    s_add_u32 m0, s40, 88064
    s_nop 0
    buffer_load_dwordx4 v22, s[8:11], s38 offen lds
    s_add_u32 m0, s40, 89088
    s_mov_b32 exec_hi, 0
    buffer_load_dwordx4 v23, s[8:11], s38 offen lds
    s_mov_b32 exec_hi, -1
    s_add_u32 m0, s40, 100352
    s_nop 0
    buffer_load_dwordx4 v24, s[8:11], s38 offen lds
    s_add_u32 m0, s40, 101376
    s_nop 0
    buffer_load_dwordx4 v25, s[8:11], s38 offen lds
    s_add_u32 m0, s40, 102400
    s_nop 0
    buffer_load_dwordx4 v26, s[8:11], s38 offen lds
    s_add_u32 m0, s40, 103424
    s_mov_b32 exec_hi, 0
    buffer_load_dwordx4 v27, s[8:11], s38 offen lds
    s_mov_b32 exec_hi, -1
    s_waitcnt vmcnt(20)
    v_mov_b32 v16, s46
    s_add_u32 s54, s47, 1
    v_mov_b32 v17, s54
    s_mov_b64 exec, 1
    buffer_store_dwordx2 v[16:17], v2, s[16:19], s84 offen offset:1024 sc1
    s_mov_b64 exec, -1
    s_waitcnt vmcnt(9)
    s_barrier
    s_add_u32 m0, s41, 0
    s_mov_b32 s38, 768
    buffer_load_dwordx4 v14, s[4:7], s38 offen lds
    s_add_u32 m0, s41, 1024
    s_mov_b32 s38, 768
    buffer_load_dwordx4 v15, s[4:7], s38 offen lds
    s_add_u32 m0, s41, 8192
    s_mov_b32 s38, 74496
    buffer_load_dwordx4 v14, s[4:7], s38 offen lds
    s_add_u32 m0, s41, 9216
    s_mov_b32 s38, 74496
    buffer_load_dwordx4 v15, s[4:7], s38 offen lds
    s_mov_b32 s38, 1327104
    s_add_u32 m0, s40, 0
    s_nop 0
    buffer_load_dwordx4 v20, s[8:11], s38 offen lds
    s_add_u32 m0, s40, 1024
    s_nop 0
    buffer_load_dwordx4 v21, s[8:11], s38 offen lds
    s_add_u32 m0, s40, 2048
    s_nop 0
    buffer_load_dwordx4 v22, s[8:11], s38 offen lds
    s_add_u32 m0, s40, 3072
    s_mov_b32 exec_hi, 0
    buffer_load_dwordx4 v23, s[8:11], s38 offen lds
    s_mov_b32 exec_hi, -1
    s_add_u32 m0, s40, 14336
    s_nop 0
    buffer_load_dwordx4 v24, s[8:11], s38 offen lds
    s_add_u32 m0, s40, 15360
    s_nop 0
    buffer_load_dwordx4 v25, s[8:11], s38 offen lds
    s_add_u32 m0, s40, 16384
    s_nop 0
    buffer_load_dwordx4 v26, s[8:11], s38 offen lds
    s_add_u32 m0, s40, 17408
    s_mov_b32 exec_hi, 0
    buffer_load_dwordx4 v27, s[8:11], s38 offen lds
    s_mov_b32 exec_hi, -1
    s_getpc_b64 s[94:95]
L_cpfA:
    s_sub_u32 s94, s94, L_cpfA-L_tgtA
    s_subb_u32 s95, s95, 0
    s_bfe_u32 s54, s2, 0x30005
    s_lshl_b32 s54, s54, 2
    s_add_u32 s54, s54, s32
    s_lshl_b32 s54, s54, 10
    v_and_b32 v18, 7, v3
    v_lshlrev_b32 v18, 7, v18
    v_add_u32 v18, s54, v18
    v_min_u32 v18, CODE_A, v18
    global_load_dword v28, v18, s[94:95]
    s_waitcnt vmcnt(14)
    s_barrier
    s_mov_b32 s38, 1437696
    s_add_u32 m0, s40, 28672
    s_nop 0
    buffer_load_dwordx4 v20, s[8:11], s38 offen lds
    s_add_u32 m0, s40, 29696
    s_nop 0
    buffer_load_dwordx4 v21, s[8:11], s38 offen lds
    s_add_u32 m0, s40, 30720
    s_nop 0
    buffer_load_dwordx4 v22, s[8:11], s38 offen lds
    s_add_u32 m0, s40, 31744
    s_mov_b32 exec_hi, 0
    buffer_load_dwordx4 v23, s[8:11], s38 offen lds
    s_mov_b32 exec_hi, -1
    s_add_u32 m0, s40, 43008
    s_nop 0
    buffer_load_dwordx4 v24, s[8:11], s38 offen lds
    s_add_u32 m0, s40, 44032
    s_nop 0
    buffer_load_dwordx4 v25, s[8:11], s38 offen lds
    s_add_u32 m0, s40, 45056
    s_nop 0
    buffer_load_dwordx4 v26, s[8:11], s38 offen lds
    s_add_u32 m0, s40, 46080
    s_mov_b32 exec_hi, 0
    buffer_load_dwordx4 v27, s[8:11], s38 offen lds
    s_mov_b32 exec_hi, -1
    buffer_load_dwordx4 v[100:103], v122, s[16:19], 0 offen sc1
    buffer_load_dwordx2 v[16:17], v121, s[16:19], s86 offen offset:0 sc1
    s_waitcnt vmcnt(11)
    s_barrier
    s_add_u32 m0, s41, 16384
    s_mov_b32 s38, 896
    buffer_load_dwordx4 v14, s[4:7], s38 offen lds
    s_add_u32 m0, s41, 17408
    s_mov_b32 s38, 896
    buffer_load_dwordx4 v15, s[4:7], s38 offen lds
    s_add_u32 m0, s41, 24576
    s_mov_b32 s38, 74624
    buffer_load_dwordx4 v14, s[4:7], s38 offen lds
    s_add_u32 m0, s41, 25600
    s_mov_b32 s38, 74624
    buffer_load_dwordx4 v15, s[4:7], s38 offen lds
    s_mov_b32 s38, 1548288
    s_add_u32 m0, s40, 57344
    s_nop 0
    buffer_load_dwordx4 v20, s[8:11], s38 offen lds
    s_add_u32 m0, s40, 58368
    s_nop 0
    buffer_load_dwordx4 v21, s[8:11], s38 offen lds
    s_add_u32 m0, s40, 59392
    s_nop 0
    buffer_load_dwordx4 v22, s[8:11], s38 offen lds
    s_add_u32 m0, s40, 60416
    s_mov_b32 exec_hi, 0
    buffer_load_dwordx4 v23, s[8:11], s38 offen lds
    s_mov_b32 exec_hi, -1
    s_add_u32 m0, s40, 71680
    s_nop 0
    buffer_load_dwordx4 v24, s[8:11], s38 offen lds
    s_add_u32 m0, s40, 72704
    s_nop 0
    buffer_load_dwordx4 v25, s[8:11], s38 offen lds
    s_add_u32 m0, s40, 73728
    s_nop 0
    buffer_load_dwordx4 v26, s[8:11], s38 offen lds
    s_add_u32 m0, s40, 74752
    s_mov_b32 exec_hi, 0
    buffer_load_dwordx4 v27, s[8:11], s38 offen lds
    s_mov_b32 exec_hi, -1
    s_waitcnt vmcnt(14)
    s_barrier
    s_mov_b32 s38, 1658880
    s_add_u32 m0, s40, 86016
    s_nop 0
    buffer_load_dwordx4 v20, s[8:11], s38 offen lds
    s_add_u32 m0, s40, 87040
    s_nop 0
    buffer_load_dwordx4 v21, s[8:11], s38 offen lds
    s_add_u32 m0, s40, 88064
    s_nop 0
    buffer_load_dwordx4 v22, s[8:11], s38 offen lds
    s_add_u32 m0, s40, 89088
    s_mov_b32 exec_hi, 0
    buffer_load_dwordx4 v23, s[8:11], s38 offen lds
    s_mov_b32 exec_hi, -1
    s_add_u32 m0, s40, 100352
    s_nop 0
    buffer_load_dwordx4 v24, s[8:11], s38 offen lds
    s_add_u32 m0, s40, 101376
    s_nop 0
    buffer_load_dwordx4 v25, s[8:11], s38 offen lds
    s_add_u32 m0, s40, 102400
    s_nop 0
    buffer_load_dwordx4 v26, s[8:11], s38 offen lds
    s_add_u32 m0, s40, 103424
    s_mov_b32 exec_hi, 0
    buffer_load_dwordx4 v27, s[8:11], s38 offen lds
    s_mov_b32 exec_hi, -1
    s_waitcnt vmcnt(20)
    s_mov_b32 s55, 0
    s_add_u32 s54, s47, 1
L_poll12:
    v_xor_b32 v16, s46, v16
    v_subrev_u32 v17, s54, v17
    v_and_b32 v17, -8, v17
    v_or_b32 v16, v16, v17
    v_cmp_ne_u32 vcc, 0, v16
    s_add_u32 s55, s55, 1
    s_nop 0
    s_cmp_eq_u64 vcc, 0
    s_cbranch_scc1 L_pollx12
    s_cmp_ge_u32 s55, 1048576
    s_cbranch_scc1 L_pollx12
    buffer_load_dwordx2 v[16:17], v121, s[16:19], s86 offen offset:0 sc1
    s_waitcnt vmcnt(0)
    s_branch L_poll12
L_pollx12:
    s_add_u32 s54, s85, 0
    buffer_load_dwordx4 v[56:59], v1, s[16:19], s54 offen offset:0 sc1
    buffer_load_dwordx4 v[60:63], v1, s[16:19], s54 offen offset:1024 sc1
    s_add_u32 s54, s85, 2048
    buffer_load_dwordx4 v[64:67], v1, s[16:19], s54 offen offset:0 sc1
    buffer_load_dwordx4 v[68:71], v1, s[16:19], s54 offen offset:1024 sc1
    s_add_u32 s54, s85, 4096
    buffer_load_dwordx4 v[72:75], v1, s[16:19], s54 offen offset:0 sc1
    buffer_load_dwordx4 v[76:79], v1, s[16:19], s54 offen offset:1024 sc1
    s_add_u32 s54, s85, 6144
    buffer_load_dwordx4 v[80:83], v1, s[16:19], s54 offen offset:0 sc1
    buffer_load_dwordx4 v[84:87], v1, s[16:19], s54 offen offset:1024 sc1
    s_mov_b32 s55, 0
L_st13:
    v_cmp_ne_u32 vcc, s46, v102
    s_add_u32 s55, s55, 1
    s_nop 0
    s_cmp_eq_u64 vcc, 0
    s_cbranch_scc1 L_stx13
    s_cmp_ge_u32 s55, 1048576
    s_cbranch_scc1 L_stx13
    buffer_load_dwordx4 v[100:103], v122, s[16:19], 0 offen sc1
    s_waitcnt vmcnt(0)
    s_branch L_st13
L_stx13:
    ds_write_b64 v123, v[100:101]
    s_waitcnt vmcnt(16) lgkmcnt(0)
    s_barrier
    s_add_u32 m0, s41, 0
    s_mov_b32 s38, 1024
    buffer_load_dwordx4 v14, s[4:7], s38 offen lds
    s_add_u32 m0, s41, 1024
    s_mov_b32 s38, 1024
    buffer_load_dwordx4 v15, s[4:7], s38 offen lds
    s_add_u32 m0, s41, 8192
    s_mov_b32 s38, 74752
    buffer_load_dwordx4 v14, s[4:7], s38 offen lds
    s_add_u32 m0, s41, 9216
    s_mov_b32 s38, 74752
    buffer_load_dwordx4 v15, s[4:7], s38 offen lds
    s_mov_b32 s38, 1769472
    s_add_u32 m0, s40, 0
    s_nop 0
    buffer_load_dwordx4 v20, s[8:11], s38 offen lds
    s_add_u32 m0, s40, 1024
    s_nop 0
    buffer_load_dwordx4 v21, s[8:11], s38 offen lds
    s_add_u32 m0, s40, 2048
    s_nop 0
    buffer_load_dwordx4 v22, s[8:11], s38 offen lds
    s_add_u32 m0, s40, 3072
    s_mov_b32 exec_hi, 0
    buffer_load_dwordx4 v23, s[8:11], s38 offen lds
    s_mov_b32 exec_hi, -1
    s_add_u32 m0, s40, 14336
    s_nop 0
    buffer_load_dwordx4 v24, s[8:11], s38 offen lds
    s_add_u32 m0, s40, 15360
    s_nop 0
    buffer_load_dwordx4 v25, s[8:11], s38 offen lds
    s_add_u32 m0, s40, 16384
    s_nop 0
    buffer_load_dwordx4 v26, s[8:11], s38 offen lds
    s_add_u32 m0, s40, 17408
    s_mov_b32 exec_hi, 0
    buffer_load_dwordx4 v27, s[8:11], s38 offen lds
    s_mov_b32 exec_hi, -1
    s_waitcnt vmcnt(20)
    s_barrier
    s_mov_b32 s38, 1880064
    s_add_u32 m0, s40, 28672
    s_nop 0
    buffer_load_dwordx4 v20, s[8:11], s38 offen lds
    s_add_u32 m0, s40, 29696
    s_nop 0
    buffer_load_dwordx4 v21, s[8:11], s38 offen lds
    s_add_u32 m0, s40, 30720
    s_nop 0
    buffer_load_dwordx4 v22, s[8:11], s38 offen lds
    s_add_u32 m0, s40, 31744
    s_mov_b32 exec_hi, 0
    buffer_load_dwordx4 v23, s[8:11], s38 offen lds
    s_mov_b32 exec_hi, -1
    s_add_u32 m0, s40, 43008
    s_nop 0
    buffer_load_dwordx4 v24, s[8:11], s38 offen lds
    s_add_u32 m0, s40, 44032
    s_nop 0
    buffer_load_dwordx4 v25, s[8:11], s38 offen lds
    s_add_u32 m0, s40, 45056
    s_nop 0
    buffer_load_dwordx4 v26, s[8:11], s38 offen lds
    s_add_u32 m0, s40, 46080
    s_mov_b32 exec_hi, 0
    buffer_load_dwordx4 v27, s[8:11], s38 offen lds
    s_mov_b32 exec_hi, -1
    s_waitcnt vmcnt(20)
    v_add_f32 v56, v56, v72
    v_add_f32 v57, v57, v73
    v_add_f32 v58, v58, v74
    v_add_f32 v59, v59, v75
    v_add_f32 v60, v60, v76
    v_add_f32 v61, v61, v77
    v_add_f32 v62, v62, v78
    v_add_f32 v63, v63, v79
    v_add_f32 v64, v64, v80
    v_add_f32 v65, v65, v81
    v_add_f32 v66, v66, v82
    v_add_f32 v67, v67, v83
    v_add_f32 v68, v68, v84
    v_add_f32 v69, v69, v85
    v_add_f32 v70, v70, v86
    v_add_f32 v71, v71, v87
    v_add_f32 v56, v56, v64
    v_add_f32 v57, v57, v65
    v_add_f32 v58, v58, v66
    v_add_f32 v59, v59, v67
    v_add_f32 v60, v60, v68
    v_add_f32 v61, v61, v69
    v_add_f32 v62, v62, v70
    v_add_f32 v63, v63, v71
    ds_write_b128 v19, v[56:59]
    s_mov_b32 exec_lo, 0xffffffff
    s_mov_b32 exec_hi, 0xffff
    ds_write_b128 v19, v[60:63] offset:1024
    s_mov_b64 exec, -1
    s_waitcnt vmcnt(8) lgkmcnt(0)
    s_barrier
    s_waitcnt vmcnt(0)
    s_barrier
    s_cmp_lg_u32 s32, 0
    s_cbranch_scc1 L_aend
    s_lshl_b32 s34, s28, 2
    s_add_u32 s34, s34, s29
    s_lshl_b32 s34, s34, 15
    s_add_u32 s44, s34, 28311552
    s_lshl_b32 s34, s28, 4
    s_add_u32 s34, s34, s48
    s_lshl_b32 s34, s34, 11
    s_add_u32 s88, s34, 33325056
    s_sub_u32 s45, s44, 131072
    s_mov_b32 s53, 0
    v_bfe_u32 v4, v1, 4, 4
    v_mul_u32_u24 v4, 328, v4
    v_lshrrev_b32 v5, 9, v1
    v_lshl_add_u32 v8, v5, 3, v4
    v_lshl_add_u32 v9, v5, 2, v8
    s_waitcnt vmcnt(0) lgkmcnt(0)
    s_barrier
    s_barrier
    s_mov_b32 exec_lo, 0xffff0000
    s_mov_b32 exec_hi, 0xffff0000
    s_cmp_eq_u32 s28, 0
    s_cbranch_scc1 L_ahalo_zero
    s_mov_b32 s36, 0
L_ahalo_poll:
    s_add_u32 s37, s45, 0
    buffer_load_dwordx4 v[56:59], v1, s[16:19], s37 offen offset:0 sc1
    buffer_load_dwordx4 v[60:63], v1, s[16:19], s37 offen offset:1024 sc1
    buffer_load_dwordx4 v[64:67], v1, s[16:19], s37 offen offset:2048 sc1
    buffer_load_dwordx4 v[68:71], v1, s[16:19], s37 offen offset:3072 sc1
    s_add_u32 s37, s45, 4096
    buffer_load_dwordx4 v[72:75], v1, s[16:19], s37 offen offset:0 sc1
    buffer_load_dwordx4 v[76:79], v1, s[16:19], s37 offen offset:1024 sc1
    buffer_load_dwordx4 v[80:83], v1, s[16:19], s37 offen offset:2048 sc1
    buffer_load_dwordx4 v[84:87], v1, s[16:19], s37 offen offset:3072 sc1
    s_add_u32 s37, s45, 8192
    buffer_load_dwordx4 v[88:91], v1, s[16:19], s37 offen offset:0 sc1
    buffer_load_dwordx4 v[92:95], v1, s[16:19], s37 offen offset:1024 sc1
    buffer_load_dwordx4 v[96:99], v1, s[16:19], s37 offen offset:2048 sc1
    buffer_load_dwordx4 v[100:103], v1, s[16:19], s37 offen offset:3072 sc1
    s_add_u32 s37, s45, 12288
    buffer_load_dwordx4 v[104:107], v1, s[16:19], s37 offen offset:0 sc1
    buffer_load_dwordx4 v[108:111], v1, s[16:19], s37 offen offset:1024 sc1
    buffer_load_dwordx4 v[112:115], v1, s[16:19], s37 offen offset:2048 sc1
    buffer_load_dwordx4 v[116:119], v1, s[16:19], s37 offen offset:3072 sc1
    s_add_u32 s37, s45, 16384
    buffer_load_dwordx4 v[120:123], v1, s[16:19], s37 offen offset:0 sc1
    buffer_load_dwordx4 v[124:127], v1, s[16:19], s37 offen offset:1024 sc1
    buffer_load_dwordx4 v[128:131], v1, s[16:19], s37 offen offset:2048 sc1
    buffer_load_dwordx4 v[132:135], v1, s[16:19], s37 offen offset:3072 sc1
    s_add_u32 s37, s45, 20480
    buffer_load_dwordx4 v[136:139], v1, s[16:19], s37 offen offset:0 sc1
    buffer_load_dwordx4 v[140:143], v1, s[16:19], s37 offen offset:1024 sc1
    buffer_load_dwordx4 v[144:147], v1, s[16:19], s37 offen offset:2048 sc1
    buffer_load_dwordx4 v[148:151], v1, s[16:19], s37 offen offset:3072 sc1
    s_add_u32 s37, s45, 24576
    buffer_load_dwordx4 v[152:155], v1, s[16:19], s37 offen offset:0 sc1
    v_mov_b32 v4, 0
    s_waitcnt vmcnt(24)
    v_xor_b32 v5, s46, v59
    v_or_b32 v4, v4, v5
    s_waitcnt vmcnt(23)
    v_xor_b32 v5, s46, v63
    v_or_b32 v4, v4, v5
    s_waitcnt vmcnt(22)
    v_xor_b32 v5, s46, v67
    v_or_b32 v4, v4, v5
    s_waitcnt vmcnt(21)
    v_xor_b32 v5, s46, v71
    v_or_b32 v4, v4, v5
    s_waitcnt vmcnt(20)
    v_xor_b32 v5, s46, v75
    v_or_b32 v4, v4, v5
    s_waitcnt vmcnt(19)
    v_xor_b32 v5, s46, v79
    v_or_b32 v4, v4, v5
    s_waitcnt vmcnt(18)
    v_xor_b32 v5, s46, v83
    v_or_b32 v4, v4, v5
    s_waitcnt vmcnt(17)
    v_xor_b32 v5, s46, v87
    v_or_b32 v4, v4, v5
    s_waitcnt vmcnt(16)
    v_xor_b32 v5, s46, v91
    v_or_b32 v4, v4, v5
    s_waitcnt vmcnt(15)
    v_xor_b32 v5, s46, v95
    v_or_b32 v4, v4, v5
    s_waitcnt vmcnt(14)
    v_xor_b32 v5, s46, v99
    v_or_b32 v4, v4, v5
    s_waitcnt vmcnt(13)
    v_xor_b32 v5, s46, v103
    v_or_b32 v4, v4, v5
    s_waitcnt vmcnt(12)
    v_xor_b32 v5, s46, v107
    v_or_b32 v4, v4, v5
    s_waitcnt vmcnt(11)
    v_xor_b32 v5, s46, v111
    v_or_b32 v4, v4, v5
    s_waitcnt vmcnt(10)
    v_xor_b32 v5, s46, v115
    v_or_b32 v4, v4, v5
    s_waitcnt vmcnt(9)
    v_xor_b32 v5, s46, v119
    v_or_b32 v4, v4, v5
    s_waitcnt vmcnt(8)
    v_xor_b32 v5, s46, v123
    v_or_b32 v4, v4, v5
    s_waitcnt vmcnt(7)
    v_xor_b32 v5, s46, v127
    v_or_b32 v4, v4, v5
    s_waitcnt vmcnt(6)
    v_xor_b32 v5, s46, v131
    v_or_b32 v4, v4, v5
    s_waitcnt vmcnt(5)
    v_xor_b32 v5, s46, v135
    v_or_b32 v4, v4, v5
    s_waitcnt vmcnt(4)
    v_xor_b32 v5, s46, v139
    v_or_b32 v4, v4, v5
    s_waitcnt vmcnt(3)
    v_xor_b32 v5, s46, v143
    v_or_b32 v4, v4, v5
    s_waitcnt vmcnt(2)
    v_xor_b32 v5, s46, v147
    v_or_b32 v4, v4, v5
    s_waitcnt vmcnt(1)
    v_xor_b32 v5, s46, v151
    v_or_b32 v4, v4, v5
    s_waitcnt vmcnt(0)
    v_xor_b32 v5, s46, v155
    v_or_b32 v4, v4, v5
    v_cmp_ne_u32 vcc, 0, v4
    s_add_u32 s36, s36, 1
    s_cmp_ge_u32 s36, 262144
    s_cbranch_scc1 L_ahalo_wr
    s_cmp_lg_u64 vcc, 0
    s_cbranch_scc1 L_ahalo_poll
    s_branch L_ahalo_wr
L_ahalo_zero:
    v_mov_b32 v56, 0
    v_mov_b32 v57, 0
    v_mov_b32 v58, 0
    v_mov_b32 v59, 0
    v_mov_b32 v60, 0
    v_mov_b32 v61, 0
    v_mov_b32 v62, 0
    v_mov_b32 v63, 0
    v_mov_b32 v64, 0
    v_mov_b32 v65, 0
    v_mov_b32 v66, 0
    v_mov_b32 v67, 0
    v_mov_b32 v68, 0
    v_mov_b32 v69, 0
    v_mov_b32 v70, 0
    v_mov_b32 v71, 0
    v_mov_b32 v72, 0
    v_mov_b32 v73, 0
    v_mov_b32 v74, 0
    v_mov_b32 v75, 0
    v_mov_b32 v76, 0
    v_mov_b32 v77, 0
    v_mov_b32 v78, 0
    v_mov_b32 v79, 0
    v_mov_b32 v80, 0
    v_mov_b32 v81, 0
    v_mov_b32 v82, 0
    v_mov_b32 v83, 0
    v_mov_b32 v84, 0
    v_mov_b32 v85, 0
    v_mov_b32 v86, 0
    v_mov_b32 v87, 0
    v_mov_b32 v88, 0
    v_mov_b32 v89, 0
    v_mov_b32 v90, 0
    v_mov_b32 v91, 0
    v_mov_b32 v92, 0
    v_mov_b32 v93, 0
    v_mov_b32 v94, 0
    v_mov_b32 v95, 0
    v_mov_b32 v96, 0
    v_mov_b32 v97, 0
    v_mov_b32 v98, 0
    v_mov_b32 v99, 0
    v_mov_b32 v100, 0
    v_mov_b32 v101, 0
    v_mov_b32 v102, 0
    v_mov_b32 v103, 0
    v_mov_b32 v104, 0
    v_mov_b32 v105, 0
    v_mov_b32 v106, 0
    v_mov_b32 v107, 0
    v_mov_b32 v108, 0
    v_mov_b32 v109, 0
    v_mov_b32 v110, 0
    v_mov_b32 v111, 0
    v_mov_b32 v112, 0
    v_mov_b32 v113, 0
    v_mov_b32 v114, 0
    v_mov_b32 v115, 0
    v_mov_b32 v116, 0
    v_mov_b32 v117, 0
    v_mov_b32 v118, 0
    v_mov_b32 v119, 0
    v_mov_b32 v120, 0
    v_mov_b32 v121, 0
    v_mov_b32 v122, 0
    v_mov_b32 v123, 0
    v_mov_b32 v124, 0
    v_mov_b32 v125, 0
    v_mov_b32 v126, 0
    v_mov_b32 v127, 0
    v_mov_b32 v128, 0
    v_mov_b32 v129, 0
    v_mov_b32 v130, 0
    v_mov_b32 v131, 0
    v_mov_b32 v132, 0
    v_mov_b32 v133, 0
    v_mov_b32 v134, 0
    v_mov_b32 v135, 0
    v_mov_b32 v136, 0
    v_mov_b32 v137, 0
    v_mov_b32 v138, 0
    v_mov_b32 v139, 0
    v_mov_b32 v140, 0
    v_mov_b32 v141, 0
    v_mov_b32 v142, 0
    v_mov_b32 v143, 0
    v_mov_b32 v144, 0
    v_mov_b32 v145, 0
    v_mov_b32 v146, 0
    v_mov_b32 v147, 0
    v_mov_b32 v148, 0
    v_mov_b32 v149, 0
    v_mov_b32 v150, 0
    v_mov_b32 v151, 0
    v_mov_b32 v152, 0
    v_mov_b32 v153, 0
    v_mov_b32 v154, 0
    v_mov_b32 v155, 0
    s_nop 2
L_ahalo_wr:
    ds_write_b32 v8, v56 offset:0
    ds_write_b32 v8, v57 offset:4
    ds_write_b32 v8, v58 offset:16
    ds_write_b32 v8, v60 offset:20
    ds_write_b32 v9, v61 offset:32
    ds_write_b32 v8, v62 offset:40
    ds_write_b32 v8, v64 offset:52
    ds_write_b32 v8, v65 offset:56
    ds_write_b32 v9, v66 offset:68
    ds_write_b32 v9, v68 offset:72
    ds_write_b32 v8, v69 offset:88
    ds_write_b32 v8, v70 offset:92
    ds_write_b32 v8, v72 offset:104
    ds_write_b32 v9, v73 offset:108
    ds_write_b32 v8, v74 offset:124
    ds_write_b32 v8, v76 offset:128
    ds_write_b32 v8, v77 offset:140
    ds_write_b32 v8, v78 offset:144
    ds_write_b32 v8, v80 offset:160
    ds_write_b32 v8, v81 offset:164
    ds_write_b32 v8, v82 offset:176
    ds_write_b32 v8, v84 offset:180
    ds_write_b32 v9, v85 offset:192
    ds_write_b32 v8, v86 offset:200
    ds_write_b32 v8, v88 offset:212
    ds_write_b32 v8, v89 offset:216
    ds_write_b32 v9, v90 offset:228
    ds_write_b32 v9, v92 offset:232
    ds_write_b32 v8, v93 offset:248
    ds_write_b32 v8, v94 offset:252
    ds_write_b32 v8, v96 offset:264
    ds_write_b32 v9, v97 offset:268
    ds_write_b32 v8, v98 offset:284
    ds_write_b32 v8, v100 offset:288
    ds_write_b32 v8, v101 offset:300
    ds_write_b32 v8, v102 offset:304
    ds_write_b32 v8, v104 offset:47232
    ds_write_b32 v8, v105 offset:47236
    ds_write_b32 v8, v106 offset:47248
    ds_write_b32 v8, v108 offset:47252
    ds_write_b32 v9, v109 offset:47264
    ds_write_b32 v8, v110 offset:47272
    ds_write_b32 v8, v112 offset:47284
    ds_write_b32 v8, v113 offset:47288
    ds_write_b32 v9, v114 offset:47300
    ds_write_b32 v9, v116 offset:47304
    ds_write_b32 v8, v117 offset:47320
    ds_write_b32 v8, v118 offset:47324
    ds_write_b32 v8, v120 offset:47336
    ds_write_b32 v9, v121 offset:47340
    ds_write_b32 v8, v122 offset:47356
    ds_write_b32 v8, v124 offset:47360
    ds_write_b32 v8, v125 offset:47372
    ds_write_b32 v8, v126 offset:47376
    ds_write_b32 v8, v128 offset:47392
    ds_write_b32 v8, v129 offset:47396
    ds_write_b32 v8, v132 offset:47408
    ds_write_b32 v8, v133 offset:47412
    ds_write_b32 v9, v134 offset:47424
    ds_write_b32 v8, v136 offset:47432
    ds_write_b32 v8, v137 offset:47444
    ds_write_b32 v8, v138 offset:47448
    ds_write_b32 v9, v140 offset:47460
    ds_write_b32 v9, v141 offset:47464
    ds_write_b32 v8, v142 offset:47480
    ds_write_b32 v8, v144 offset:47484
    ds_write_b32 v8, v145 offset:47496
    ds_write_b32 v9, v146 offset:47500
    ds_write_b32 v8, v148 offset:47516
    ds_write_b32 v8, v149 offset:47520
    ds_write_b32 v8, v150 offset:47532
    ds_write_b32 v8, v152 offset:47536
    s_mov_b64 exec, -1
    s_waitcnt vmcnt(0) lgkmcnt(0)
    s_setprio 3
    s_branch L_attn
L_exit:
    s_endpgm
L_code_end:
.set CODE_LAST, L_code_end - L_cpf0F - 128
.set CODE_F, L_roleA - L_tgtF
.set CODE_A, L_code_end - L_tgtA - 16
.section .rodata,"a"
.p2align 6
.amdhsa_kernel parallel_sum__sliding_local_dilated__dense_activation_squared_relu__prompt_kernel
  .amdhsa_next_free_vgpr 168
  .amdhsa_next_free_sgpr 100
  .amdhsa_accum_offset 168
  .amdhsa_group_segment_fixed_size 0
  .amdhsa_kernarg_size 88
  .amdhsa_user_sgpr_count 2
  .amdhsa_user_sgpr_kernarg_segment_ptr 1
  .amdhsa_system_sgpr_workgroup_id_x 1
.end_amdhsa_kernel
```
